```python
import torch

def _softmax(x, axis=-1):
    return torch.softmax(x, dim=axis)
def _gelu(x):
    return torch.nn.functional.gelu(x, approximate="tanh")
def _silu(x):
    return torch.nn.functional.silu(x)
def _sigmoid(x):
    return torch.sigmoid(x)
def _layernorm(x, axis=-1, eps=1e-5):
    m = x.mean(dim=axis, keepdim=True)
    v = x.var(dim=axis, keepdim=True, unbiased=False)
    return (x - m) / torch.sqrt(v + eps)
def _scatter_add(tgt, idx, src, axis=0):
    return tgt.clone().index_add_(axis, idx, src)
def _segment_sum(src, seg, n):
    out = torch.zeros((n,) + src.shape[1:], dtype=src.dtype)
    return out.index_add_(0, seg, src)
def _pad(x, pw):
    flat = tuple(v for pair in reversed(pw) for v in pair)
    return torch.nn.functional.pad(x, flat)

kernel_name = 'sequential_preLN__grouped_kv_mqa__moe_arch_mod__prompt'

def setup_inputs():

    _w = (lambda a: (lambda t: t.to(torch.bfloat16) if t.is_floating_point() else t)(torch.as_tensor(a)))
    def _A_setup():
        B, S, D, H = 1, 2048, 640, 32
        Dh = D // H
        return {
            "x": _w((lambda *s: torch.randn(*s, dtype=torch.bfloat16) * 0.05)(B, S, D)),
            "wq": _w((lambda *s: torch.randn(*s, dtype=torch.bfloat16) * 0.05)(D, H * Dh)),
            "wk": _w((lambda *s: torch.randn(*s, dtype=torch.bfloat16) * 0.05)(D, Dh)),
            "wv": _w((lambda *s: torch.randn(*s, dtype=torch.bfloat16) * 0.05)(D, Dh)),
            "wo": _w((lambda *s: torch.randn(*s, dtype=torch.bfloat16) * 0.05)(H * Dh, D)),
        }
    _A_in = _A_setup()

    def _B_setup():
        B, S, D, F, C = 1, 2048, 640, 1728, 1
        return {
            "x": _w((lambda *s: torch.randn(*s, dtype=torch.bfloat16) * 0.05)(B, S, D)),
            "w_r": _w((lambda *s: torch.randn(*s, dtype=torch.bfloat16) * 0.05)(D)),
            "w_gate": _w((lambda *s: torch.randn(*s, dtype=torch.bfloat16) * 0.05)(D, F)),
            "w_up": _w((lambda *s: torch.randn(*s, dtype=torch.bfloat16) * 0.05)(D, F)),
            "w_down": _w((lambda *s: torch.randn(*s, dtype=torch.bfloat16) * 0.05)(F, D)),
        }
    _B_in = _B_setup()

    return {
        "A_x": _A_in["x"],
        "A_wq": _A_in["wq"],
        "A_wk": _A_in["wk"],
        "A_wv": _A_in["wv"],
        "A_wo": _A_in["wo"],
        "B_x": _B_in["x"],
        "B_w_r": _B_in["w_r"],
        "B_w_gate": _B_in["w_gate"],
        "B_w_up": _B_in["w_up"],
        "B_w_down": _B_in["w_down"],
    }

def reference(A_x, A_wq, A_wk, A_wv, A_wo, B_x, B_w_r, B_w_gate, B_w_up, B_w_down):
    def _A_ref(x, wq, wk, wv, wo):
        B, S, D = x.shape
        H = 32
        Dh = D // H
        q = (lambda x, *d: x.permute(*d))((x @ wq).reshape(B, S, H, Dh), 0, 2, 1, 3)
        k = x @ wk
        v = x @ wv
        scores = torch.einsum("bhqd,bkd->bhqk", q, k) * (Dh ** -0.5)
        p = _softmax(scores, axis=-1)
        o = torch.einsum("bhqk,bkd->bhqd", p, v)
        return (lambda x, *d: x.permute(*d))(o, 0, 2, 1, 3).reshape(B, S, H * Dh) @ wo

    def _B_ref(x, w_r, w_gate, w_up, w_down):
        B, S, D = x.shape
        C = 1
        r = x @ w_r
        idx = torch.argsort(-r, axis=-1)[:, :C]
        idx_e = (lambda x, n, axis: torch.repeat_interleave(x, n, dim=axis))(idx.reshape(B, C, 1), D, axis=2)
        x_sel = (lambda x, i, axis: torch.take_along_dim(x, i, dim=axis))(x, idx_e, axis=1)
        g = _silu(x_sel @ w_gate)
        u = x_sel @ w_up
        y = (g * u) @ w_down
        r_sel = _sigmoid((lambda x, i, axis: torch.take_along_dim(x, i, dim=axis))(r, idx, axis=1))
        y = y * r_sel.reshape(B, C, 1)
        b_off = (torch.arange(B) * S).reshape(B, 1)
        flat_idx = (idx + b_off).reshape(B * C)
        zero = (x * 0.0).reshape(B * S, D)
        upd = _scatter_add(zero, flat_idx, y.reshape(B * C, D), axis=0)
        return x + upd.reshape(B, S, D)

    x = A_x
    h = x + _A_ref(_layernorm(x, axis=-1), A_wq, A_wk, A_wv, A_wo)
    h2 = h + _B_ref(_layernorm(h, axis=-1), B_w_r, B_w_gate, B_w_up, B_w_down)
    return h2
```

```asm
; @launch kernel=kv_kernel grid=(386,1,1) block=(256,1,1) lds=77824
; @launch kernel=attn_kernel grid=(256,1,1) block=(512,1,1) lds=163840
; @launch kernel=oproj_kernel grid=(256,1,1) block=(512,1,1) lds=110592
; @launch kernel=ffn_kernel grid=(276,1,1) block=(256,1,1) lds=4096
.amdgcn_target "amdgcn-amd-amdhsa--gfx950"
.text
.globl kv_kernel
.p2align 8
.type kv_kernel,@function
kv_kernel:
    s_cmp_ge_u32 s2, 386
    s_cbranch_scc1 kv_kernel_exit
    s_cmp_ge_u32 s2, 128
    s_cbranch_scc1 kv_kernel_cpy
    s_load_dwordx2 s[4:5], s[0:1], 0
    s_load_dwordx4 s[8:11], s[0:1], 16
    s_load_dwordx2 s[12:13], s[0:1], 96
    s_load_dwordx2 s[14:15], s[0:1], 48
    v_and_b32 v1, 63, v0
    v_lshrrev_b32 v2, 6, v0
    s_and_b32 s17, s2, 7
    s_lshl_b32 s17, s17, 4
    s_lshr_b32 s44, s2, 3
    s_add_u32 s17, s17, s44
    v_readfirstlane_b32 s18, v2
    v_and_b32 v3, 15, v1
    v_lshrrev_b32 v4, 4, v1
    s_waitcnt lgkmcnt(0)
    s_mov_b32 s20, s4
    s_mov_b32 s21, s5
    s_mov_b32 s22, 2621440
    s_mov_b32 s23, 0x00020000
    s_mov_b32 s24, s8
    s_mov_b32 s25, s9
    s_mov_b32 s26, 25600
    s_mov_b32 s27, 0x00020000
    s_mov_b32 s28, s10
    s_mov_b32 s29, s11
    s_mov_b32 s30, 25600
    s_mov_b32 s31, 0x00020000
    s_mul_i32 s45, s17, 20480
    s_mul_i32 s46, s18, 320
    s_mul_i32 s48, s18, 5120
    v_add_u32 v6, s46, v1
    v_add_u32 v6, 0, v6
    v_mul_u32_u24 v7, 3277, v6
    v_lshrrev_b32 v7, 18, v7
    v_mul_u32_u24 v8, 80, v7
    v_sub_u32 v8, v6, v8
    v_xor_b32 v8, v8, v7
    v_mul_u32_u24 v7, 1280, v7
    v_lshl_add_u32 v7, v8, 4, v7
    s_mov_b32 m0, s48
    s_add_u32 s48, s48, 1024
    buffer_load_dwordx4 v7, s[20:23], s45 offen lds
    v_add_u32 v6, s46, v1
    v_add_u32 v6, 64, v6
    v_mul_u32_u24 v7, 3277, v6
    v_lshrrev_b32 v7, 18, v7
    v_mul_u32_u24 v8, 80, v7
    v_sub_u32 v8, v6, v8
    v_xor_b32 v8, v8, v7
    v_mul_u32_u24 v7, 1280, v7
    v_lshl_add_u32 v7, v8, 4, v7
    s_mov_b32 m0, s48
    s_add_u32 s48, s48, 1024
    buffer_load_dwordx4 v7, s[20:23], s45 offen lds
    v_add_u32 v6, s46, v1
    v_add_u32 v6, 128, v6
    v_mul_u32_u24 v7, 3277, v6
    v_lshrrev_b32 v7, 18, v7
    v_mul_u32_u24 v8, 80, v7
    v_sub_u32 v8, v6, v8
    v_xor_b32 v8, v8, v7
    v_mul_u32_u24 v7, 1280, v7
    v_lshl_add_u32 v7, v8, 4, v7
    s_mov_b32 m0, s48
    s_add_u32 s48, s48, 1024
    buffer_load_dwordx4 v7, s[20:23], s45 offen lds
    v_add_u32 v6, s46, v1
    v_add_u32 v6, 192, v6
    v_mul_u32_u24 v7, 3277, v6
    v_lshrrev_b32 v7, 18, v7
    v_mul_u32_u24 v8, 80, v7
    v_sub_u32 v8, v6, v8
    v_xor_b32 v8, v8, v7
    v_mul_u32_u24 v7, 1280, v7
    v_lshl_add_u32 v7, v8, 4, v7
    s_mov_b32 m0, s48
    s_add_u32 s48, s48, 1024
    buffer_load_dwordx4 v7, s[20:23], s45 offen lds
    v_add_u32 v6, s46, v1
    v_add_u32 v6, 256, v6
    v_mul_u32_u24 v7, 3277, v6
    v_lshrrev_b32 v7, 18, v7
    v_mul_u32_u24 v8, 80, v7
    v_sub_u32 v8, v6, v8
    v_xor_b32 v8, v8, v7
    v_mul_u32_u24 v7, 1280, v7
    v_lshl_add_u32 v7, v8, 4, v7
    s_mov_b32 m0, s48
    s_add_u32 s48, s48, 1024
    buffer_load_dwordx4 v7, s[20:23], s45 offen lds
    v_lshlrev_b32 v7, 4, v1
    s_lshl_b32 s47, s18, 10
    s_add_u32 s48, s47, 20480
    s_mov_b32 m0, s48
    s_add_u32 s49, s48, 28672
    buffer_load_dwordx4 v7, s[24:27], s47 offen lds
    s_mov_b32 m0, s49
    s_add_u32 s48, s48, 4096
    buffer_load_dwordx4 v7, s[28:31], s47 offen lds
    s_add_u32 s47, s47, 4096
    s_mov_b32 m0, s48
    s_add_u32 s49, s48, 28672
    buffer_load_dwordx4 v7, s[24:27], s47 offen lds
    s_mov_b32 m0, s49
    s_add_u32 s48, s48, 4096
    buffer_load_dwordx4 v7, s[28:31], s47 offen lds
    s_add_u32 s47, s47, 4096
    s_mov_b32 m0, s48
    s_add_u32 s49, s48, 28672
    buffer_load_dwordx4 v7, s[24:27], s47 offen lds
    s_mov_b32 m0, s49
    s_add_u32 s48, s48, 4096
    buffer_load_dwordx4 v7, s[28:31], s47 offen lds
    s_add_u32 s47, s47, 4096
    s_mov_b32 m0, s48
    s_add_u32 s49, s48, 28672
    buffer_load_dwordx4 v7, s[24:27], s47 offen lds
    s_mov_b32 m0, s49
    s_add_u32 s48, s48, 4096
    buffer_load_dwordx4 v7, s[28:31], s47 offen lds
    s_add_u32 s47, s47, 4096
    s_mov_b32 m0, s48
    s_add_u32 s49, s48, 28672
    buffer_load_dwordx4 v7, s[24:27], s47 offen lds
    s_mov_b32 m0, s49
    s_add_u32 s48, s48, 4096
    buffer_load_dwordx4 v7, s[28:31], s47 offen lds
    s_add_u32 s47, s47, 4096
    s_mov_b32 m0, s48
    s_add_u32 s49, s48, 28672
    buffer_load_dwordx4 v7, s[24:27], s47 offen lds
    s_mov_b32 m0, s49
    s_add_u32 s48, s48, 4096
    buffer_load_dwordx4 v7, s[28:31], s47 offen lds
    s_add_u32 s47, s47, 4096
    s_mov_b32 m0, s48
    s_add_u32 s49, s48, 28672
    buffer_load_dwordx4 v7, s[24:27], s47 offen lds
    s_mov_b32 m0, s49
    s_add_u32 s48, s48, 4096
    buffer_load_dwordx4 v7, s[28:31], s47 offen lds
    s_add_u32 s47, s47, 4096
    v_mul_u32_u24 v9, 1280, v3
    v_and_b32 v6, 3, v3
    v_xor_b32 v6, v6, v4
    v_lshl_add_u32 v9, v6, 4, v9
    v_and_b32 v10, 12, v3
    v_lshrrev_b32 v12, 2, v1
    v_and_b32 v12, 3, v12
    v_lshl_add_u32 v12, v4, 3, v12
    v_and_b32 v13, 3, v1
    v_mul_u32_u24 v11, 40, v12
    v_lshl_add_u32 v11, v13, 3, v11
    s_lshr_b32 s46, s18, 1
    s_mul_i32 s46, s46, 28672
    s_and_b32 s47, s18, 1
    s_lshl_b32 s47, s47, 5
    s_add_u32 s46, s46, s47
    s_add_u32 s46, s46, 20480
    v_add_u32 v11, s46, v11
    v_xor_b32 v6, 0, v10
    v_lshl_add_u32 v60, v6, 4, v9
    v_xor_b32 v6, 4, v10
    v_lshl_add_u32 v61, v6, 4, v9
    v_xor_b32 v6, 8, v10
    v_lshl_add_u32 v62, v6, 4, v9
    v_xor_b32 v6, 12, v10
    v_lshl_add_u32 v63, v6, 4, v9
    v_mov_b32 v40, 0x3f803f80
    v_mov_b32 v44, 0
    v_mov_b32 v41, 0x3f803f80
    v_mov_b32 v45, 0
    v_mov_b32 v42, 0x3f803f80
    v_mov_b32 v46, 0
    v_mov_b32 v43, 0x3f803f80
    v_mov_b32 v47, 0
    s_add_u32 s36, s12, 4194304
    s_addc_u32 s37, s13, 0
    s_mov_b32 s38, 163840
    s_mov_b32 s39, 0x00020000
    s_waitcnt vmcnt(0)
    s_barrier
    ds_read_b128 v[16:19], v60 offset:0
    ds_read_b64_tr_b16 v[24:25], v11 offset:0
    ds_read_b64_tr_b16 v[26:27], v11 offset:160
    ds_read_b128 v[20:23], v61 offset:0
    ds_read_b64_tr_b16 v[28:29], v11 offset:1280
    ds_read_b64_tr_b16 v[30:31], v11 offset:1440
    s_waitcnt lgkmcnt(3)
    v_mfma_f32_16x16x32_bf16 v[32:35], v[24:27], v[16:19], 0
    v_mfma_f32_16x16x32_bf16 v[36:39], v[24:27], v[40:43], 0
    v_dot2_f32_bf16 v44, v16, v40, v44
    v_dot2_f32_bf16 v46, v16, v16, v46
    v_dot2_f32_bf16 v45, v17, v40, v45
    v_dot2_f32_bf16 v47, v17, v17, v47
    v_dot2_f32_bf16 v44, v18, v40, v44
    v_dot2_f32_bf16 v46, v18, v18, v46
    v_dot2_f32_bf16 v45, v19, v40, v45
    v_dot2_f32_bf16 v47, v19, v19, v47
    ds_read_b128 v[16:19], v62 offset:0
    ds_read_b64_tr_b16 v[24:25], v11 offset:2560
    ds_read_b64_tr_b16 v[26:27], v11 offset:2720
    s_waitcnt lgkmcnt(3)
    v_mfma_f32_16x16x32_bf16 v[32:35], v[28:31], v[20:23], v[32:35]
    v_mfma_f32_16x16x32_bf16 v[36:39], v[28:31], v[40:43], v[36:39]
    v_dot2_f32_bf16 v44, v20, v40, v44
    v_dot2_f32_bf16 v46, v20, v20, v46
    v_dot2_f32_bf16 v45, v21, v40, v45
    v_dot2_f32_bf16 v47, v21, v21, v47
    v_dot2_f32_bf16 v44, v22, v40, v44
    v_dot2_f32_bf16 v46, v22, v22, v46
    v_dot2_f32_bf16 v45, v23, v40, v45
    v_dot2_f32_bf16 v47, v23, v23, v47
    ds_read_b128 v[20:23], v63 offset:0
    ds_read_b64_tr_b16 v[28:29], v11 offset:3840
    ds_read_b64_tr_b16 v[30:31], v11 offset:4000
    s_waitcnt lgkmcnt(3)
    v_mfma_f32_16x16x32_bf16 v[32:35], v[24:27], v[16:19], v[32:35]
    v_mfma_f32_16x16x32_bf16 v[36:39], v[24:27], v[40:43], v[36:39]
    v_dot2_f32_bf16 v44, v16, v40, v44
    v_dot2_f32_bf16 v46, v16, v16, v46
    v_dot2_f32_bf16 v45, v17, v40, v45
    v_dot2_f32_bf16 v47, v17, v17, v47
    v_dot2_f32_bf16 v44, v18, v40, v44
    v_dot2_f32_bf16 v46, v18, v18, v46
    v_dot2_f32_bf16 v45, v19, v40, v45
    v_dot2_f32_bf16 v47, v19, v19, v47
    ds_read_b128 v[16:19], v60 offset:256
    ds_read_b64_tr_b16 v[24:25], v11 offset:5120
    ds_read_b64_tr_b16 v[26:27], v11 offset:5280
    s_waitcnt lgkmcnt(3)
    v_mfma_f32_16x16x32_bf16 v[32:35], v[28:31], v[20:23], v[32:35]
    v_mfma_f32_16x16x32_bf16 v[36:39], v[28:31], v[40:43], v[36:39]
    v_dot2_f32_bf16 v44, v20, v40, v44
    v_dot2_f32_bf16 v46, v20, v20, v46
    v_dot2_f32_bf16 v45, v21, v40, v45
    v_dot2_f32_bf16 v47, v21, v21, v47
    v_dot2_f32_bf16 v44, v22, v40, v44
    v_dot2_f32_bf16 v46, v22, v22, v46
    v_dot2_f32_bf16 v45, v23, v40, v45
    v_dot2_f32_bf16 v47, v23, v23, v47
    ds_read_b128 v[20:23], v61 offset:256
    ds_read_b64_tr_b16 v[28:29], v11 offset:6400
    ds_read_b64_tr_b16 v[30:31], v11 offset:6560
    s_waitcnt lgkmcnt(3)
    v_mfma_f32_16x16x32_bf16 v[32:35], v[24:27], v[16:19], v[32:35]
    v_mfma_f32_16x16x32_bf16 v[36:39], v[24:27], v[40:43], v[36:39]
    v_dot2_f32_bf16 v44, v16, v40, v44
    v_dot2_f32_bf16 v46, v16, v16, v46
    v_dot2_f32_bf16 v45, v17, v40, v45
    v_dot2_f32_bf16 v47, v17, v17, v47
    v_dot2_f32_bf16 v44, v18, v40, v44
    v_dot2_f32_bf16 v46, v18, v18, v46
    v_dot2_f32_bf16 v45, v19, v40, v45
    v_dot2_f32_bf16 v47, v19, v19, v47
    ds_read_b128 v[16:19], v62 offset:256
    ds_read_b64_tr_b16 v[24:25], v11 offset:7680
    ds_read_b64_tr_b16 v[26:27], v11 offset:7840
    s_waitcnt lgkmcnt(3)
    v_mfma_f32_16x16x32_bf16 v[32:35], v[28:31], v[20:23], v[32:35]
    v_mfma_f32_16x16x32_bf16 v[36:39], v[28:31], v[40:43], v[36:39]
    v_dot2_f32_bf16 v44, v20, v40, v44
    v_dot2_f32_bf16 v46, v20, v20, v46
    v_dot2_f32_bf16 v45, v21, v40, v45
    v_dot2_f32_bf16 v47, v21, v21, v47
    v_dot2_f32_bf16 v44, v22, v40, v44
    v_dot2_f32_bf16 v46, v22, v22, v46
    v_dot2_f32_bf16 v45, v23, v40, v45
    v_dot2_f32_bf16 v47, v23, v23, v47
    ds_read_b128 v[20:23], v63 offset:256
    ds_read_b64_tr_b16 v[28:29], v11 offset:8960
    ds_read_b64_tr_b16 v[30:31], v11 offset:9120
    s_waitcnt lgkmcnt(3)
    v_mfma_f32_16x16x32_bf16 v[32:35], v[24:27], v[16:19], v[32:35]
    v_mfma_f32_16x16x32_bf16 v[36:39], v[24:27], v[40:43], v[36:39]
    v_dot2_f32_bf16 v44, v16, v40, v44
    v_dot2_f32_bf16 v46, v16, v16, v46
    v_dot2_f32_bf16 v45, v17, v40, v45
    v_dot2_f32_bf16 v47, v17, v17, v47
    v_dot2_f32_bf16 v44, v18, v40, v44
    v_dot2_f32_bf16 v46, v18, v18, v46
    v_dot2_f32_bf16 v45, v19, v40, v45
    v_dot2_f32_bf16 v47, v19, v19, v47
    ds_read_b128 v[16:19], v60 offset:512
    ds_read_b64_tr_b16 v[24:25], v11 offset:10240
    ds_read_b64_tr_b16 v[26:27], v11 offset:10400
    s_waitcnt lgkmcnt(3)
    v_mfma_f32_16x16x32_bf16 v[32:35], v[28:31], v[20:23], v[32:35]
    v_mfma_f32_16x16x32_bf16 v[36:39], v[28:31], v[40:43], v[36:39]
    v_dot2_f32_bf16 v44, v20, v40, v44
    v_dot2_f32_bf16 v46, v20, v20, v46
    v_dot2_f32_bf16 v45, v21, v40, v45
    v_dot2_f32_bf16 v47, v21, v21, v47
    v_dot2_f32_bf16 v44, v22, v40, v44
    v_dot2_f32_bf16 v46, v22, v22, v46
    v_dot2_f32_bf16 v45, v23, v40, v45
    v_dot2_f32_bf16 v47, v23, v23, v47
    ds_read_b128 v[20:23], v61 offset:512
    ds_read_b64_tr_b16 v[28:29], v11 offset:11520
    ds_read_b64_tr_b16 v[30:31], v11 offset:11680
    s_waitcnt lgkmcnt(3)
    v_mfma_f32_16x16x32_bf16 v[32:35], v[24:27], v[16:19], v[32:35]
    v_mfma_f32_16x16x32_bf16 v[36:39], v[24:27], v[40:43], v[36:39]
    v_dot2_f32_bf16 v44, v16, v40, v44
    v_dot2_f32_bf16 v46, v16, v16, v46
    v_dot2_f32_bf16 v45, v17, v40, v45
    v_dot2_f32_bf16 v47, v17, v17, v47
    v_dot2_f32_bf16 v44, v18, v40, v44
    v_dot2_f32_bf16 v46, v18, v18, v46
    v_dot2_f32_bf16 v45, v19, v40, v45
    v_dot2_f32_bf16 v47, v19, v19, v47
    ds_read_b128 v[16:19], v62 offset:512
    ds_read_b64_tr_b16 v[24:25], v11 offset:12800
    ds_read_b64_tr_b16 v[26:27], v11 offset:12960
    s_waitcnt lgkmcnt(3)
    v_mfma_f32_16x16x32_bf16 v[32:35], v[28:31], v[20:23], v[32:35]
    v_mfma_f32_16x16x32_bf16 v[36:39], v[28:31], v[40:43], v[36:39]
    v_dot2_f32_bf16 v44, v20, v40, v44
    v_dot2_f32_bf16 v46, v20, v20, v46
    v_dot2_f32_bf16 v45, v21, v40, v45
    v_dot2_f32_bf16 v47, v21, v21, v47
    v_dot2_f32_bf16 v44, v22, v40, v44
    v_dot2_f32_bf16 v46, v22, v22, v46
    v_dot2_f32_bf16 v45, v23, v40, v45
    v_dot2_f32_bf16 v47, v23, v23, v47
    ds_read_b128 v[20:23], v63 offset:512
    ds_read_b64_tr_b16 v[28:29], v11 offset:14080
    ds_read_b64_tr_b16 v[30:31], v11 offset:14240
    s_waitcnt lgkmcnt(3)
    v_mfma_f32_16x16x32_bf16 v[32:35], v[24:27], v[16:19], v[32:35]
    v_mfma_f32_16x16x32_bf16 v[36:39], v[24:27], v[40:43], v[36:39]
    v_dot2_f32_bf16 v44, v16, v40, v44
    v_dot2_f32_bf16 v46, v16, v16, v46
    v_dot2_f32_bf16 v45, v17, v40, v45
    v_dot2_f32_bf16 v47, v17, v17, v47
    v_dot2_f32_bf16 v44, v18, v40, v44
    v_dot2_f32_bf16 v46, v18, v18, v46
    v_dot2_f32_bf16 v45, v19, v40, v45
    v_dot2_f32_bf16 v47, v19, v19, v47
    ds_read_b128 v[16:19], v60 offset:768
    ds_read_b64_tr_b16 v[24:25], v11 offset:15360
    ds_read_b64_tr_b16 v[26:27], v11 offset:15520
    s_waitcnt lgkmcnt(3)
    v_mfma_f32_16x16x32_bf16 v[32:35], v[28:31], v[20:23], v[32:35]
    v_mfma_f32_16x16x32_bf16 v[36:39], v[28:31], v[40:43], v[36:39]
    v_dot2_f32_bf16 v44, v20, v40, v44
    v_dot2_f32_bf16 v46, v20, v20, v46
    v_dot2_f32_bf16 v45, v21, v40, v45
    v_dot2_f32_bf16 v47, v21, v21, v47
    v_dot2_f32_bf16 v44, v22, v40, v44
    v_dot2_f32_bf16 v46, v22, v22, v46
    v_dot2_f32_bf16 v45, v23, v40, v45
    v_dot2_f32_bf16 v47, v23, v23, v47
    ds_read_b128 v[20:23], v61 offset:768
    ds_read_b64_tr_b16 v[28:29], v11 offset:16640
    ds_read_b64_tr_b16 v[30:31], v11 offset:16800
    s_waitcnt lgkmcnt(3)
    v_mfma_f32_16x16x32_bf16 v[32:35], v[24:27], v[16:19], v[32:35]
    v_mfma_f32_16x16x32_bf16 v[36:39], v[24:27], v[40:43], v[36:39]
    v_dot2_f32_bf16 v44, v16, v40, v44
    v_dot2_f32_bf16 v46, v16, v16, v46
    v_dot2_f32_bf16 v45, v17, v40, v45
    v_dot2_f32_bf16 v47, v17, v17, v47
    v_dot2_f32_bf16 v44, v18, v40, v44
    v_dot2_f32_bf16 v46, v18, v18, v46
    v_dot2_f32_bf16 v45, v19, v40, v45
    v_dot2_f32_bf16 v47, v19, v19, v47
    ds_read_b128 v[16:19], v62 offset:768
    ds_read_b64_tr_b16 v[24:25], v11 offset:17920
    ds_read_b64_tr_b16 v[26:27], v11 offset:18080
    s_waitcnt lgkmcnt(3)
    v_mfma_f32_16x16x32_bf16 v[32:35], v[28:31], v[20:23], v[32:35]
    v_mfma_f32_16x16x32_bf16 v[36:39], v[28:31], v[40:43], v[36:39]
    v_dot2_f32_bf16 v44, v20, v40, v44
    v_dot2_f32_bf16 v46, v20, v20, v46
    v_dot2_f32_bf16 v45, v21, v40, v45
    v_dot2_f32_bf16 v47, v21, v21, v47
    v_dot2_f32_bf16 v44, v22, v40, v44
    v_dot2_f32_bf16 v46, v22, v22, v46
    v_dot2_f32_bf16 v45, v23, v40, v45
    v_dot2_f32_bf16 v47, v23, v23, v47
    ds_read_b128 v[20:23], v63 offset:768
    ds_read_b64_tr_b16 v[28:29], v11 offset:19200
    ds_read_b64_tr_b16 v[30:31], v11 offset:19360
    s_waitcnt lgkmcnt(3)
    v_mfma_f32_16x16x32_bf16 v[32:35], v[24:27], v[16:19], v[32:35]
    v_mfma_f32_16x16x32_bf16 v[36:39], v[24:27], v[40:43], v[36:39]
    v_dot2_f32_bf16 v44, v16, v40, v44
    v_dot2_f32_bf16 v46, v16, v16, v46
    v_dot2_f32_bf16 v45, v17, v40, v45
    v_dot2_f32_bf16 v47, v17, v17, v47
    v_dot2_f32_bf16 v44, v18, v40, v44
    v_dot2_f32_bf16 v46, v18, v18, v46
    v_dot2_f32_bf16 v45, v19, v40, v45
    v_dot2_f32_bf16 v47, v19, v19, v47
    ds_read_b128 v[16:19], v60 offset:1024
    ds_read_b64_tr_b16 v[24:25], v11 offset:20480
    ds_read_b64_tr_b16 v[26:27], v11 offset:20640
    s_waitcnt lgkmcnt(3)
    v_mfma_f32_16x16x32_bf16 v[32:35], v[28:31], v[20:23], v[32:35]
    v_mfma_f32_16x16x32_bf16 v[36:39], v[28:31], v[40:43], v[36:39]
    v_dot2_f32_bf16 v44, v20, v40, v44
    v_dot2_f32_bf16 v46, v20, v20, v46
    v_dot2_f32_bf16 v45, v21, v40, v45
    v_dot2_f32_bf16 v47, v21, v21, v47
    v_dot2_f32_bf16 v44, v22, v40, v44
    v_dot2_f32_bf16 v46, v22, v22, v46
    v_dot2_f32_bf16 v45, v23, v40, v45
    v_dot2_f32_bf16 v47, v23, v23, v47
    ds_read_b128 v[20:23], v61 offset:1024
    ds_read_b64_tr_b16 v[28:29], v11 offset:21760
    ds_read_b64_tr_b16 v[30:31], v11 offset:21920
    s_waitcnt lgkmcnt(3)
    v_mfma_f32_16x16x32_bf16 v[32:35], v[24:27], v[16:19], v[32:35]
    v_mfma_f32_16x16x32_bf16 v[36:39], v[24:27], v[40:43], v[36:39]
    v_dot2_f32_bf16 v44, v16, v40, v44
    v_dot2_f32_bf16 v46, v16, v16, v46
    v_dot2_f32_bf16 v45, v17, v40, v45
    v_dot2_f32_bf16 v47, v17, v17, v47
    v_dot2_f32_bf16 v44, v18, v40, v44
    v_dot2_f32_bf16 v46, v18, v18, v46
    v_dot2_f32_bf16 v45, v19, v40, v45
    v_dot2_f32_bf16 v47, v19, v19, v47
    ds_read_b128 v[16:19], v62 offset:1024
    ds_read_b64_tr_b16 v[24:25], v11 offset:23040
    ds_read_b64_tr_b16 v[26:27], v11 offset:23200
    s_waitcnt lgkmcnt(3)
    v_mfma_f32_16x16x32_bf16 v[32:35], v[28:31], v[20:23], v[32:35]
    v_mfma_f32_16x16x32_bf16 v[36:39], v[28:31], v[40:43], v[36:39]
    v_dot2_f32_bf16 v44, v20, v40, v44
    v_dot2_f32_bf16 v46, v20, v20, v46
    v_dot2_f32_bf16 v45, v21, v40, v45
    v_dot2_f32_bf16 v47, v21, v21, v47
    v_dot2_f32_bf16 v44, v22, v40, v44
    v_dot2_f32_bf16 v46, v22, v22, v46
    v_dot2_f32_bf16 v45, v23, v40, v45
    v_dot2_f32_bf16 v47, v23, v23, v47
    ds_read_b128 v[20:23], v63 offset:1024
    ds_read_b64_tr_b16 v[28:29], v11 offset:24320
    ds_read_b64_tr_b16 v[30:31], v11 offset:24480
    s_waitcnt lgkmcnt(3)
    v_mfma_f32_16x16x32_bf16 v[32:35], v[24:27], v[16:19], v[32:35]
    v_mfma_f32_16x16x32_bf16 v[36:39], v[24:27], v[40:43], v[36:39]
    v_dot2_f32_bf16 v44, v16, v40, v44
    v_dot2_f32_bf16 v46, v16, v16, v46
    v_dot2_f32_bf16 v45, v17, v40, v45
    v_dot2_f32_bf16 v47, v17, v17, v47
    v_dot2_f32_bf16 v44, v18, v40, v44
    v_dot2_f32_bf16 v46, v18, v18, v46
    v_dot2_f32_bf16 v45, v19, v40, v45
    v_dot2_f32_bf16 v47, v19, v19, v47
    s_waitcnt lgkmcnt(0)
    v_mfma_f32_16x16x32_bf16 v[32:35], v[28:31], v[20:23], v[32:35]
    v_mfma_f32_16x16x32_bf16 v[36:39], v[28:31], v[40:43], v[36:39]
    v_dot2_f32_bf16 v44, v20, v40, v44
    v_dot2_f32_bf16 v46, v20, v20, v46
    v_dot2_f32_bf16 v45, v21, v40, v45
    v_dot2_f32_bf16 v47, v21, v21, v47
    v_dot2_f32_bf16 v44, v22, v40, v44
    v_dot2_f32_bf16 v46, v22, v22, v46
    v_dot2_f32_bf16 v45, v23, v40, v45
    v_dot2_f32_bf16 v47, v23, v23, v47
    s_nop 7
    v_add_f32 v44, v44, v45
    v_add_f32 v45, v46, v47
    ds_swizzle_b32 v52, v44 offset:0x401F
    ds_swizzle_b32 v53, v45 offset:0x401F
    s_waitcnt lgkmcnt(0)
    v_add_f32 v44, v44, v52
    v_mov_b32 v52, v44
    v_add_f32 v45, v45, v53
    v_mov_b32 v53, v45
    s_nop 1
    v_permlane32_swap_b32 v52, v44
    v_permlane32_swap_b32 v53, v45
    s_nop 1
    v_add_f32 v44, v44, v52
    v_add_f32 v45, v45, v53
    v_mul_f32 v44, 0x3acccccd, v44
    v_mul_f32 v45, 0x3acccccd, v45
    v_fma_f32 v45, -v44, v44, v45
    v_max_f32 v45, 0, v45
    v_add_f32 v45, 0x3727c5ac, v45
    v_rsq_f32 v45, v45
    s_nop 0
    v_mul_f32 v44, v44, v45
    s_add_u32 s40, s12, 0
    s_addc_u32 s41, s13, 0
    s_mov_b32 s42, 16384
    s_mov_b32 s43, 0x00020000
    s_cmp_eq_u32 s18, 3
    s_cbranch_scc0 kv_kernel_nost
    s_lshl_b32 s46, s17, 7
    v_lshlrev_b32 v14, 3, v3
    s_mov_b64 exec, 0xffff
    buffer_store_dwordx2 v[44:45], v14, s[40:43], s46 offen
    s_mov_b64 exec, -1
kv_kernel_nost:
    v_mul_f32 v32, v32, v45
    v_fma_f32 v32, -v36, v44, v32
    v_mul_f32 v33, v33, v45
    v_fma_f32 v33, -v37, v44, v33
    v_mul_f32 v34, v34, v45
    v_fma_f32 v34, -v38, v44, v34
    v_mul_f32 v35, v35, v45
    v_fma_f32 v35, -v39, v44, v35
    v_cvt_pk_bf16_f32 v32, v32, v33
    v_cvt_pk_bf16_f32 v33, v34, v35
    s_lshr_b32 s44, s17, 1
    s_mul_i32 s44, s44, 2560
    s_and_b32 s45, s17, 1
    s_cmp_ge_u32 s18, 2
    s_cbranch_scc1 kv_kernel_vepi
    v_mov_b32 v15, 0
    s_cmp_eq_u32 s18, 0
    s_cbranch_scc0 kv_kernel_k1
    s_lshl_b32 s46, s45, 8
    s_add_u32 s44, s44, s46
    v_lshrrev_b32 v14, 1, v4
    v_lshlrev_b32 v14, 9, v14
    v_lshl_add_u32 v14, v3, 4, v14
    v_and_b32 v13, 1, v4
    v_lshl_add_u32 v14, v13, 3, v14
    buffer_store_dwordx2 v[32:33], v14, s[36:39], s44 offen
    v_dot2_f32_bf16 v15, v32, v32, v15
    v_dot2_f32_bf16 v15, v33, v33, v15
    s_nop 3
    ds_swizzle_b32 v52, v15 offset:0x401F
    s_waitcnt lgkmcnt(0)
    v_add_f32 v15, v15, v52
    v_mov_b32 v52, v15
    s_nop 1
    v_permlane32_swap_b32 v52, v15
    s_nop 1
    v_add_f32 v15, v15, v52
    s_branch kv_kernel_kmax
kv_kernel_k1:
    s_lshl_b32 s46, s45, 7
    s_add_u32 s44, s44, s46
    v_lshlrev_b32 v14, 3, v3
    s_mov_b64 exec, 0xffff
    buffer_store_dwordx2 v[32:33], v14, s[36:39], s44 offen offset:1024
    v_dot2_f32_bf16 v15, v32, v32, v15
    v_dot2_f32_bf16 v15, v33, v33, v15
    s_add_u32 s40, s12, 30408704
    s_addc_u32 s41, s13, 0
    s_mov_b32 s42, 6912
    s_mov_b32 s43, 0x00020000
    s_mov_b64 exec, -1
    v_mov_b32 v20, -1
    v_mov_b32 v21, -1
    v_mov_b32 v22, -1
    v_mov_b32 v23, -1
    s_lshl_b32 s46, s2, 10
    v_lshlrev_b32 v14, 4, v1
    buffer_store_dwordx4 v[20:23], v14, s[40:43], s46 offen
    s_mov_b64 exec, 0xffff
    s_nop 1
    s_add_u32 s40, s12, 16777216
    s_addc_u32 s41, s13, 0
    s_mov_b32 s42, 32768
    s_mov_b32 s43, 0x00020000
    v_mov_b32 v20, 0
    v_mov_b32 v21, 0
    v_mov_b32 v22, 0
    v_mov_b32 v23, 0
    s_lshl_b32 s46, s17, 8
    v_lshlrev_b32 v14, 4, v3
    buffer_store_dwordx4 v[20:23], v14, s[40:43], s46 offen
    s_mov_b64 exec, -1
kv_kernel_kmax:
    ds_swizzle_b32 v52, v15 offset:0x041F
    s_waitcnt lgkmcnt(0)
    v_max_f32 v15, v15, v52
    ds_swizzle_b32 v52, v15 offset:0x081F
    s_waitcnt lgkmcnt(0)
    v_max_f32 v15, v15, v52
    ds_swizzle_b32 v52, v15 offset:0x101F
    s_waitcnt lgkmcnt(0)
    v_max_f32 v15, v15, v52
    ds_swizzle_b32 v52, v15 offset:0x201F
    s_waitcnt lgkmcnt(0)
    v_max_f32 v15, v15, v52
    s_add_u32 s40, s12, 17825792
    s_addc_u32 s41, s13, 0
    s_mov_b32 s42, 1024
    s_mov_b32 s43, 0x00020000
    s_lshl_b32 s44, s18, 7
    s_add_u32 s44, s44, s17
    s_lshl_b32 s44, s44, 2
    v_mov_b32 v14, 0
    s_mov_b64 exec, 1
    buffer_store_dword v15, v14, s[40:43], s44 offen
    s_mov_b64 exec, -1
    s_branch kv_kernel_end
kv_kernel_vepi:
    s_mul_i32 s46, s45, 640
    s_add_u32 s44, s44, s46
    v_bfe_u32 v14, v3, 2, 1
    v_mul_u32_u24 v12, 320, v14
    v_bfe_u32 v14, v3, 3, 1
    v_lshl_add_u32 v12, v14, 3, v12
    v_and_b32 v14, 3, v3
    v_lshl_add_u32 v12, v14, 1, v12
    v_lshl_add_u32 v14, v4, 6, v12
    s_cmp_eq_u32 s18, 2
    s_cbranch_scc1 kv_kernel_v0
    v_add_u32 v14, 256, v12
    s_mov_b64 exec, 0xffff
kv_kernel_v0:
    buffer_store_short v32, v14, s[36:39], s44 offen offset:1280
    buffer_store_short_d16_hi v32, v14, s[36:39], s44 offen offset:1296
    buffer_store_short v33, v14, s[36:39], s44 offen offset:1312
    buffer_store_short_d16_hi v33, v14, s[36:39], s44 offen offset:1328
    s_mov_b64 exec, -1
    s_cmp_eq_u32 s18, 3
    s_cbranch_scc0 kv_kernel_end
    s_cmp_eq_u32 s2, 0
    s_cbranch_scc0 kv_kernel_end
    s_mov_b32 s40, s14
    s_mov_b32 s41, s15
    s_mov_b32 s42, 1280
    s_mov_b32 s43, 0x00020000
    v_mul_u32_u24 v8, 20, v1
    buffer_load_dwordx4 v[20:23], v8, s[40:43], 0 offen
    buffer_load_dword v24, v8, s[40:43], 0 offen offset:16
    v_mov_b32 v17, 0
    s_waitcnt vmcnt(0)
    v_dot2_f32_bf16 v17, v20, v40, v17
    v_dot2_f32_bf16 v17, v21, v40, v17
    v_dot2_f32_bf16 v17, v22, v40, v17
    v_dot2_f32_bf16 v17, v23, v40, v17
    v_dot2_f32_bf16 v17, v24, v40, v17
    s_nop 3
    ds_swizzle_b32 v18, v17 offset:0x041F
    s_waitcnt lgkmcnt(0)
    v_add_f32 v17, v17, v18
    ds_swizzle_b32 v18, v17 offset:0x081F
    s_waitcnt lgkmcnt(0)
    v_add_f32 v17, v17, v18
    ds_swizzle_b32 v18, v17 offset:0x101F
    s_waitcnt lgkmcnt(0)
    v_add_f32 v17, v17, v18
    ds_swizzle_b32 v18, v17 offset:0x201F
    s_waitcnt lgkmcnt(0)
    v_add_f32 v17, v17, v18
    ds_swizzle_b32 v18, v17 offset:0x401F
    s_waitcnt lgkmcnt(0)
    v_add_f32 v17, v17, v18
    v_mov_b32 v18, v17
    s_nop 1
    v_permlane32_swap_b32 v18, v17
    s_nop 1
    v_add_f32 v17, v17, v18
    s_add_u32 s40, s12, 19922944
    s_addc_u32 s41, s13, 0
    s_mov_b32 s42, 64
    s_mov_b32 s43, 0x00020000
    v_mov_b32 v14, 0
    s_mov_b64 exec, 1
    buffer_store_dword v17, v14, s[40:43], 0 offen offset:32
    s_mov_b64 exec, -1
    s_branch kv_kernel_end
kv_kernel_cpy:
    s_load_dwordx2 s[12:13], s[0:1], 96
    s_sub_u32 s16, s2, 128
    s_mov_b32 s46, 0x12F684C
    s_mov_b32 s47, 0x3333334
    s_mov_b32 s48, 0x1999999A
    v_mov_b32 v14, 0x7fffffff
kv_kernel_j0:
    s_cmp_ge_u32 s16, 25
    s_cbranch_scc1 kv_kernel_j1
    s_load_dwordx2 s[4:5], s[0:1], 8
    s_sub_u32 s17, s16, 0
    s_lshl_b32 s17, s17, 11
    v_add_u32 v1, s17, v0
    s_waitcnt lgkmcnt(0)
    s_mov_b32 s20, s4
    s_mov_b32 s21, s5
    s_mov_b32 s22, 819200
    s_mov_b32 s23, 0x00020000
    s_add_u32 s24, s12, 31457280
    s_addc_u32 s25, s13, 0
    s_mov_b32 s26, 819200
    s_mov_b32 s27, 0x00020000
    v_add_u32 v2, 0, v1
    v_lshlrev_b32 v10, 4, v2
    buffer_load_dwordx4 v[16:19], v10, s[20:23], 0 offen
    v_add_u32 v3, 256, v1
    v_lshlrev_b32 v10, 4, v3
    buffer_load_dwordx4 v[20:23], v10, s[20:23], 0 offen
    v_add_u32 v4, 512, v1
    v_lshlrev_b32 v10, 4, v4
    buffer_load_dwordx4 v[24:27], v10, s[20:23], 0 offen
    v_add_u32 v5, 768, v1
    v_lshlrev_b32 v10, 4, v5
    buffer_load_dwordx4 v[28:31], v10, s[20:23], 0 offen
    v_add_u32 v6, 1024, v1
    v_lshlrev_b32 v10, 4, v6
    buffer_load_dwordx4 v[32:35], v10, s[20:23], 0 offen
    v_add_u32 v7, 1280, v1
    v_lshlrev_b32 v10, 4, v7
    buffer_load_dwordx4 v[36:39], v10, s[20:23], 0 offen
    v_add_u32 v8, 1536, v1
    v_lshlrev_b32 v10, 4, v8
    buffer_load_dwordx4 v[40:43], v10, s[20:23], 0 offen
    v_add_u32 v9, 1792, v1
    v_lshlrev_b32 v10, 4, v9
    buffer_load_dwordx4 v[44:47], v10, s[20:23], 0 offen
    v_mul_hi_u32 v10, v2, s47
    v_mul_u32_u24 v11, 80, v10
    v_sub_u32 v11, v2, v11
    v_mul_hi_u32 v12, v11, s48
    v_mul_u32_u24 v13, 10, v12
    v_sub_u32 v13, v11, v13
    v_mul_u32_u24 v12, 102400, v12
    v_mul_u32_u24 v10, 160, v10
    v_add_u32 v12, v12, v10
    v_lshl_add_u32 v12, v13, 4, v12
    v_cmp_gt_u32 vcc, 51200, v2
    s_nop 1
    v_cndmask_b32 v2, v14, v12, vcc
    v_mul_hi_u32 v10, v3, s47
    v_mul_u32_u24 v11, 80, v10
    v_sub_u32 v11, v3, v11
    v_mul_hi_u32 v12, v11, s48
    v_mul_u32_u24 v13, 10, v12
    v_sub_u32 v13, v11, v13
    v_mul_u32_u24 v12, 102400, v12
    v_mul_u32_u24 v10, 160, v10
    v_add_u32 v12, v12, v10
    v_lshl_add_u32 v12, v13, 4, v12
    v_cmp_gt_u32 vcc, 51200, v3
    s_nop 1
    v_cndmask_b32 v3, v14, v12, vcc
    v_mul_hi_u32 v10, v4, s47
    v_mul_u32_u24 v11, 80, v10
    v_sub_u32 v11, v4, v11
    v_mul_hi_u32 v12, v11, s48
    v_mul_u32_u24 v13, 10, v12
    v_sub_u32 v13, v11, v13
    v_mul_u32_u24 v12, 102400, v12
    v_mul_u32_u24 v10, 160, v10
    v_add_u32 v12, v12, v10
    v_lshl_add_u32 v12, v13, 4, v12
    v_cmp_gt_u32 vcc, 51200, v4
    s_nop 1
    v_cndmask_b32 v4, v14, v12, vcc
    v_mul_hi_u32 v10, v5, s47
    v_mul_u32_u24 v11, 80, v10
    v_sub_u32 v11, v5, v11
    v_mul_hi_u32 v12, v11, s48
    v_mul_u32_u24 v13, 10, v12
    v_sub_u32 v13, v11, v13
    v_mul_u32_u24 v12, 102400, v12
    v_mul_u32_u24 v10, 160, v10
    v_add_u32 v12, v12, v10
    v_lshl_add_u32 v12, v13, 4, v12
    v_cmp_gt_u32 vcc, 51200, v5
    s_nop 1
    v_cndmask_b32 v5, v14, v12, vcc
    v_mul_hi_u32 v10, v6, s47
    v_mul_u32_u24 v11, 80, v10
    v_sub_u32 v11, v6, v11
    v_mul_hi_u32 v12, v11, s48
    v_mul_u32_u24 v13, 10, v12
    v_sub_u32 v13, v11, v13
    v_mul_u32_u24 v12, 102400, v12
    v_mul_u32_u24 v10, 160, v10
    v_add_u32 v12, v12, v10
    v_lshl_add_u32 v12, v13, 4, v12
    v_cmp_gt_u32 vcc, 51200, v6
    s_nop 1
    v_cndmask_b32 v6, v14, v12, vcc
    v_mul_hi_u32 v10, v7, s47
    v_mul_u32_u24 v11, 80, v10
    v_sub_u32 v11, v7, v11
    v_mul_hi_u32 v12, v11, s48
    v_mul_u32_u24 v13, 10, v12
    v_sub_u32 v13, v11, v13
    v_mul_u32_u24 v12, 102400, v12
    v_mul_u32_u24 v10, 160, v10
    v_add_u32 v12, v12, v10
    v_lshl_add_u32 v12, v13, 4, v12
    v_cmp_gt_u32 vcc, 51200, v7
    s_nop 1
    v_cndmask_b32 v7, v14, v12, vcc
    v_mul_hi_u32 v10, v8, s47
    v_mul_u32_u24 v11, 80, v10
    v_sub_u32 v11, v8, v11
    v_mul_hi_u32 v12, v11, s48
    v_mul_u32_u24 v13, 10, v12
    v_sub_u32 v13, v11, v13
    v_mul_u32_u24 v12, 102400, v12
    v_mul_u32_u24 v10, 160, v10
    v_add_u32 v12, v12, v10
    v_lshl_add_u32 v12, v13, 4, v12
    v_cmp_gt_u32 vcc, 51200, v8
    s_nop 1
    v_cndmask_b32 v8, v14, v12, vcc
    v_mul_hi_u32 v10, v9, s47
    v_mul_u32_u24 v11, 80, v10
    v_sub_u32 v11, v9, v11
    v_mul_hi_u32 v12, v11, s48
    v_mul_u32_u24 v13, 10, v12
    v_sub_u32 v13, v11, v13
    v_mul_u32_u24 v12, 102400, v12
    v_mul_u32_u24 v10, 160, v10
    v_add_u32 v12, v12, v10
    v_lshl_add_u32 v12, v13, 4, v12
    v_cmp_gt_u32 vcc, 51200, v9
    s_nop 1
    v_cndmask_b32 v9, v14, v12, vcc
    s_waitcnt vmcnt(7)
    buffer_store_dwordx4 v[16:19], v2, s[24:27], 0 offen
    s_waitcnt vmcnt(6)
    buffer_store_dwordx4 v[20:23], v3, s[24:27], 0 offen
    s_waitcnt vmcnt(5)
    buffer_store_dwordx4 v[24:27], v4, s[24:27], 0 offen
    s_waitcnt vmcnt(4)
    buffer_store_dwordx4 v[28:31], v5, s[24:27], 0 offen
    s_waitcnt vmcnt(3)
    buffer_store_dwordx4 v[32:35], v6, s[24:27], 0 offen
    s_waitcnt vmcnt(2)
    buffer_store_dwordx4 v[36:39], v7, s[24:27], 0 offen
    s_waitcnt vmcnt(1)
    buffer_store_dwordx4 v[40:43], v8, s[24:27], 0 offen
    s_waitcnt vmcnt(0)
    buffer_store_dwordx4 v[44:47], v9, s[24:27], 0 offen
    s_endpgm
kv_kernel_j1:
    s_cmp_ge_u32 s16, 50
    s_cbranch_scc1 kv_kernel_j2
    s_load_dwordx2 s[4:5], s[0:1], 32
    s_sub_u32 s17, s16, 25
    s_lshl_b32 s17, s17, 11
    v_add_u32 v1, s17, v0
    s_waitcnt lgkmcnt(0)
    s_mov_b32 s20, s4
    s_mov_b32 s21, s5
    s_mov_b32 s22, 819200
    s_mov_b32 s23, 0x00020000
    s_add_u32 s24, s12, 26214400
    s_addc_u32 s25, s13, 0
    s_mov_b32 s26, 819200
    s_mov_b32 s27, 0x00020000
    v_add_u32 v2, 0, v1
    v_lshlrev_b32 v10, 4, v2
    buffer_load_dwordx4 v[16:19], v10, s[20:23], 0 offen
    v_add_u32 v3, 256, v1
    v_lshlrev_b32 v10, 4, v3
    buffer_load_dwordx4 v[20:23], v10, s[20:23], 0 offen
    v_add_u32 v4, 512, v1
    v_lshlrev_b32 v10, 4, v4
    buffer_load_dwordx4 v[24:27], v10, s[20:23], 0 offen
    v_add_u32 v5, 768, v1
    v_lshlrev_b32 v10, 4, v5
    buffer_load_dwordx4 v[28:31], v10, s[20:23], 0 offen
    v_add_u32 v6, 1024, v1
    v_lshlrev_b32 v10, 4, v6
    buffer_load_dwordx4 v[32:35], v10, s[20:23], 0 offen
    v_add_u32 v7, 1280, v1
    v_lshlrev_b32 v10, 4, v7
    buffer_load_dwordx4 v[36:39], v10, s[20:23], 0 offen
    v_add_u32 v8, 1536, v1
    v_lshlrev_b32 v10, 4, v8
    buffer_load_dwordx4 v[40:43], v10, s[20:23], 0 offen
    v_add_u32 v9, 1792, v1
    v_lshlrev_b32 v10, 4, v9
    buffer_load_dwordx4 v[44:47], v10, s[20:23], 0 offen
    v_mul_hi_u32 v10, v2, s47
    v_mul_u32_u24 v11, 80, v10
    v_sub_u32 v11, v2, v11
    v_mul_hi_u32 v12, v11, s48
    v_mul_u32_u24 v13, 10, v12
    v_sub_u32 v13, v11, v13
    v_mul_u32_u24 v12, 102400, v12
    v_mul_u32_u24 v10, 160, v10
    v_add_u32 v12, v12, v10
    v_lshl_add_u32 v12, v13, 4, v12
    v_cmp_gt_u32 vcc, 51200, v2
    s_nop 1
    v_cndmask_b32 v2, v14, v12, vcc
    v_mul_hi_u32 v10, v3, s47
    v_mul_u32_u24 v11, 80, v10
    v_sub_u32 v11, v3, v11
    v_mul_hi_u32 v12, v11, s48
    v_mul_u32_u24 v13, 10, v12
    v_sub_u32 v13, v11, v13
    v_mul_u32_u24 v12, 102400, v12
    v_mul_u32_u24 v10, 160, v10
    v_add_u32 v12, v12, v10
    v_lshl_add_u32 v12, v13, 4, v12
    v_cmp_gt_u32 vcc, 51200, v3
    s_nop 1
    v_cndmask_b32 v3, v14, v12, vcc
    v_mul_hi_u32 v10, v4, s47
    v_mul_u32_u24 v11, 80, v10
    v_sub_u32 v11, v4, v11
    v_mul_hi_u32 v12, v11, s48
    v_mul_u32_u24 v13, 10, v12
    v_sub_u32 v13, v11, v13
    v_mul_u32_u24 v12, 102400, v12
    v_mul_u32_u24 v10, 160, v10
    v_add_u32 v12, v12, v10
    v_lshl_add_u32 v12, v13, 4, v12
    v_cmp_gt_u32 vcc, 51200, v4
    s_nop 1
    v_cndmask_b32 v4, v14, v12, vcc
    v_mul_hi_u32 v10, v5, s47
    v_mul_u32_u24 v11, 80, v10
    v_sub_u32 v11, v5, v11
    v_mul_hi_u32 v12, v11, s48
    v_mul_u32_u24 v13, 10, v12
    v_sub_u32 v13, v11, v13
    v_mul_u32_u24 v12, 102400, v12
    v_mul_u32_u24 v10, 160, v10
    v_add_u32 v12, v12, v10
    v_lshl_add_u32 v12, v13, 4, v12
    v_cmp_gt_u32 vcc, 51200, v5
    s_nop 1
    v_cndmask_b32 v5, v14, v12, vcc
    v_mul_hi_u32 v10, v6, s47
    v_mul_u32_u24 v11, 80, v10
    v_sub_u32 v11, v6, v11
    v_mul_hi_u32 v12, v11, s48
    v_mul_u32_u24 v13, 10, v12
    v_sub_u32 v13, v11, v13
    v_mul_u32_u24 v12, 102400, v12
    v_mul_u32_u24 v10, 160, v10
    v_add_u32 v12, v12, v10
    v_lshl_add_u32 v12, v13, 4, v12
    v_cmp_gt_u32 vcc, 51200, v6
    s_nop 1
    v_cndmask_b32 v6, v14, v12, vcc
    v_mul_hi_u32 v10, v7, s47
    v_mul_u32_u24 v11, 80, v10
    v_sub_u32 v11, v7, v11
    v_mul_hi_u32 v12, v11, s48
    v_mul_u32_u24 v13, 10, v12
    v_sub_u32 v13, v11, v13
    v_mul_u32_u24 v12, 102400, v12
    v_mul_u32_u24 v10, 160, v10
    v_add_u32 v12, v12, v10
    v_lshl_add_u32 v12, v13, 4, v12
    v_cmp_gt_u32 vcc, 51200, v7
    s_nop 1
    v_cndmask_b32 v7, v14, v12, vcc
    v_mul_hi_u32 v10, v8, s47
    v_mul_u32_u24 v11, 80, v10
    v_sub_u32 v11, v8, v11
    v_mul_hi_u32 v12, v11, s48
    v_mul_u32_u24 v13, 10, v12
    v_sub_u32 v13, v11, v13
    v_mul_u32_u24 v12, 102400, v12
    v_mul_u32_u24 v10, 160, v10
    v_add_u32 v12, v12, v10
    v_lshl_add_u32 v12, v13, 4, v12
    v_cmp_gt_u32 vcc, 51200, v8
    s_nop 1
    v_cndmask_b32 v8, v14, v12, vcc
    v_mul_hi_u32 v10, v9, s47
    v_mul_u32_u24 v11, 80, v10
    v_sub_u32 v11, v9, v11
    v_mul_hi_u32 v12, v11, s48
    v_mul_u32_u24 v13, 10, v12
    v_sub_u32 v13, v11, v13
    v_mul_u32_u24 v12, 102400, v12
    v_mul_u32_u24 v10, 160, v10
    v_add_u32 v12, v12, v10
    v_lshl_add_u32 v12, v13, 4, v12
    v_cmp_gt_u32 vcc, 51200, v9
    s_nop 1
    v_cndmask_b32 v9, v14, v12, vcc
    s_waitcnt vmcnt(7)
    buffer_store_dwordx4 v[16:19], v2, s[24:27], 0 offen
    s_waitcnt vmcnt(6)
    buffer_store_dwordx4 v[20:23], v3, s[24:27], 0 offen
    s_waitcnt vmcnt(5)
    buffer_store_dwordx4 v[24:27], v4, s[24:27], 0 offen
    s_waitcnt vmcnt(4)
    buffer_store_dwordx4 v[28:31], v5, s[24:27], 0 offen
    s_waitcnt vmcnt(3)
    buffer_store_dwordx4 v[32:35], v6, s[24:27], 0 offen
    s_waitcnt vmcnt(2)
    buffer_store_dwordx4 v[36:39], v7, s[24:27], 0 offen
    s_waitcnt vmcnt(1)
    buffer_store_dwordx4 v[40:43], v8, s[24:27], 0 offen
    s_waitcnt vmcnt(0)
    buffer_store_dwordx4 v[44:47], v9, s[24:27], 0 offen
    s_endpgm
kv_kernel_j2:
    s_cmp_ge_u32 s16, 120
    s_cbranch_scc1 kv_kernel_j3
    s_load_dwordx2 s[4:5], s[0:1], 56
    v_and_b32 v1, 63, v0
    v_lshrrev_b32 v2, 6, v0
    v_lshrrev_b32 v3, 4, v1
    v_bfe_u32 v4, v1, 1, 3
    v_and_b32 v5, 1, v1
    v_readfirstlane_b32 s18, v2
    v_mul_u32_u24 v6, 3456, v3
    v_lshl_add_u32 v6, v4, 5, v6
    v_lshl_add_u32 v6, v5, 4, v6
    v_mul_u32_u24 v7, 40960, v4
    v_lshl_add_u32 v7, v3, 5, v7
    v_lshl_add_u32 v7, v5, 4, v7
    s_sub_u32 s17, s16, 50
    s_lshl_b32 s17, s17, 5
    s_lshl_b32 s18, s18, 3
    s_add_u32 s17, s17, s18
    s_mov_b32 s19, 306783379
    s_waitcnt lgkmcnt(0)
    s_mov_b32 s20, s4
    s_mov_b32 s21, s5
    s_mov_b32 s22, 2211840
    s_mov_b32 s23, 0x00020000
    s_add_u32 s24, s12, 20971520
    s_addc_u32 s25, s13, 0
    s_mov_b32 s26, 4423680
    s_mov_b32 s27, 0x00020000
    s_add_u32 s30, s17, 0
    s_mul_hi_u32 s31, s30, s19
    s_mul_i32 s32, s31, 14
    s_sub_u32 s32, s30, s32
    s_mul_i32 s33, s31, 13824
    s_lshl_b32 s34, s32, 8
    s_add_u32 s33, s33, s34
    s_mul_i32 s40, s32, 327680
    s_lshl_b32 s34, s31, 7
    s_add_u32 s40, s40, s34
    s_cmp_lt_u32 s30, 2240
    s_cselect_b32 s40, s40, 0x40000000
    buffer_load_dwordx4 v[16:19], v6, s[20:23], s33 offen
    s_add_u32 s30, s17, 1
    s_mul_hi_u32 s31, s30, s19
    s_mul_i32 s32, s31, 14
    s_sub_u32 s32, s30, s32
    s_mul_i32 s33, s31, 13824
    s_lshl_b32 s34, s32, 8
    s_add_u32 s33, s33, s34
    s_mul_i32 s41, s32, 327680
    s_lshl_b32 s34, s31, 7
    s_add_u32 s41, s41, s34
    s_cmp_lt_u32 s30, 2240
    s_cselect_b32 s41, s41, 0x40000000
    buffer_load_dwordx4 v[20:23], v6, s[20:23], s33 offen
    s_add_u32 s30, s17, 2
    s_mul_hi_u32 s31, s30, s19
    s_mul_i32 s32, s31, 14
    s_sub_u32 s32, s30, s32
    s_mul_i32 s33, s31, 13824
    s_lshl_b32 s34, s32, 8
    s_add_u32 s33, s33, s34
    s_mul_i32 s42, s32, 327680
    s_lshl_b32 s34, s31, 7
    s_add_u32 s42, s42, s34
    s_cmp_lt_u32 s30, 2240
    s_cselect_b32 s42, s42, 0x40000000
    buffer_load_dwordx4 v[24:27], v6, s[20:23], s33 offen
    s_add_u32 s30, s17, 3
    s_mul_hi_u32 s31, s30, s19
    s_mul_i32 s32, s31, 14
    s_sub_u32 s32, s30, s32
    s_mul_i32 s33, s31, 13824
    s_lshl_b32 s34, s32, 8
    s_add_u32 s33, s33, s34
    s_mul_i32 s43, s32, 327680
    s_lshl_b32 s34, s31, 7
    s_add_u32 s43, s43, s34
    s_cmp_lt_u32 s30, 2240
    s_cselect_b32 s43, s43, 0x40000000
    buffer_load_dwordx4 v[28:31], v6, s[20:23], s33 offen
    s_add_u32 s30, s17, 4
    s_mul_hi_u32 s31, s30, s19
    s_mul_i32 s32, s31, 14
    s_sub_u32 s32, s30, s32
    s_mul_i32 s33, s31, 13824
    s_lshl_b32 s34, s32, 8
    s_add_u32 s33, s33, s34
    s_mul_i32 s44, s32, 327680
    s_lshl_b32 s34, s31, 7
    s_add_u32 s44, s44, s34
    s_cmp_lt_u32 s30, 2240
    s_cselect_b32 s44, s44, 0x40000000
    buffer_load_dwordx4 v[32:35], v6, s[20:23], s33 offen
    s_add_u32 s30, s17, 5
    s_mul_hi_u32 s31, s30, s19
    s_mul_i32 s32, s31, 14
    s_sub_u32 s32, s30, s32
    s_mul_i32 s33, s31, 13824
    s_lshl_b32 s34, s32, 8
    s_add_u32 s33, s33, s34
    s_mul_i32 s45, s32, 327680
    s_lshl_b32 s34, s31, 7
    s_add_u32 s45, s45, s34
    s_cmp_lt_u32 s30, 2240
    s_cselect_b32 s45, s45, 0x40000000
    buffer_load_dwordx4 v[36:39], v6, s[20:23], s33 offen
    s_add_u32 s30, s17, 6
    s_mul_hi_u32 s31, s30, s19
    s_mul_i32 s32, s31, 14
    s_sub_u32 s32, s30, s32
    s_mul_i32 s33, s31, 13824
    s_lshl_b32 s34, s32, 8
    s_add_u32 s33, s33, s34
    s_mul_i32 s46, s32, 327680
    s_lshl_b32 s34, s31, 7
    s_add_u32 s46, s46, s34
    s_cmp_lt_u32 s30, 2240
    s_cselect_b32 s46, s46, 0x40000000
    buffer_load_dwordx4 v[40:43], v6, s[20:23], s33 offen
    s_add_u32 s30, s17, 7
    s_mul_hi_u32 s31, s30, s19
    s_mul_i32 s32, s31, 14
    s_sub_u32 s32, s30, s32
    s_mul_i32 s33, s31, 13824
    s_lshl_b32 s34, s32, 8
    s_add_u32 s33, s33, s34
    s_mul_i32 s47, s32, 327680
    s_lshl_b32 s34, s31, 7
    s_add_u32 s47, s47, s34
    s_cmp_lt_u32 s30, 2240
    s_cselect_b32 s47, s47, 0x40000000
    buffer_load_dwordx4 v[44:47], v6, s[20:23], s33 offen
    s_waitcnt vmcnt(7)
    buffer_store_dwordx4 v[16:19], v7, s[24:27], s40 offen
    s_waitcnt vmcnt(6)
    buffer_store_dwordx4 v[20:23], v7, s[24:27], s41 offen
    s_waitcnt vmcnt(5)
    buffer_store_dwordx4 v[24:27], v7, s[24:27], s42 offen
    s_waitcnt vmcnt(4)
    buffer_store_dwordx4 v[28:31], v7, s[24:27], s43 offen
    s_waitcnt vmcnt(3)
    buffer_store_dwordx4 v[32:35], v7, s[24:27], s44 offen
    s_waitcnt vmcnt(2)
    buffer_store_dwordx4 v[36:39], v7, s[24:27], s45 offen
    s_waitcnt vmcnt(1)
    buffer_store_dwordx4 v[40:43], v7, s[24:27], s46 offen
    s_waitcnt vmcnt(0)
    buffer_store_dwordx4 v[44:47], v7, s[24:27], s47 offen
    s_endpgm
kv_kernel_j3:
    s_cmp_ge_u32 s16, 190
    s_cbranch_scc1 kv_kernel_j4
    s_load_dwordx2 s[4:5], s[0:1], 64
    v_and_b32 v1, 63, v0
    v_lshrrev_b32 v2, 6, v0
    v_lshrrev_b32 v3, 4, v1
    v_bfe_u32 v4, v1, 1, 3
    v_and_b32 v5, 1, v1
    v_readfirstlane_b32 s18, v2
    v_mul_u32_u24 v6, 3456, v3
    v_lshl_add_u32 v6, v4, 5, v6
    v_lshl_add_u32 v6, v5, 4, v6
    v_mul_u32_u24 v7, 40960, v4
    v_lshl_add_u32 v7, v3, 5, v7
    v_lshl_add_u32 v7, v5, 4, v7
    s_sub_u32 s17, s16, 120
    s_lshl_b32 s17, s17, 5
    s_lshl_b32 s18, s18, 3
    s_add_u32 s17, s17, s18
    s_mov_b32 s19, 306783379
    s_waitcnt lgkmcnt(0)
    s_mov_b32 s20, s4
    s_mov_b32 s21, s5
    s_mov_b32 s22, 2211840
    s_mov_b32 s23, 0x00020000
    s_add_u32 s24, s12, 20992000
    s_addc_u32 s25, s13, 0
    s_mov_b32 s26, 4403200
    s_mov_b32 s27, 0x00020000
    s_add_u32 s30, s17, 0
    s_mul_hi_u32 s31, s30, s19
    s_mul_i32 s32, s31, 14
    s_sub_u32 s32, s30, s32
    s_mul_i32 s33, s31, 13824
    s_lshl_b32 s34, s32, 8
    s_add_u32 s33, s33, s34
    s_mul_i32 s40, s32, 327680
    s_lshl_b32 s34, s31, 7
    s_add_u32 s40, s40, s34
    s_cmp_lt_u32 s30, 2240
    s_cselect_b32 s40, s40, 0x40000000
    buffer_load_dwordx4 v[16:19], v6, s[20:23], s33 offen
    s_add_u32 s30, s17, 1
    s_mul_hi_u32 s31, s30, s19
    s_mul_i32 s32, s31, 14
    s_sub_u32 s32, s30, s32
    s_mul_i32 s33, s31, 13824
    s_lshl_b32 s34, s32, 8
    s_add_u32 s33, s33, s34
    s_mul_i32 s41, s32, 327680
    s_lshl_b32 s34, s31, 7
    s_add_u32 s41, s41, s34
    s_cmp_lt_u32 s30, 2240
    s_cselect_b32 s41, s41, 0x40000000
    buffer_load_dwordx4 v[20:23], v6, s[20:23], s33 offen
    s_add_u32 s30, s17, 2
    s_mul_hi_u32 s31, s30, s19
    s_mul_i32 s32, s31, 14
    s_sub_u32 s32, s30, s32
    s_mul_i32 s33, s31, 13824
    s_lshl_b32 s34, s32, 8
    s_add_u32 s33, s33, s34
    s_mul_i32 s42, s32, 327680
    s_lshl_b32 s34, s31, 7
    s_add_u32 s42, s42, s34
    s_cmp_lt_u32 s30, 2240
    s_cselect_b32 s42, s42, 0x40000000
    buffer_load_dwordx4 v[24:27], v6, s[20:23], s33 offen
    s_add_u32 s30, s17, 3
    s_mul_hi_u32 s31, s30, s19
    s_mul_i32 s32, s31, 14
    s_sub_u32 s32, s30, s32
    s_mul_i32 s33, s31, 13824
    s_lshl_b32 s34, s32, 8
    s_add_u32 s33, s33, s34
    s_mul_i32 s43, s32, 327680
    s_lshl_b32 s34, s31, 7
    s_add_u32 s43, s43, s34
    s_cmp_lt_u32 s30, 2240
    s_cselect_b32 s43, s43, 0x40000000
    buffer_load_dwordx4 v[28:31], v6, s[20:23], s33 offen
    s_add_u32 s30, s17, 4
    s_mul_hi_u32 s31, s30, s19
    s_mul_i32 s32, s31, 14
    s_sub_u32 s32, s30, s32
    s_mul_i32 s33, s31, 13824
    s_lshl_b32 s34, s32, 8
    s_add_u32 s33, s33, s34
    s_mul_i32 s44, s32, 327680
    s_lshl_b32 s34, s31, 7
    s_add_u32 s44, s44, s34
    s_cmp_lt_u32 s30, 2240
    s_cselect_b32 s44, s44, 0x40000000
    buffer_load_dwordx4 v[32:35], v6, s[20:23], s33 offen
    s_add_u32 s30, s17, 5
    s_mul_hi_u32 s31, s30, s19
    s_mul_i32 s32, s31, 14
    s_sub_u32 s32, s30, s32
    s_mul_i32 s33, s31, 13824
    s_lshl_b32 s34, s32, 8
    s_add_u32 s33, s33, s34
    s_mul_i32 s45, s32, 327680
    s_lshl_b32 s34, s31, 7
    s_add_u32 s45, s45, s34
    s_cmp_lt_u32 s30, 2240
    s_cselect_b32 s45, s45, 0x40000000
    buffer_load_dwordx4 v[36:39], v6, s[20:23], s33 offen
    s_add_u32 s30, s17, 6
    s_mul_hi_u32 s31, s30, s19
    s_mul_i32 s32, s31, 14
    s_sub_u32 s32, s30, s32
    s_mul_i32 s33, s31, 13824
    s_lshl_b32 s34, s32, 8
    s_add_u32 s33, s33, s34
    s_mul_i32 s46, s32, 327680
    s_lshl_b32 s34, s31, 7
    s_add_u32 s46, s46, s34
    s_cmp_lt_u32 s30, 2240
    s_cselect_b32 s46, s46, 0x40000000
    buffer_load_dwordx4 v[40:43], v6, s[20:23], s33 offen
    s_add_u32 s30, s17, 7
    s_mul_hi_u32 s31, s30, s19
    s_mul_i32 s32, s31, 14
    s_sub_u32 s32, s30, s32
    s_mul_i32 s33, s31, 13824
    s_lshl_b32 s34, s32, 8
    s_add_u32 s33, s33, s34
    s_mul_i32 s47, s32, 327680
    s_lshl_b32 s34, s31, 7
    s_add_u32 s47, s47, s34
    s_cmp_lt_u32 s30, 2240
    s_cselect_b32 s47, s47, 0x40000000
    buffer_load_dwordx4 v[44:47], v6, s[20:23], s33 offen
    s_waitcnt vmcnt(7)
    buffer_store_dwordx4 v[16:19], v7, s[24:27], s40 offen
    s_waitcnt vmcnt(6)
    buffer_store_dwordx4 v[20:23], v7, s[24:27], s41 offen
    s_waitcnt vmcnt(5)
    buffer_store_dwordx4 v[24:27], v7, s[24:27], s42 offen
    s_waitcnt vmcnt(4)
    buffer_store_dwordx4 v[28:31], v7, s[24:27], s43 offen
    s_waitcnt vmcnt(3)
    buffer_store_dwordx4 v[32:35], v7, s[24:27], s44 offen
    s_waitcnt vmcnt(2)
    buffer_store_dwordx4 v[36:39], v7, s[24:27], s45 offen
    s_waitcnt vmcnt(1)
    buffer_store_dwordx4 v[40:43], v7, s[24:27], s46 offen
    s_waitcnt vmcnt(0)
    buffer_store_dwordx4 v[44:47], v7, s[24:27], s47 offen
    s_endpgm
kv_kernel_j4:
    s_load_dwordx2 s[4:5], s[0:1], 72
    v_and_b32 v1, 63, v0
    v_lshrrev_b32 v2, 6, v0
    v_lshrrev_b32 v3, 4, v1
    v_bfe_u32 v4, v1, 1, 3
    v_and_b32 v5, 1, v1
    v_readfirstlane_b32 s18, v2
    v_mul_u32_u24 v6, 1280, v3
    v_lshl_add_u32 v6, v4, 5, v6
    v_lshl_add_u32 v6, v5, 4, v6
    v_mul_u32_u24 v7, 55296, v4
    v_lshl_add_u32 v7, v3, 5, v7
    v_lshl_add_u32 v7, v5, 4, v7
    s_sub_u32 s17, s16, 190
    s_lshl_b32 s17, s17, 5
    s_lshl_b32 s18, s18, 3
    s_add_u32 s17, s17, s18
    s_mov_b32 s19, 858993460
    s_waitcnt lgkmcnt(0)
    s_mov_b32 s20, s4
    s_mov_b32 s21, s5
    s_mov_b32 s22, 2211840
    s_mov_b32 s23, 0x00020000
    s_add_u32 s24, s12, 27262976
    s_addc_u32 s25, s13, 0
    s_mov_b32 s26, 2211840
    s_mov_b32 s27, 0x00020000
    s_add_u32 s30, s17, 0
    s_mul_hi_u32 s31, s30, s19
    s_mul_i32 s32, s31, 5
    s_sub_u32 s32, s30, s32
    s_mul_i32 s33, s31, 5120
    s_lshl_b32 s34, s32, 8
    s_add_u32 s33, s33, s34
    s_mul_i32 s40, s32, 442368
    s_lshl_b32 s34, s31, 7
    s_add_u32 s40, s40, s34
    s_cmp_lt_u32 s30, 2160
    s_cselect_b32 s40, s40, 0x40000000
    buffer_load_dwordx4 v[16:19], v6, s[20:23], s33 offen
    s_add_u32 s30, s17, 1
    s_mul_hi_u32 s31, s30, s19
    s_mul_i32 s32, s31, 5
    s_sub_u32 s32, s30, s32
    s_mul_i32 s33, s31, 5120
    s_lshl_b32 s34, s32, 8
    s_add_u32 s33, s33, s34
    s_mul_i32 s41, s32, 442368
    s_lshl_b32 s34, s31, 7
    s_add_u32 s41, s41, s34
    s_cmp_lt_u32 s30, 2160
    s_cselect_b32 s41, s41, 0x40000000
    buffer_load_dwordx4 v[20:23], v6, s[20:23], s33 offen
    s_add_u32 s30, s17, 2
    s_mul_hi_u32 s31, s30, s19
    s_mul_i32 s32, s31, 5
    s_sub_u32 s32, s30, s32
    s_mul_i32 s33, s31, 5120
    s_lshl_b32 s34, s32, 8
    s_add_u32 s33, s33, s34
    s_mul_i32 s42, s32, 442368
    s_lshl_b32 s34, s31, 7
    s_add_u32 s42, s42, s34
    s_cmp_lt_u32 s30, 2160
    s_cselect_b32 s42, s42, 0x40000000
    buffer_load_dwordx4 v[24:27], v6, s[20:23], s33 offen
    s_add_u32 s30, s17, 3
    s_mul_hi_u32 s31, s30, s19
    s_mul_i32 s32, s31, 5
    s_sub_u32 s32, s30, s32
    s_mul_i32 s33, s31, 5120
    s_lshl_b32 s34, s32, 8
    s_add_u32 s33, s33, s34
    s_mul_i32 s43, s32, 442368
    s_lshl_b32 s34, s31, 7
    s_add_u32 s43, s43, s34
    s_cmp_lt_u32 s30, 2160
    s_cselect_b32 s43, s43, 0x40000000
    buffer_load_dwordx4 v[28:31], v6, s[20:23], s33 offen
    s_add_u32 s30, s17, 4
    s_mul_hi_u32 s31, s30, s19
    s_mul_i32 s32, s31, 5
    s_sub_u32 s32, s30, s32
    s_mul_i32 s33, s31, 5120
    s_lshl_b32 s34, s32, 8
    s_add_u32 s33, s33, s34
    s_mul_i32 s44, s32, 442368
    s_lshl_b32 s34, s31, 7
    s_add_u32 s44, s44, s34
    s_cmp_lt_u32 s30, 2160
    s_cselect_b32 s44, s44, 0x40000000
    buffer_load_dwordx4 v[32:35], v6, s[20:23], s33 offen
    s_add_u32 s30, s17, 5
    s_mul_hi_u32 s31, s30, s19
    s_mul_i32 s32, s31, 5
    s_sub_u32 s32, s30, s32
    s_mul_i32 s33, s31, 5120
    s_lshl_b32 s34, s32, 8
    s_add_u32 s33, s33, s34
    s_mul_i32 s45, s32, 442368
    s_lshl_b32 s34, s31, 7
    s_add_u32 s45, s45, s34
    s_cmp_lt_u32 s30, 2160
    s_cselect_b32 s45, s45, 0x40000000
    buffer_load_dwordx4 v[36:39], v6, s[20:23], s33 offen
    s_add_u32 s30, s17, 6
    s_mul_hi_u32 s31, s30, s19
    s_mul_i32 s32, s31, 5
    s_sub_u32 s32, s30, s32
    s_mul_i32 s33, s31, 5120
    s_lshl_b32 s34, s32, 8
    s_add_u32 s33, s33, s34
    s_mul_i32 s46, s32, 442368
    s_lshl_b32 s34, s31, 7
    s_add_u32 s46, s46, s34
    s_cmp_lt_u32 s30, 2160
    s_cselect_b32 s46, s46, 0x40000000
    buffer_load_dwordx4 v[40:43], v6, s[20:23], s33 offen
    s_add_u32 s30, s17, 7
    s_mul_hi_u32 s31, s30, s19
    s_mul_i32 s32, s31, 5
    s_sub_u32 s32, s30, s32
    s_mul_i32 s33, s31, 5120
    s_lshl_b32 s34, s32, 8
    s_add_u32 s33, s33, s34
    s_mul_i32 s47, s32, 442368
    s_lshl_b32 s34, s31, 7
    s_add_u32 s47, s47, s34
    s_cmp_lt_u32 s30, 2160
    s_cselect_b32 s47, s47, 0x40000000
    buffer_load_dwordx4 v[44:47], v6, s[20:23], s33 offen
    s_waitcnt vmcnt(7)
    buffer_store_dwordx4 v[16:19], v7, s[24:27], s40 offen
    s_waitcnt vmcnt(6)
    buffer_store_dwordx4 v[20:23], v7, s[24:27], s41 offen
    s_waitcnt vmcnt(5)
    buffer_store_dwordx4 v[24:27], v7, s[24:27], s42 offen
    s_waitcnt vmcnt(4)
    buffer_store_dwordx4 v[28:31], v7, s[24:27], s43 offen
    s_waitcnt vmcnt(3)
    buffer_store_dwordx4 v[32:35], v7, s[24:27], s44 offen
    s_waitcnt vmcnt(2)
    buffer_store_dwordx4 v[36:39], v7, s[24:27], s45 offen
    s_waitcnt vmcnt(1)
    buffer_store_dwordx4 v[40:43], v7, s[24:27], s46 offen
    s_waitcnt vmcnt(0)
    buffer_store_dwordx4 v[44:47], v7, s[24:27], s47 offen
    s_endpgm
kv_kernel_end:
kv_kernel_exit:
    s_endpgm
.globl attn_kernel
.p2align 8
.type attn_kernel,@function
attn_kernel:
    s_cmp_ge_u32 s2, 256
    s_cbranch_scc1 attn_kernel_exit
    s_load_dwordx2 s[4:5], s[0:1], 0
    s_load_dwordx2 s[12:13], s[0:1], 96
    s_load_dwordx2 s[14:15], s[0:1], 32
    s_load_dwordx4 s[8:11], s[0:1], 56
    v_and_b32 v1, 63, v0
    v_lshrrev_b32 v2, 6, v0
    s_lshr_b32 s16, s2, 5
    s_and_b32 s17, s2, 7
    s_lshl_b32 s17, s17, 2
    s_bfe_u32 s44, s2, 0x20003
    s_add_u32 s17, s17, s44
    v_readfirstlane_b32 s18, v2
    v_and_b32 v3, 15, v1
    v_lshrrev_b32 v4, 4, v1
    s_waitcnt lgkmcnt(0)
    s_mov_b32 s20, s4
    s_mov_b32 s21, s5
    s_mov_b32 s22, 2621440
    s_mov_b32 s23, 0x00020000
    s_mul_i32 s44, s16, 102400
    s_add_u32 s44, s44, 31457280
    s_add_u32 s24, s12, s44
    s_addc_u32 s25, s13, 0
    s_mov_b32 s26, 102400
    s_mov_b32 s27, 0x00020000
    s_add_u32 s28, s12, 17825792
    s_addc_u32 s29, s13, 0
    s_mov_b32 s30, 1024
    s_mov_b32 s31, 0x00020000
    s_add_u32 s56, s12, 4194304
    s_addc_u32 s57, s13, 0
    s_mov_b32 s58, 163840
    s_mov_b32 s59, 0x00020000
    v_lshlrev_b32 v7, 2, v1
    buffer_load_dword v128, v7, s[28:31], 0 offen
    buffer_load_dword v129, v7, s[28:31], 0 offen offset:256
    buffer_load_dword v130, v7, s[28:31], 0 offen offset:512
    buffer_load_dword v131, v7, s[28:31], 0 offen offset:768
    v_lshlrev_b32 v132, 4, v1
    s_lshl_b32 s52, s18, 10
    s_add_u32 s52, s52, 49152
    s_cmp_lt_u32 s18, 4
    s_cbranch_scc1 attn_kernel_mm
    s_cmp_eq_u32 s18, 4
    s_cbranch_scc0 attn_kernel_ld0
    s_barrier
    s_barrier
    s_barrier
    s_barrier
    s_barrier
    s_branch attn_kernel_ldone
attn_kernel_ld0:
    s_cmp_eq_u32 s18, 5
    s_cbranch_scc0 attn_kernel_ld1
    s_lshl_b32 s45, s17, 6
    v_add_u32 v6, 0, v4
    v_and_b32 v7, 15, v6
    v_xor_b32 v7, v7, v3
    v_add_u32 v6, s45, v6
    v_mul_u32_u24 v6, 1280, v6
    v_lshl_add_u32 v16, v7, 4, v6
    v_add_u32 v6, 4, v4
    v_and_b32 v7, 15, v6
    v_xor_b32 v7, v7, v3
    v_add_u32 v6, s45, v6
    v_mul_u32_u24 v6, 1280, v6
    v_lshl_add_u32 v17, v7, 4, v6
    v_add_u32 v6, 8, v4
    v_and_b32 v7, 15, v6
    v_xor_b32 v7, v7, v3
    v_add_u32 v6, s45, v6
    v_mul_u32_u24 v6, 1280, v6
    v_lshl_add_u32 v18, v7, 4, v6
    v_add_u32 v6, 12, v4
    v_and_b32 v7, 15, v6
    v_xor_b32 v7, v7, v3
    v_add_u32 v6, s45, v6
    v_mul_u32_u24 v6, 1280, v6
    v_lshl_add_u32 v19, v7, 4, v6
    v_add_u32 v6, 16, v4
    v_and_b32 v7, 15, v6
    v_xor_b32 v7, v7, v3
    v_add_u32 v6, s45, v6
    v_mul_u32_u24 v6, 1280, v6
    v_lshl_add_u32 v20, v7, 4, v6
    v_add_u32 v6, 20, v4
    v_and_b32 v7, 15, v6
    v_xor_b32 v7, v7, v3
    v_add_u32 v6, s45, v6
    v_mul_u32_u24 v6, 1280, v6
    v_lshl_add_u32 v21, v7, 4, v6
    v_add_u32 v6, 24, v4
    v_and_b32 v7, 15, v6
    v_xor_b32 v7, v7, v3
    v_add_u32 v6, s45, v6
    v_mul_u32_u24 v6, 1280, v6
    v_lshl_add_u32 v22, v7, 4, v6
    v_add_u32 v6, 28, v4
    v_and_b32 v7, 15, v6
    v_xor_b32 v7, v7, v3
    v_add_u32 v6, s45, v6
    v_mul_u32_u24 v6, 1280, v6
    v_lshl_add_u32 v23, v7, 4, v6
    v_add_u32 v6, 32, v4
    v_and_b32 v7, 15, v6
    v_xor_b32 v7, v7, v3
    v_add_u32 v6, s45, v6
    v_mul_u32_u24 v6, 1280, v6
    v_lshl_add_u32 v24, v7, 4, v6
    v_add_u32 v6, 36, v4
    v_and_b32 v7, 15, v6
    v_xor_b32 v7, v7, v3
    v_add_u32 v6, s45, v6
    v_mul_u32_u24 v6, 1280, v6
    v_lshl_add_u32 v25, v7, 4, v6
    v_add_u32 v6, 40, v4
    v_and_b32 v7, 15, v6
    v_xor_b32 v7, v7, v3
    v_add_u32 v6, s45, v6
    v_mul_u32_u24 v6, 1280, v6
    v_lshl_add_u32 v26, v7, 4, v6
    v_add_u32 v6, 44, v4
    v_and_b32 v7, 15, v6
    v_xor_b32 v7, v7, v3
    v_add_u32 v6, s45, v6
    v_mul_u32_u24 v6, 1280, v6
    v_lshl_add_u32 v27, v7, 4, v6
    s_mov_b32 s46, 0
    s_mov_b32 s47, 0
    s_mov_b32 m0, 53248
    s_nop 0
    buffer_load_dwordx4 v16, s[20:23], s46 offen lds
    s_mov_b32 m0, 54272
    s_nop 0
    buffer_load_dwordx4 v17, s[20:23], s46 offen lds
    s_mov_b32 m0, 55296
    s_nop 0
    buffer_load_dwordx4 v18, s[20:23], s46 offen lds
    s_mov_b32 m0, 56320
    s_nop 0
    buffer_load_dwordx4 v19, s[20:23], s46 offen lds
    s_mov_b32 m0, 57344
    s_nop 0
    buffer_load_dwordx4 v20, s[20:23], s46 offen lds
    s_mov_b32 m0, 58368
    s_nop 0
    buffer_load_dwordx4 v21, s[20:23], s46 offen lds
    s_mov_b32 m0, 59392
    s_nop 0
    buffer_load_dwordx4 v22, s[20:23], s46 offen lds
    s_mov_b32 m0, 60416
    s_nop 0
    buffer_load_dwordx4 v23, s[20:23], s46 offen lds
    s_mov_b32 m0, 61440
    s_nop 0
    buffer_load_dwordx4 v24, s[20:23], s46 offen lds
    s_mov_b32 m0, 62464
    s_nop 0
    buffer_load_dwordx4 v25, s[20:23], s46 offen lds
    s_mov_b32 m0, 63488
    s_nop 0
    buffer_load_dwordx4 v26, s[20:23], s46 offen lds
    s_mov_b32 m0, 64512
    s_nop 0
    buffer_load_dwordx4 v27, s[20:23], s46 offen lds
    s_mov_b32 s46, 256
    s_mov_b32 s47, 20480
    s_mov_b32 m0, 90112
    s_nop 0
    buffer_load_dwordx4 v16, s[20:23], s46 offen lds
    s_mov_b32 m0, 91136
    s_nop 0
    buffer_load_dwordx4 v17, s[20:23], s46 offen lds
    s_mov_b32 m0, 92160
    s_nop 0
    buffer_load_dwordx4 v18, s[20:23], s46 offen lds
    s_mov_b32 m0, 93184
    s_nop 0
    buffer_load_dwordx4 v19, s[20:23], s46 offen lds
    s_mov_b32 m0, 94208
    s_nop 0
    buffer_load_dwordx4 v20, s[20:23], s46 offen lds
    s_mov_b32 m0, 95232
    s_nop 0
    buffer_load_dwordx4 v21, s[20:23], s46 offen lds
    s_mov_b32 m0, 96256
    s_nop 0
    buffer_load_dwordx4 v22, s[20:23], s46 offen lds
    s_mov_b32 m0, 97280
    s_nop 0
    buffer_load_dwordx4 v23, s[20:23], s46 offen lds
    s_mov_b32 m0, 98304
    s_nop 0
    buffer_load_dwordx4 v24, s[20:23], s46 offen lds
    s_mov_b32 m0, 99328
    s_nop 0
    buffer_load_dwordx4 v25, s[20:23], s46 offen lds
    s_mov_b32 m0, 100352
    s_nop 0
    buffer_load_dwordx4 v26, s[20:23], s46 offen lds
    s_mov_b32 m0, 101376
    s_nop 0
    buffer_load_dwordx4 v27, s[20:23], s46 offen lds
    s_waitcnt vmcnt(12)
    s_barrier
    s_mov_b32 s46, 512
    s_mov_b32 s47, 40960
    s_mov_b32 m0, 126976
    s_nop 0
    buffer_load_dwordx4 v16, s[20:23], s46 offen lds
    s_mov_b32 m0, 128000
    s_nop 0
    buffer_load_dwordx4 v17, s[20:23], s46 offen lds
    s_mov_b32 m0, 129024
    s_nop 0
    buffer_load_dwordx4 v18, s[20:23], s46 offen lds
    s_mov_b32 m0, 130048
    s_nop 0
    buffer_load_dwordx4 v19, s[20:23], s46 offen lds
    s_mov_b32 m0, 131072
    s_nop 0
    buffer_load_dwordx4 v20, s[20:23], s46 offen lds
    s_mov_b32 m0, 132096
    s_nop 0
    buffer_load_dwordx4 v21, s[20:23], s46 offen lds
    s_mov_b32 m0, 133120
    s_nop 0
    buffer_load_dwordx4 v22, s[20:23], s46 offen lds
    s_mov_b32 m0, 134144
    s_nop 0
    buffer_load_dwordx4 v23, s[20:23], s46 offen lds
    s_mov_b32 m0, 135168
    s_nop 0
    buffer_load_dwordx4 v24, s[20:23], s46 offen lds
    s_mov_b32 m0, 136192
    s_nop 0
    buffer_load_dwordx4 v25, s[20:23], s46 offen lds
    s_mov_b32 m0, 137216
    s_nop 0
    buffer_load_dwordx4 v26, s[20:23], s46 offen lds
    s_mov_b32 m0, 138240
    s_nop 0
    buffer_load_dwordx4 v27, s[20:23], s46 offen lds
    s_waitcnt vmcnt(12)
    s_barrier
    s_mov_b32 s46, 768
    s_mov_b32 s47, 61440
    s_mov_b32 m0, 53248
    s_nop 0
    buffer_load_dwordx4 v16, s[20:23], s46 offen lds
    s_mov_b32 m0, 54272
    s_nop 0
    buffer_load_dwordx4 v17, s[20:23], s46 offen lds
    s_mov_b32 m0, 55296
    s_nop 0
    buffer_load_dwordx4 v18, s[20:23], s46 offen lds
    s_mov_b32 m0, 56320
    s_nop 0
    buffer_load_dwordx4 v19, s[20:23], s46 offen lds
    s_mov_b32 m0, 57344
    s_nop 0
    buffer_load_dwordx4 v20, s[20:23], s46 offen lds
    s_mov_b32 m0, 58368
    s_nop 0
    buffer_load_dwordx4 v21, s[20:23], s46 offen lds
    s_mov_b32 m0, 59392
    s_nop 0
    buffer_load_dwordx4 v22, s[20:23], s46 offen lds
    s_mov_b32 m0, 60416
    s_nop 0
    buffer_load_dwordx4 v23, s[20:23], s46 offen lds
    s_mov_b32 m0, 61440
    s_nop 0
    buffer_load_dwordx4 v24, s[20:23], s46 offen lds
    s_mov_b32 m0, 62464
    s_nop 0
    buffer_load_dwordx4 v25, s[20:23], s46 offen lds
    s_mov_b32 m0, 63488
    s_nop 0
    buffer_load_dwordx4 v26, s[20:23], s46 offen lds
    s_mov_b32 m0, 64512
    s_nop 0
    buffer_load_dwordx4 v27, s[20:23], s46 offen lds
    s_waitcnt vmcnt(12)
    s_barrier
    s_mov_b32 s46, 1024
    s_mov_b32 s47, 81920
    s_mov_b32 m0, 90112
    s_nop 0
    buffer_load_dwordx4 v16, s[20:23], s46 offen lds
    s_mov_b32 m0, 91136
    s_nop 0
    buffer_load_dwordx4 v17, s[20:23], s46 offen lds
    s_mov_b32 m0, 92160
    s_nop 0
    buffer_load_dwordx4 v18, s[20:23], s46 offen lds
    s_mov_b32 m0, 93184
    s_nop 0
    buffer_load_dwordx4 v19, s[20:23], s46 offen lds
    s_mov_b32 m0, 94208
    s_nop 0
    buffer_load_dwordx4 v20, s[20:23], s46 offen lds
    s_mov_b32 m0, 95232
    s_nop 0
    buffer_load_dwordx4 v21, s[20:23], s46 offen lds
    s_mov_b32 m0, 96256
    s_nop 0
    buffer_load_dwordx4 v22, s[20:23], s46 offen lds
    s_mov_b32 m0, 97280
    s_nop 0
    buffer_load_dwordx4 v23, s[20:23], s46 offen lds
    s_mov_b32 m0, 98304
    s_nop 0
    buffer_load_dwordx4 v24, s[20:23], s46 offen lds
    s_mov_b32 m0, 99328
    s_nop 0
    buffer_load_dwordx4 v25, s[20:23], s46 offen lds
    s_mov_b32 m0, 100352
    s_nop 0
    buffer_load_dwordx4 v26, s[20:23], s46 offen lds
    s_mov_b32 m0, 101376
    s_nop 0
    buffer_load_dwordx4 v27, s[20:23], s46 offen lds
    s_waitcnt vmcnt(12)
    s_barrier
    s_mov_b32 m0, 0
    s_mov_b32 s46, 0
    buffer_load_dwordx4 v132, s[56:59], s46 offen lds
    s_mov_b32 m0, 1024
    s_mov_b32 s46, 1024
    buffer_load_dwordx4 v132, s[56:59], s46 offen lds
    s_mov_b32 m0, 2048
    s_mov_b32 s46, 2048
    buffer_load_dwordx4 v132, s[56:59], s46 offen lds
    s_mov_b32 m0, 3072
    s_mov_b32 s46, 3072
    buffer_load_dwordx4 v132, s[56:59], s46 offen lds
    s_mov_b32 m0, 4096
    s_mov_b32 s46, 4096
    buffer_load_dwordx4 v132, s[56:59], s46 offen lds
    s_mov_b32 m0, 5120
    s_mov_b32 s46, 5120
    buffer_load_dwordx4 v132, s[56:59], s46 offen lds
    s_mov_b32 m0, 6144
    s_mov_b32 s46, 6144
    buffer_load_dwordx4 v132, s[56:59], s46 offen lds
    s_mov_b32 m0, 7168
    s_mov_b32 s46, 7168
    buffer_load_dwordx4 v132, s[56:59], s46 offen lds
    s_mov_b32 m0, 8192
    s_mov_b32 s46, 8192
    buffer_load_dwordx4 v132, s[56:59], s46 offen lds
    s_mov_b32 m0, 9216
    s_mov_b32 s46, 9216
    buffer_load_dwordx4 v132, s[56:59], s46 offen lds
    s_mov_b32 m0, 10240
    s_mov_b32 s46, 10240
    buffer_load_dwordx4 v132, s[56:59], s46 offen lds
    s_mov_b32 m0, 11264
    s_mov_b32 s46, 11264
    buffer_load_dwordx4 v132, s[56:59], s46 offen lds
    s_mov_b32 m0, 12288
    s_mov_b32 s46, 12288
    buffer_load_dwordx4 v132, s[56:59], s46 offen lds
    s_mov_b32 m0, 13312
    s_mov_b32 s46, 13312
    buffer_load_dwordx4 v132, s[56:59], s46 offen lds
    s_mov_b32 m0, 14336
    s_mov_b32 s46, 14336
    buffer_load_dwordx4 v132, s[56:59], s46 offen lds
    s_mov_b32 m0, 15360
    s_mov_b32 s46, 15360
    buffer_load_dwordx4 v132, s[56:59], s46 offen lds
    s_waitcnt vmcnt(16)
    s_barrier
    s_waitcnt vmcnt(0)
    s_branch attn_kernel_ldone
attn_kernel_ld1:
    s_cmp_eq_u32 s18, 6
    s_cbranch_scc0 attn_kernel_ld2
    s_lshl_b32 s45, s17, 6
    v_add_u32 v6, 48, v4
    v_and_b32 v7, 15, v6
    v_xor_b32 v7, v7, v3
    v_add_u32 v6, s45, v6
    v_mul_u32_u24 v6, 1280, v6
    v_lshl_add_u32 v16, v7, 4, v6
    v_add_u32 v6, 52, v4
    v_and_b32 v7, 15, v6
    v_xor_b32 v7, v7, v3
    v_add_u32 v6, s45, v6
    v_mul_u32_u24 v6, 1280, v6
    v_lshl_add_u32 v17, v7, 4, v6
    v_add_u32 v6, 56, v4
    v_and_b32 v7, 15, v6
    v_xor_b32 v7, v7, v3
    v_add_u32 v6, s45, v6
    v_mul_u32_u24 v6, 1280, v6
    v_lshl_add_u32 v18, v7, 4, v6
    v_add_u32 v6, 60, v4
    v_and_b32 v7, 15, v6
    v_xor_b32 v7, v7, v3
    v_add_u32 v6, s45, v6
    v_mul_u32_u24 v6, 1280, v6
    v_lshl_add_u32 v19, v7, 4, v6
    v_add_u32 v6, 0, v1
    v_lshlrev_b32 v20, 4, v6
    v_add_u32 v6, 64, v1
    v_lshlrev_b32 v21, 4, v6
    v_add_u32 v6, 128, v1
    v_lshlrev_b32 v22, 4, v6
    v_add_u32 v6, 192, v1
    v_lshlrev_b32 v23, 4, v6
    v_add_u32 v6, 256, v1
    v_lshlrev_b32 v24, 4, v6
    v_add_u32 v6, 320, v1
    v_lshlrev_b32 v25, 4, v6
    v_add_u32 v6, 384, v1
    v_lshlrev_b32 v26, 4, v6
    v_add_u32 v6, 448, v1
    v_lshlrev_b32 v27, 4, v6
    s_mov_b32 s46, 0
    s_mov_b32 s47, 0
    s_mov_b32 m0, 65536
    s_nop 0
    buffer_load_dwordx4 v16, s[20:23], s46 offen lds
    s_mov_b32 m0, 66560
    s_nop 0
    buffer_load_dwordx4 v17, s[20:23], s46 offen lds
    s_mov_b32 m0, 67584
    s_nop 0
    buffer_load_dwordx4 v18, s[20:23], s46 offen lds
    s_mov_b32 m0, 68608
    s_nop 0
    buffer_load_dwordx4 v19, s[20:23], s46 offen lds
    s_mov_b32 m0, 69632
    s_nop 0
    buffer_load_dwordx4 v20, s[24:27], s47 offen lds
    s_mov_b32 m0, 70656
    s_nop 0
    buffer_load_dwordx4 v21, s[24:27], s47 offen lds
    s_mov_b32 m0, 71680
    s_nop 0
    buffer_load_dwordx4 v22, s[24:27], s47 offen lds
    s_mov_b32 m0, 72704
    s_nop 0
    buffer_load_dwordx4 v23, s[24:27], s47 offen lds
    s_mov_b32 m0, 73728
    s_nop 0
    buffer_load_dwordx4 v24, s[24:27], s47 offen lds
    s_mov_b32 m0, 74752
    s_nop 0
    buffer_load_dwordx4 v25, s[24:27], s47 offen lds
    s_mov_b32 m0, 75776
    s_nop 0
    buffer_load_dwordx4 v26, s[24:27], s47 offen lds
    s_mov_b32 m0, 76800
    s_nop 0
    buffer_load_dwordx4 v27, s[24:27], s47 offen lds
    s_mov_b32 s46, 256
    s_mov_b32 s47, 20480
    s_mov_b32 m0, 102400
    s_nop 0
    buffer_load_dwordx4 v16, s[20:23], s46 offen lds
    s_mov_b32 m0, 103424
    s_nop 0
    buffer_load_dwordx4 v17, s[20:23], s46 offen lds
    s_mov_b32 m0, 104448
    s_nop 0
    buffer_load_dwordx4 v18, s[20:23], s46 offen lds
    s_mov_b32 m0, 105472
    s_nop 0
    buffer_load_dwordx4 v19, s[20:23], s46 offen lds
    s_mov_b32 m0, 106496
    s_nop 0
    buffer_load_dwordx4 v20, s[24:27], s47 offen lds
    s_mov_b32 m0, 107520
    s_nop 0
    buffer_load_dwordx4 v21, s[24:27], s47 offen lds
    s_mov_b32 m0, 108544
    s_nop 0
    buffer_load_dwordx4 v22, s[24:27], s47 offen lds
    s_mov_b32 m0, 109568
    s_nop 0
    buffer_load_dwordx4 v23, s[24:27], s47 offen lds
    s_mov_b32 m0, 110592
    s_nop 0
    buffer_load_dwordx4 v24, s[24:27], s47 offen lds
    s_mov_b32 m0, 111616
    s_nop 0
    buffer_load_dwordx4 v25, s[24:27], s47 offen lds
    s_mov_b32 m0, 112640
    s_nop 0
    buffer_load_dwordx4 v26, s[24:27], s47 offen lds
    s_mov_b32 m0, 113664
    s_nop 0
    buffer_load_dwordx4 v27, s[24:27], s47 offen lds
    s_waitcnt vmcnt(12)
    s_barrier
    s_mov_b32 s46, 512
    s_mov_b32 s47, 40960
    s_mov_b32 m0, 139264
    s_nop 0
    buffer_load_dwordx4 v16, s[20:23], s46 offen lds
    s_mov_b32 m0, 140288
    s_nop 0
    buffer_load_dwordx4 v17, s[20:23], s46 offen lds
    s_mov_b32 m0, 141312
    s_nop 0
    buffer_load_dwordx4 v18, s[20:23], s46 offen lds
    s_mov_b32 m0, 142336
    s_nop 0
    buffer_load_dwordx4 v19, s[20:23], s46 offen lds
    s_mov_b32 m0, 143360
    s_nop 0
    buffer_load_dwordx4 v20, s[24:27], s47 offen lds
    s_mov_b32 m0, 144384
    s_nop 0
    buffer_load_dwordx4 v21, s[24:27], s47 offen lds
    s_mov_b32 m0, 145408
    s_nop 0
    buffer_load_dwordx4 v22, s[24:27], s47 offen lds
    s_mov_b32 m0, 146432
    s_nop 0
    buffer_load_dwordx4 v23, s[24:27], s47 offen lds
    s_mov_b32 m0, 147456
    s_nop 0
    buffer_load_dwordx4 v24, s[24:27], s47 offen lds
    s_mov_b32 m0, 148480
    s_nop 0
    buffer_load_dwordx4 v25, s[24:27], s47 offen lds
    s_mov_b32 m0, 149504
    s_nop 0
    buffer_load_dwordx4 v26, s[24:27], s47 offen lds
    s_mov_b32 m0, 150528
    s_nop 0
    buffer_load_dwordx4 v27, s[24:27], s47 offen lds
    s_waitcnt vmcnt(12)
    s_barrier
    s_mov_b32 s46, 768
    s_mov_b32 s47, 61440
    s_mov_b32 m0, 65536
    s_nop 0
    buffer_load_dwordx4 v16, s[20:23], s46 offen lds
    s_mov_b32 m0, 66560
    s_nop 0
    buffer_load_dwordx4 v17, s[20:23], s46 offen lds
    s_mov_b32 m0, 67584
    s_nop 0
    buffer_load_dwordx4 v18, s[20:23], s46 offen lds
    s_mov_b32 m0, 68608
    s_nop 0
    buffer_load_dwordx4 v19, s[20:23], s46 offen lds
    s_mov_b32 m0, 69632
    s_nop 0
    buffer_load_dwordx4 v20, s[24:27], s47 offen lds
    s_mov_b32 m0, 70656
    s_nop 0
    buffer_load_dwordx4 v21, s[24:27], s47 offen lds
    s_mov_b32 m0, 71680
    s_nop 0
    buffer_load_dwordx4 v22, s[24:27], s47 offen lds
    s_mov_b32 m0, 72704
    s_nop 0
    buffer_load_dwordx4 v23, s[24:27], s47 offen lds
    s_mov_b32 m0, 73728
    s_nop 0
    buffer_load_dwordx4 v24, s[24:27], s47 offen lds
    s_mov_b32 m0, 74752
    s_nop 0
    buffer_load_dwordx4 v25, s[24:27], s47 offen lds
    s_mov_b32 m0, 75776
    s_nop 0
    buffer_load_dwordx4 v26, s[24:27], s47 offen lds
    s_mov_b32 m0, 76800
    s_nop 0
    buffer_load_dwordx4 v27, s[24:27], s47 offen lds
    s_waitcnt vmcnt(12)
    s_barrier
    s_mov_b32 s46, 1024
    s_mov_b32 s47, 81920
    s_mov_b32 m0, 102400
    s_nop 0
    buffer_load_dwordx4 v16, s[20:23], s46 offen lds
    s_mov_b32 m0, 103424
    s_nop 0
    buffer_load_dwordx4 v17, s[20:23], s46 offen lds
    s_mov_b32 m0, 104448
    s_nop 0
    buffer_load_dwordx4 v18, s[20:23], s46 offen lds
    s_mov_b32 m0, 105472
    s_nop 0
    buffer_load_dwordx4 v19, s[20:23], s46 offen lds
    s_mov_b32 m0, 106496
    s_nop 0
    buffer_load_dwordx4 v20, s[24:27], s47 offen lds
    s_mov_b32 m0, 107520
    s_nop 0
    buffer_load_dwordx4 v21, s[24:27], s47 offen lds
    s_mov_b32 m0, 108544
    s_nop 0
    buffer_load_dwordx4 v22, s[24:27], s47 offen lds
    s_mov_b32 m0, 109568
    s_nop 0
    buffer_load_dwordx4 v23, s[24:27], s47 offen lds
    s_mov_b32 m0, 110592
    s_nop 0
    buffer_load_dwordx4 v24, s[24:27], s47 offen lds
    s_mov_b32 m0, 111616
    s_nop 0
    buffer_load_dwordx4 v25, s[24:27], s47 offen lds
    s_mov_b32 m0, 112640
    s_nop 0
    buffer_load_dwordx4 v26, s[24:27], s47 offen lds
    s_mov_b32 m0, 113664
    s_nop 0
    buffer_load_dwordx4 v27, s[24:27], s47 offen lds
    s_waitcnt vmcnt(12)
    s_barrier
    s_mov_b32 m0, 16384
    s_mov_b32 s46, 16384
    buffer_load_dwordx4 v132, s[56:59], s46 offen lds
    s_mov_b32 m0, 17408
    s_mov_b32 s46, 17408
    buffer_load_dwordx4 v132, s[56:59], s46 offen lds
    s_mov_b32 m0, 18432
    s_mov_b32 s46, 18432
    buffer_load_dwordx4 v132, s[56:59], s46 offen lds
    s_mov_b32 m0, 19456
    s_mov_b32 s46, 19456
    buffer_load_dwordx4 v132, s[56:59], s46 offen lds
    s_mov_b32 m0, 20480
    s_mov_b32 s46, 20480
    buffer_load_dwordx4 v132, s[56:59], s46 offen lds
    s_mov_b32 m0, 21504
    s_mov_b32 s46, 21504
    buffer_load_dwordx4 v132, s[56:59], s46 offen lds
    s_mov_b32 m0, 22528
    s_mov_b32 s46, 22528
    buffer_load_dwordx4 v132, s[56:59], s46 offen lds
    s_mov_b32 m0, 23552
    s_mov_b32 s46, 23552
    buffer_load_dwordx4 v132, s[56:59], s46 offen lds
    s_mov_b32 m0, 24576
    s_mov_b32 s46, 24576
    buffer_load_dwordx4 v132, s[56:59], s46 offen lds
    s_mov_b32 m0, 25600
    s_mov_b32 s46, 25600
    buffer_load_dwordx4 v132, s[56:59], s46 offen lds
    s_mov_b32 m0, 26624
    s_mov_b32 s46, 26624
    buffer_load_dwordx4 v132, s[56:59], s46 offen lds
    s_mov_b32 m0, 27648
    s_mov_b32 s46, 27648
    buffer_load_dwordx4 v132, s[56:59], s46 offen lds
    s_mov_b32 m0, 28672
    s_mov_b32 s46, 28672
    buffer_load_dwordx4 v132, s[56:59], s46 offen lds
    s_mov_b32 m0, 29696
    s_mov_b32 s46, 29696
    buffer_load_dwordx4 v132, s[56:59], s46 offen lds
    s_mov_b32 m0, 30720
    s_mov_b32 s46, 30720
    buffer_load_dwordx4 v132, s[56:59], s46 offen lds
    s_mov_b32 m0, 31744
    s_mov_b32 s46, 31744
    buffer_load_dwordx4 v132, s[56:59], s46 offen lds
    s_waitcnt vmcnt(16)
    s_barrier
    s_waitcnt vmcnt(0)
    s_branch attn_kernel_ldone
attn_kernel_ld2:
    s_lshl_b32 s45, s17, 6
    v_add_u32 v6, 512, v1
    v_lshlrev_b32 v16, 4, v6
    v_add_u32 v6, 576, v1
    v_lshlrev_b32 v17, 4, v6
    v_add_u32 v6, 640, v1
    v_lshlrev_b32 v18, 4, v6
    v_add_u32 v6, 704, v1
    v_lshlrev_b32 v19, 4, v6
    v_add_u32 v6, 768, v1
    v_lshlrev_b32 v20, 4, v6
    v_add_u32 v6, 832, v1
    v_lshlrev_b32 v21, 4, v6
    v_add_u32 v6, 896, v1
    v_lshlrev_b32 v22, 4, v6
    v_add_u32 v6, 960, v1
    v_lshlrev_b32 v23, 4, v6
    v_add_u32 v6, 1024, v1
    v_lshlrev_b32 v24, 4, v6
    v_add_u32 v6, 1088, v1
    v_lshlrev_b32 v25, 4, v6
    v_add_u32 v6, 1152, v1
    v_lshlrev_b32 v26, 4, v6
    v_add_u32 v6, 1216, v1
    v_lshlrev_b32 v27, 4, v6
    s_mov_b32 s46, 0
    s_mov_b32 s47, 0
    s_mov_b32 m0, 77824
    s_nop 0
    buffer_load_dwordx4 v16, s[24:27], s47 offen lds
    s_mov_b32 m0, 78848
    s_nop 0
    buffer_load_dwordx4 v17, s[24:27], s47 offen lds
    s_mov_b32 m0, 79872
    s_nop 0
    buffer_load_dwordx4 v18, s[24:27], s47 offen lds
    s_mov_b32 m0, 80896
    s_nop 0
    buffer_load_dwordx4 v19, s[24:27], s47 offen lds
    s_mov_b32 m0, 81920
    s_nop 0
    buffer_load_dwordx4 v20, s[24:27], s47 offen lds
    s_mov_b32 m0, 82944
    s_nop 0
    buffer_load_dwordx4 v21, s[24:27], s47 offen lds
    s_mov_b32 m0, 83968
    s_nop 0
    buffer_load_dwordx4 v22, s[24:27], s47 offen lds
    s_mov_b32 m0, 84992
    s_nop 0
    buffer_load_dwordx4 v23, s[24:27], s47 offen lds
    s_mov_b32 m0, 86016
    s_nop 0
    buffer_load_dwordx4 v24, s[24:27], s47 offen lds
    s_mov_b32 m0, 87040
    s_nop 0
    buffer_load_dwordx4 v25, s[24:27], s47 offen lds
    s_mov_b32 m0, 88064
    s_nop 0
    buffer_load_dwordx4 v26, s[24:27], s47 offen lds
    s_mov_b32 m0, 89088
    s_nop 0
    buffer_load_dwordx4 v27, s[24:27], s47 offen lds
    s_mov_b32 s46, 256
    s_mov_b32 s47, 20480
    s_mov_b32 m0, 114688
    s_nop 0
    buffer_load_dwordx4 v16, s[24:27], s47 offen lds
    s_mov_b32 m0, 115712
    s_nop 0
    buffer_load_dwordx4 v17, s[24:27], s47 offen lds
    s_mov_b32 m0, 116736
    s_nop 0
    buffer_load_dwordx4 v18, s[24:27], s47 offen lds
    s_mov_b32 m0, 117760
    s_nop 0
    buffer_load_dwordx4 v19, s[24:27], s47 offen lds
    s_mov_b32 m0, 118784
    s_nop 0
    buffer_load_dwordx4 v20, s[24:27], s47 offen lds
    s_mov_b32 m0, 119808
    s_nop 0
    buffer_load_dwordx4 v21, s[24:27], s47 offen lds
    s_mov_b32 m0, 120832
    s_nop 0
    buffer_load_dwordx4 v22, s[24:27], s47 offen lds
    s_mov_b32 m0, 121856
    s_nop 0
    buffer_load_dwordx4 v23, s[24:27], s47 offen lds
    s_mov_b32 m0, 122880
    s_nop 0
    buffer_load_dwordx4 v24, s[24:27], s47 offen lds
    s_mov_b32 m0, 123904
    s_nop 0
    buffer_load_dwordx4 v25, s[24:27], s47 offen lds
    s_mov_b32 m0, 124928
    s_nop 0
    buffer_load_dwordx4 v26, s[24:27], s47 offen lds
    s_mov_b32 m0, 125952
    s_nop 0
    buffer_load_dwordx4 v27, s[24:27], s47 offen lds
    s_waitcnt vmcnt(12)
    s_barrier
    s_mov_b32 s46, 512
    s_mov_b32 s47, 40960
    s_mov_b32 m0, 151552
    s_nop 0
    buffer_load_dwordx4 v16, s[24:27], s47 offen lds
    s_mov_b32 m0, 152576
    s_nop 0
    buffer_load_dwordx4 v17, s[24:27], s47 offen lds
    s_mov_b32 m0, 153600
    s_nop 0
    buffer_load_dwordx4 v18, s[24:27], s47 offen lds
    s_mov_b32 m0, 154624
    s_nop 0
    buffer_load_dwordx4 v19, s[24:27], s47 offen lds
    s_mov_b32 m0, 155648
    s_nop 0
    buffer_load_dwordx4 v20, s[24:27], s47 offen lds
    s_mov_b32 m0, 156672
    s_nop 0
    buffer_load_dwordx4 v21, s[24:27], s47 offen lds
    s_mov_b32 m0, 157696
    s_nop 0
    buffer_load_dwordx4 v22, s[24:27], s47 offen lds
    s_mov_b32 m0, 158720
    s_nop 0
    buffer_load_dwordx4 v23, s[24:27], s47 offen lds
    s_mov_b32 m0, 159744
    s_nop 0
    buffer_load_dwordx4 v24, s[24:27], s47 offen lds
    s_mov_b32 m0, 160768
    s_nop 0
    buffer_load_dwordx4 v25, s[24:27], s47 offen lds
    s_mov_b32 m0, 161792
    s_nop 0
    buffer_load_dwordx4 v26, s[24:27], s47 offen lds
    s_mov_b32 m0, 162816
    s_nop 0
    buffer_load_dwordx4 v27, s[24:27], s47 offen lds
    s_waitcnt vmcnt(12)
    s_barrier
    s_mov_b32 s46, 768
    s_mov_b32 s47, 61440
    s_mov_b32 m0, 77824
    s_nop 0
    buffer_load_dwordx4 v16, s[24:27], s47 offen lds
    s_mov_b32 m0, 78848
    s_nop 0
    buffer_load_dwordx4 v17, s[24:27], s47 offen lds
    s_mov_b32 m0, 79872
    s_nop 0
    buffer_load_dwordx4 v18, s[24:27], s47 offen lds
    s_mov_b32 m0, 80896
    s_nop 0
    buffer_load_dwordx4 v19, s[24:27], s47 offen lds
    s_mov_b32 m0, 81920
    s_nop 0
    buffer_load_dwordx4 v20, s[24:27], s47 offen lds
    s_mov_b32 m0, 82944
    s_nop 0
    buffer_load_dwordx4 v21, s[24:27], s47 offen lds
    s_mov_b32 m0, 83968
    s_nop 0
    buffer_load_dwordx4 v22, s[24:27], s47 offen lds
    s_mov_b32 m0, 84992
    s_nop 0
    buffer_load_dwordx4 v23, s[24:27], s47 offen lds
    s_mov_b32 m0, 86016
    s_nop 0
    buffer_load_dwordx4 v24, s[24:27], s47 offen lds
    s_mov_b32 m0, 87040
    s_nop 0
    buffer_load_dwordx4 v25, s[24:27], s47 offen lds
    s_mov_b32 m0, 88064
    s_nop 0
    buffer_load_dwordx4 v26, s[24:27], s47 offen lds
    s_mov_b32 m0, 89088
    s_nop 0
    buffer_load_dwordx4 v27, s[24:27], s47 offen lds
    s_waitcnt vmcnt(12)
    s_barrier
    s_mov_b32 s46, 1024
    s_mov_b32 s47, 81920
    s_mov_b32 m0, 114688
    s_nop 0
    buffer_load_dwordx4 v16, s[24:27], s47 offen lds
    s_mov_b32 m0, 115712
    s_nop 0
    buffer_load_dwordx4 v17, s[24:27], s47 offen lds
    s_mov_b32 m0, 116736
    s_nop 0
    buffer_load_dwordx4 v18, s[24:27], s47 offen lds
    s_mov_b32 m0, 117760
    s_nop 0
    buffer_load_dwordx4 v19, s[24:27], s47 offen lds
    s_mov_b32 m0, 118784
    s_nop 0
    buffer_load_dwordx4 v20, s[24:27], s47 offen lds
    s_mov_b32 m0, 119808
    s_nop 0
    buffer_load_dwordx4 v21, s[24:27], s47 offen lds
    s_mov_b32 m0, 120832
    s_nop 0
    buffer_load_dwordx4 v22, s[24:27], s47 offen lds
    s_mov_b32 m0, 121856
    s_nop 0
    buffer_load_dwordx4 v23, s[24:27], s47 offen lds
    s_mov_b32 m0, 122880
    s_nop 0
    buffer_load_dwordx4 v24, s[24:27], s47 offen lds
    s_mov_b32 m0, 123904
    s_nop 0
    buffer_load_dwordx4 v25, s[24:27], s47 offen lds
    s_mov_b32 m0, 124928
    s_nop 0
    buffer_load_dwordx4 v26, s[24:27], s47 offen lds
    s_mov_b32 m0, 125952
    s_nop 0
    buffer_load_dwordx4 v27, s[24:27], s47 offen lds
    s_waitcnt vmcnt(12)
    s_barrier
    s_mov_b32 m0, 32768
    s_mov_b32 s46, 32768
    buffer_load_dwordx4 v132, s[56:59], s46 offen lds
    s_mov_b32 m0, 33792
    s_mov_b32 s46, 33792
    buffer_load_dwordx4 v132, s[56:59], s46 offen lds
    s_mov_b32 m0, 34816
    s_mov_b32 s46, 34816
    buffer_load_dwordx4 v132, s[56:59], s46 offen lds
    s_mov_b32 m0, 35840
    s_mov_b32 s46, 35840
    buffer_load_dwordx4 v132, s[56:59], s46 offen lds
    s_mov_b32 m0, 36864
    s_mov_b32 s46, 36864
    buffer_load_dwordx4 v132, s[56:59], s46 offen lds
    s_mov_b32 m0, 37888
    s_mov_b32 s46, 37888
    buffer_load_dwordx4 v132, s[56:59], s46 offen lds
    s_mov_b32 m0, 38912
    s_mov_b32 s46, 38912
    buffer_load_dwordx4 v132, s[56:59], s46 offen lds
    s_mov_b32 m0, 39936
    s_mov_b32 s46, 39936
    buffer_load_dwordx4 v132, s[56:59], s46 offen lds
    s_mov_b32 m0, 40960
    s_mov_b32 s46, 40960
    buffer_load_dwordx4 v132, s[56:59], s46 offen lds
    s_mov_b32 m0, 41984
    s_mov_b32 s46, 41984
    buffer_load_dwordx4 v132, s[56:59], s46 offen lds
    s_mov_b32 m0, 43008
    s_mov_b32 s46, 43008
    buffer_load_dwordx4 v132, s[56:59], s46 offen lds
    s_mov_b32 m0, 44032
    s_mov_b32 s46, 44032
    buffer_load_dwordx4 v132, s[56:59], s46 offen lds
    s_mov_b32 m0, 45056
    s_mov_b32 s46, 45056
    buffer_load_dwordx4 v132, s[56:59], s46 offen lds
    s_mov_b32 m0, 46080
    s_mov_b32 s46, 46080
    buffer_load_dwordx4 v132, s[56:59], s46 offen lds
    s_mov_b32 m0, 47104
    s_mov_b32 s46, 47104
    buffer_load_dwordx4 v132, s[56:59], s46 offen lds
    s_mov_b32 m0, 48128
    s_mov_b32 s46, 48128
    buffer_load_dwordx4 v132, s[56:59], s46 offen lds
    s_waitcnt vmcnt(16)
    s_barrier
    s_waitcnt vmcnt(0)
    s_branch attn_kernel_ldone
attn_kernel_ldone:
    v_and_b32 v108, 31, v1
    v_lshrrev_b32 v109, 5, v1
    v_lshrrev_b32 v110, 2, v108
    v_and_b32 v111, 3, v108
    v_mul_u32_u24 v125, 160, v110
    v_mul_u32_u24 v111, 40, v111
    v_add_u32 v125, v125, v111
    s_mul_i32 s46, s18, 1280
    s_add_u32 s46, s46, 153600
    v_add_u32 v125, s46, v125
    v_lshl_add_u32 v126, v109, 4, v125
    v_mul_u32_u24 v139, 1280, v110
    v_add_u32 v139, v139, v111
    v_lshl_add_u32 v139, v109, 3, v139
    s_lshl_b32 s19, s17, 6
    s_lshl_b32 s46, s18, 3
    s_add_u32 s19, s19, s46
    s_mul_i32 s19, s19, 1280
    s_mul_i32 s46, s16, 160
    s_add_u32 s19, s19, s46
    v_lshlrev_b32 v136, 4, v1
    v_lshlrev_b32 v137, 3, v108
    v_mul_u32_u24 v138, 320, v109
    v_lshl_add_u32 v138, v108, 4, v138
    s_mov_b32 s40, 0x000fffff
    s_mov_b32 s41, 0x000fffff
    s_waitcnt vmcnt(0)
    v_max_f32 v108, v128, v129
    v_max_f32 v109, v130, v131
    s_nop 1
    v_max_f32_dpp v108, v108, v108 row_ror:8 row_mask:0xf bank_mask:0xf
    v_max_f32_dpp v109, v109, v109 row_ror:8 row_mask:0xf bank_mask:0xf
    s_nop 1
    v_max_f32_dpp v108, v108, v108 row_ror:4 row_mask:0xf bank_mask:0xf
    v_max_f32_dpp v109, v109, v109 row_ror:4 row_mask:0xf bank_mask:0xf
    s_nop 1
    v_max_f32_dpp v108, v108, v108 row_ror:2 row_mask:0xf bank_mask:0xf
    v_max_f32_dpp v109, v109, v109 row_ror:2 row_mask:0xf bank_mask:0xf
    s_nop 1
    v_max_f32_dpp v108, v108, v108 row_ror:1 row_mask:0xf bank_mask:0xf
    v_max_f32_dpp v109, v109, v109 row_ror:1 row_mask:0xf bank_mask:0xf
    ds_swizzle_b32 v110, v108 offset:0x401F
    ds_swizzle_b32 v111, v109 offset:0x401F
    s_waitcnt lgkmcnt(0)
    v_max_f32 v108, v108, v110
    v_mov_b32 v110, v108
    v_max_f32 v109, v109, v111
    v_mov_b32 v111, v109
    s_nop 1
    v_permlane32_swap_b32 v110, v108
    v_permlane32_swap_b32 v111, v109
    s_nop 1
    v_max_f32 v108, v108, v110
    v_max_f32 v109, v109, v111
    v_add_f32 v127, v108, v109
    s_add_u32 s32, s12, 8388608
    s_addc_u32 s33, s13, 0
    s_mov_b32 s34, 2621440
    s_mov_b32 s35, 0x00020000
    s_branch attn_kernel_qrd
attn_kernel_mm:
    s_add_u32 s36, s12, 0
    s_addc_u32 s37, s13, 0
    s_mov_b32 s38, 16384
    s_mov_b32 s39, 0x00020000
    s_lshl_b32 s46, s17, 9
    s_and_b32 s47, s18, 1
    s_lshl_b32 s47, s47, 8
    s_add_u32 s46, s46, s47
    v_lshlrev_b32 v9, 3, v3
    buffer_load_dwordx2 v[140:141], v9, s[36:39], s46 offen offset:0
    buffer_load_dwordx2 v[142:143], v9, s[36:39], s46 offen offset:128
    v_and_b32 v108, 31, v1
    v_lshrrev_b32 v109, 5, v1
    v_lshrrev_b32 v110, 2, v108
    v_and_b32 v111, 3, v108
    v_mul_u32_u24 v125, 160, v110
    v_mul_u32_u24 v111, 40, v111
    v_add_u32 v125, v125, v111
    s_mul_i32 s46, s18, 1280
    s_add_u32 s46, s46, 153600
    v_add_u32 v125, s46, v125
    v_lshl_add_u32 v126, v109, 4, v125
    v_mul_u32_u24 v139, 1280, v110
    v_add_u32 v139, v139, v111
    v_lshl_add_u32 v139, v109, 3, v139
    s_lshl_b32 s19, s17, 6
    s_lshl_b32 s46, s18, 3
    s_add_u32 s19, s19, s46
    s_mul_i32 s19, s19, 1280
    s_mul_i32 s46, s16, 160
    s_add_u32 s19, s19, s46
    v_lshlrev_b32 v136, 4, v1
    v_lshlrev_b32 v137, 3, v108
    v_mul_u32_u24 v138, 320, v109
    v_lshl_add_u32 v138, v108, 4, v138
    s_mov_b32 s40, 0x000fffff
    s_mov_b32 s41, 0x000fffff
    s_waitcnt vmcnt(2)
    v_max_f32 v108, v128, v129
    v_max_f32 v109, v130, v131
    s_nop 1
    v_max_f32_dpp v108, v108, v108 row_ror:8 row_mask:0xf bank_mask:0xf
    v_max_f32_dpp v109, v109, v109 row_ror:8 row_mask:0xf bank_mask:0xf
    s_nop 1
    v_max_f32_dpp v108, v108, v108 row_ror:4 row_mask:0xf bank_mask:0xf
    v_max_f32_dpp v109, v109, v109 row_ror:4 row_mask:0xf bank_mask:0xf
    s_nop 1
    v_max_f32_dpp v108, v108, v108 row_ror:2 row_mask:0xf bank_mask:0xf
    v_max_f32_dpp v109, v109, v109 row_ror:2 row_mask:0xf bank_mask:0xf
    s_nop 1
    v_max_f32_dpp v108, v108, v108 row_ror:1 row_mask:0xf bank_mask:0xf
    v_max_f32_dpp v109, v109, v109 row_ror:1 row_mask:0xf bank_mask:0xf
    ds_swizzle_b32 v110, v108 offset:0x401F
    ds_swizzle_b32 v111, v109 offset:0x401F
    s_waitcnt lgkmcnt(0)
    v_max_f32 v108, v108, v110
    v_mov_b32 v110, v108
    v_max_f32 v109, v109, v111
    v_mov_b32 v111, v109
    s_nop 1
    v_permlane32_swap_b32 v110, v108
    v_permlane32_swap_b32 v111, v109
    s_nop 1
    v_max_f32 v108, v108, v110
    v_max_f32 v109, v109, v111
    v_add_f32 v127, v108, v109
    s_add_u32 s32, s12, 8388608
    s_addc_u32 s33, s13, 0
    s_mov_b32 s34, 2621440
    s_mov_b32 s35, 0x00020000
    s_cmp_lt_u32 s18, 2
    s_cbranch_scc0 attn_kernel_mm1
    v_lshlrev_b32 v6, 8, v3
    v_and_b32 v7, 3, v3
    v_xor_b32 v7, v7, v4
    v_lshl_add_u32 v6, v7, 4, v6
    s_and_b32 s46, s18, 1
    s_lshl_b32 s46, s46, 13
    s_add_u32 s46, s46, 53248
    v_add_u32 v6, s46, v6
    v_and_b32 v7, 12, v3
    v_xor_b32 v8, 0, v7
    v_lshl_add_u32 v100, v8, 4, v6
    v_xor_b32 v8, 4, v7
    v_lshl_add_u32 v101, v8, 4, v6
    v_xor_b32 v8, 8, v7
    v_lshl_add_u32 v102, v8, 4, v6
    v_xor_b32 v8, 12, v7
    v_lshl_add_u32 v103, v8, 4, v6
    v_lshrrev_b32 v12, 2, v1
    v_and_b32 v12, 3, v12
    v_lshl_add_u32 v12, v4, 3, v12
    v_and_b32 v13, 3, v1
    v_mul_u32_u24 v104, 160, v12
    v_lshl_add_u32 v104, v13, 3, v104
    v_add_u32 v104, 69632, v104
    v_mov_b32 v56, 0x3f803f80
    v_mov_b32 v57, 0x3f803f80
    v_mov_b32 v58, 0x3f803f80
    v_mov_b32 v59, 0x3f803f80
    s_barrier
    ds_read_b128 v[16:19], v100 offset:0
    ds_read_b128 v[20:23], v100 offset:4096
    ds_read_b64_tr_b16 v[32:33], v104 offset:0
    ds_read_b64_tr_b16 v[34:35], v104 offset:640
    ds_read_b64_tr_b16 v[36:37], v104 offset:32
    ds_read_b64_tr_b16 v[38:39], v104 offset:672
    ds_read_b64_tr_b16 v[40:41], v104 offset:64
    ds_read_b64_tr_b16 v[42:43], v104 offset:704
    ds_read_b128 v[24:27], v101 offset:0
    ds_read_b128 v[28:31], v101 offset:4096
    ds_read_b64_tr_b16 v[44:45], v104 offset:5120
    ds_read_b64_tr_b16 v[46:47], v104 offset:5760
    ds_read_b64_tr_b16 v[48:49], v104 offset:5152
    ds_read_b64_tr_b16 v[50:51], v104 offset:5792
    ds_read_b64_tr_b16 v[52:53], v104 offset:5184
    ds_read_b64_tr_b16 v[54:55], v104 offset:5824
    s_waitcnt lgkmcnt(8)
    v_mfma_f32_16x16x32_bf16 v[64:67], v[32:35], v[16:19], 0
    v_mfma_f32_16x16x32_bf16 v[76:79], v[32:35], v[20:23], 0
    v_mfma_f32_16x16x32_bf16 v[88:91], v[32:35], v[56:59], 0
    v_mfma_f32_16x16x32_bf16 v[68:71], v[36:39], v[16:19], 0
    v_mfma_f32_16x16x32_bf16 v[80:83], v[36:39], v[20:23], 0
    v_mfma_f32_16x16x32_bf16 v[92:95], v[36:39], v[56:59], 0
    v_mfma_f32_16x16x32_bf16 v[72:75], v[40:43], v[16:19], 0
    v_mfma_f32_16x16x32_bf16 v[84:87], v[40:43], v[20:23], 0
    v_mfma_f32_16x16x32_bf16 v[96:99], v[40:43], v[56:59], 0
    ds_read_b128 v[16:19], v102 offset:0
    ds_read_b128 v[20:23], v102 offset:4096
    ds_read_b64_tr_b16 v[32:33], v104 offset:10240
    ds_read_b64_tr_b16 v[34:35], v104 offset:10880
    ds_read_b64_tr_b16 v[36:37], v104 offset:10272
    ds_read_b64_tr_b16 v[38:39], v104 offset:10912
    ds_read_b64_tr_b16 v[40:41], v104 offset:10304
    ds_read_b64_tr_b16 v[42:43], v104 offset:10944
    s_waitcnt lgkmcnt(8)
    v_mfma_f32_16x16x32_bf16 v[64:67], v[44:47], v[24:27], v[64:67]
    v_mfma_f32_16x16x32_bf16 v[76:79], v[44:47], v[28:31], v[76:79]
    v_mfma_f32_16x16x32_bf16 v[88:91], v[44:47], v[56:59], v[88:91]
    v_mfma_f32_16x16x32_bf16 v[68:71], v[48:51], v[24:27], v[68:71]
    v_mfma_f32_16x16x32_bf16 v[80:83], v[48:51], v[28:31], v[80:83]
    v_mfma_f32_16x16x32_bf16 v[92:95], v[48:51], v[56:59], v[92:95]
    v_mfma_f32_16x16x32_bf16 v[72:75], v[52:55], v[24:27], v[72:75]
    v_mfma_f32_16x16x32_bf16 v[84:87], v[52:55], v[28:31], v[84:87]
    v_mfma_f32_16x16x32_bf16 v[96:99], v[52:55], v[56:59], v[96:99]
    ds_read_b128 v[24:27], v103 offset:0
    ds_read_b128 v[28:31], v103 offset:4096
    ds_read_b64_tr_b16 v[44:45], v104 offset:15360
    ds_read_b64_tr_b16 v[46:47], v104 offset:16000
    ds_read_b64_tr_b16 v[48:49], v104 offset:15392
    ds_read_b64_tr_b16 v[50:51], v104 offset:16032
    ds_read_b64_tr_b16 v[52:53], v104 offset:15424
    ds_read_b64_tr_b16 v[54:55], v104 offset:16064
    s_waitcnt lgkmcnt(8)
    v_mfma_f32_16x16x32_bf16 v[64:67], v[32:35], v[16:19], v[64:67]
    v_mfma_f32_16x16x32_bf16 v[76:79], v[32:35], v[20:23], v[76:79]
    v_mfma_f32_16x16x32_bf16 v[88:91], v[32:35], v[56:59], v[88:91]
    v_mfma_f32_16x16x32_bf16 v[68:71], v[36:39], v[16:19], v[68:71]
    v_mfma_f32_16x16x32_bf16 v[80:83], v[36:39], v[20:23], v[80:83]
    v_mfma_f32_16x16x32_bf16 v[92:95], v[36:39], v[56:59], v[92:95]
    v_mfma_f32_16x16x32_bf16 v[72:75], v[40:43], v[16:19], v[72:75]
    v_mfma_f32_16x16x32_bf16 v[84:87], v[40:43], v[20:23], v[84:87]
    v_mfma_f32_16x16x32_bf16 v[96:99], v[40:43], v[56:59], v[96:99]
    s_waitcnt lgkmcnt(0)
    v_add_u32 v100, 36864, v100
    v_add_u32 v101, 36864, v101
    v_add_u32 v102, 36864, v102
    v_add_u32 v103, 36864, v103
    v_add_u32 v104, 36864, v104
    v_mfma_f32_16x16x32_bf16 v[64:67], v[44:47], v[24:27], v[64:67]
    v_mfma_f32_16x16x32_bf16 v[76:79], v[44:47], v[28:31], v[76:79]
    v_mfma_f32_16x16x32_bf16 v[88:91], v[44:47], v[56:59], v[88:91]
    v_mfma_f32_16x16x32_bf16 v[68:71], v[48:51], v[24:27], v[68:71]
    v_mfma_f32_16x16x32_bf16 v[80:83], v[48:51], v[28:31], v[80:83]
    v_mfma_f32_16x16x32_bf16 v[92:95], v[48:51], v[56:59], v[92:95]
    v_mfma_f32_16x16x32_bf16 v[72:75], v[52:55], v[24:27], v[72:75]
    v_mfma_f32_16x16x32_bf16 v[84:87], v[52:55], v[28:31], v[84:87]
    v_mfma_f32_16x16x32_bf16 v[96:99], v[52:55], v[56:59], v[96:99]
    s_barrier
    ds_read_b128 v[16:19], v100 offset:0
    ds_read_b128 v[20:23], v100 offset:4096
    ds_read_b64_tr_b16 v[32:33], v104 offset:0
    ds_read_b64_tr_b16 v[34:35], v104 offset:640
    ds_read_b64_tr_b16 v[36:37], v104 offset:32
    ds_read_b64_tr_b16 v[38:39], v104 offset:672
    ds_read_b64_tr_b16 v[40:41], v104 offset:64
    ds_read_b64_tr_b16 v[42:43], v104 offset:704
    ds_read_b128 v[24:27], v101 offset:0
    ds_read_b128 v[28:31], v101 offset:4096
    ds_read_b64_tr_b16 v[44:45], v104 offset:5120
    ds_read_b64_tr_b16 v[46:47], v104 offset:5760
    ds_read_b64_tr_b16 v[48:49], v104 offset:5152
    ds_read_b64_tr_b16 v[50:51], v104 offset:5792
    ds_read_b64_tr_b16 v[52:53], v104 offset:5184
    ds_read_b64_tr_b16 v[54:55], v104 offset:5824
    s_waitcnt lgkmcnt(8)
    v_mfma_f32_16x16x32_bf16 v[64:67], v[32:35], v[16:19], v[64:67]
    v_mfma_f32_16x16x32_bf16 v[76:79], v[32:35], v[20:23], v[76:79]
    v_mfma_f32_16x16x32_bf16 v[88:91], v[32:35], v[56:59], v[88:91]
    v_mfma_f32_16x16x32_bf16 v[68:71], v[36:39], v[16:19], v[68:71]
    v_mfma_f32_16x16x32_bf16 v[80:83], v[36:39], v[20:23], v[80:83]
    v_mfma_f32_16x16x32_bf16 v[92:95], v[36:39], v[56:59], v[92:95]
    v_mfma_f32_16x16x32_bf16 v[72:75], v[40:43], v[16:19], v[72:75]
    v_mfma_f32_16x16x32_bf16 v[84:87], v[40:43], v[20:23], v[84:87]
    v_mfma_f32_16x16x32_bf16 v[96:99], v[40:43], v[56:59], v[96:99]
    ds_read_b128 v[16:19], v102 offset:0
    ds_read_b128 v[20:23], v102 offset:4096
    ds_read_b64_tr_b16 v[32:33], v104 offset:10240
    ds_read_b64_tr_b16 v[34:35], v104 offset:10880
    ds_read_b64_tr_b16 v[36:37], v104 offset:10272
    ds_read_b64_tr_b16 v[38:39], v104 offset:10912
    ds_read_b64_tr_b16 v[40:41], v104 offset:10304
    ds_read_b64_tr_b16 v[42:43], v104 offset:10944
    s_waitcnt lgkmcnt(8)
    v_mfma_f32_16x16x32_bf16 v[64:67], v[44:47], v[24:27], v[64:67]
    v_mfma_f32_16x16x32_bf16 v[76:79], v[44:47], v[28:31], v[76:79]
    v_mfma_f32_16x16x32_bf16 v[88:91], v[44:47], v[56:59], v[88:91]
    v_mfma_f32_16x16x32_bf16 v[68:71], v[48:51], v[24:27], v[68:71]
    v_mfma_f32_16x16x32_bf16 v[80:83], v[48:51], v[28:31], v[80:83]
    v_mfma_f32_16x16x32_bf16 v[92:95], v[48:51], v[56:59], v[92:95]
    v_mfma_f32_16x16x32_bf16 v[72:75], v[52:55], v[24:27], v[72:75]
    v_mfma_f32_16x16x32_bf16 v[84:87], v[52:55], v[28:31], v[84:87]
    v_mfma_f32_16x16x32_bf16 v[96:99], v[52:55], v[56:59], v[96:99]
    ds_read_b128 v[24:27], v103 offset:0
    ds_read_b128 v[28:31], v103 offset:4096
    ds_read_b64_tr_b16 v[44:45], v104 offset:15360
    ds_read_b64_tr_b16 v[46:47], v104 offset:16000
    ds_read_b64_tr_b16 v[48:49], v104 offset:15392
    ds_read_b64_tr_b16 v[50:51], v104 offset:16032
    ds_read_b64_tr_b16 v[52:53], v104 offset:15424
    ds_read_b64_tr_b16 v[54:55], v104 offset:16064
    s_waitcnt lgkmcnt(8)
    v_mfma_f32_16x16x32_bf16 v[64:67], v[32:35], v[16:19], v[64:67]
    v_mfma_f32_16x16x32_bf16 v[76:79], v[32:35], v[20:23], v[76:79]
    v_mfma_f32_16x16x32_bf16 v[88:91], v[32:35], v[56:59], v[88:91]
    v_mfma_f32_16x16x32_bf16 v[68:71], v[36:39], v[16:19], v[68:71]
    v_mfma_f32_16x16x32_bf16 v[80:83], v[36:39], v[20:23], v[80:83]
    v_mfma_f32_16x16x32_bf16 v[92:95], v[36:39], v[56:59], v[92:95]
    v_mfma_f32_16x16x32_bf16 v[72:75], v[40:43], v[16:19], v[72:75]
    v_mfma_f32_16x16x32_bf16 v[84:87], v[40:43], v[20:23], v[84:87]
    v_mfma_f32_16x16x32_bf16 v[96:99], v[40:43], v[56:59], v[96:99]
    s_waitcnt lgkmcnt(0)
    v_add_u32 v100, 36864, v100
    v_add_u32 v101, 36864, v101
    v_add_u32 v102, 36864, v102
    v_add_u32 v103, 36864, v103
    v_add_u32 v104, 36864, v104
    v_mfma_f32_16x16x32_bf16 v[64:67], v[44:47], v[24:27], v[64:67]
    v_mfma_f32_16x16x32_bf16 v[76:79], v[44:47], v[28:31], v[76:79]
    v_mfma_f32_16x16x32_bf16 v[88:91], v[44:47], v[56:59], v[88:91]
    v_mfma_f32_16x16x32_bf16 v[68:71], v[48:51], v[24:27], v[68:71]
    v_mfma_f32_16x16x32_bf16 v[80:83], v[48:51], v[28:31], v[80:83]
    v_mfma_f32_16x16x32_bf16 v[92:95], v[48:51], v[56:59], v[92:95]
    v_mfma_f32_16x16x32_bf16 v[72:75], v[52:55], v[24:27], v[72:75]
    v_mfma_f32_16x16x32_bf16 v[84:87], v[52:55], v[28:31], v[84:87]
    v_mfma_f32_16x16x32_bf16 v[96:99], v[52:55], v[56:59], v[96:99]
    s_barrier
    ds_read_b128 v[16:19], v100 offset:0
    ds_read_b128 v[20:23], v100 offset:4096
    ds_read_b64_tr_b16 v[32:33], v104 offset:0
    ds_read_b64_tr_b16 v[34:35], v104 offset:640
    ds_read_b64_tr_b16 v[36:37], v104 offset:32
    ds_read_b64_tr_b16 v[38:39], v104 offset:672
    ds_read_b64_tr_b16 v[40:41], v104 offset:64
    ds_read_b64_tr_b16 v[42:43], v104 offset:704
    ds_read_b128 v[24:27], v101 offset:0
    ds_read_b128 v[28:31], v101 offset:4096
    ds_read_b64_tr_b16 v[44:45], v104 offset:5120
    ds_read_b64_tr_b16 v[46:47], v104 offset:5760
    ds_read_b64_tr_b16 v[48:49], v104 offset:5152
    ds_read_b64_tr_b16 v[50:51], v104 offset:5792
    ds_read_b64_tr_b16 v[52:53], v104 offset:5184
    ds_read_b64_tr_b16 v[54:55], v104 offset:5824
    s_waitcnt lgkmcnt(8)
    v_mfma_f32_16x16x32_bf16 v[64:67], v[32:35], v[16:19], v[64:67]
    v_mfma_f32_16x16x32_bf16 v[76:79], v[32:35], v[20:23], v[76:79]
    v_mfma_f32_16x16x32_bf16 v[88:91], v[32:35], v[56:59], v[88:91]
    v_mfma_f32_16x16x32_bf16 v[68:71], v[36:39], v[16:19], v[68:71]
    v_mfma_f32_16x16x32_bf16 v[80:83], v[36:39], v[20:23], v[80:83]
    v_mfma_f32_16x16x32_bf16 v[92:95], v[36:39], v[56:59], v[92:95]
    v_mfma_f32_16x16x32_bf16 v[72:75], v[40:43], v[16:19], v[72:75]
    v_mfma_f32_16x16x32_bf16 v[84:87], v[40:43], v[20:23], v[84:87]
    v_mfma_f32_16x16x32_bf16 v[96:99], v[40:43], v[56:59], v[96:99]
    ds_read_b128 v[16:19], v102 offset:0
    ds_read_b128 v[20:23], v102 offset:4096
    ds_read_b64_tr_b16 v[32:33], v104 offset:10240
    ds_read_b64_tr_b16 v[34:35], v104 offset:10880
    ds_read_b64_tr_b16 v[36:37], v104 offset:10272
    ds_read_b64_tr_b16 v[38:39], v104 offset:10912
    ds_read_b64_tr_b16 v[40:41], v104 offset:10304
    ds_read_b64_tr_b16 v[42:43], v104 offset:10944
    s_waitcnt lgkmcnt(8)
    v_mfma_f32_16x16x32_bf16 v[64:67], v[44:47], v[24:27], v[64:67]
    v_mfma_f32_16x16x32_bf16 v[76:79], v[44:47], v[28:31], v[76:79]
    v_mfma_f32_16x16x32_bf16 v[88:91], v[44:47], v[56:59], v[88:91]
    v_mfma_f32_16x16x32_bf16 v[68:71], v[48:51], v[24:27], v[68:71]
    v_mfma_f32_16x16x32_bf16 v[80:83], v[48:51], v[28:31], v[80:83]
    v_mfma_f32_16x16x32_bf16 v[92:95], v[48:51], v[56:59], v[92:95]
    v_mfma_f32_16x16x32_bf16 v[72:75], v[52:55], v[24:27], v[72:75]
    v_mfma_f32_16x16x32_bf16 v[84:87], v[52:55], v[28:31], v[84:87]
    v_mfma_f32_16x16x32_bf16 v[96:99], v[52:55], v[56:59], v[96:99]
    ds_read_b128 v[24:27], v103 offset:0
    ds_read_b128 v[28:31], v103 offset:4096
    ds_read_b64_tr_b16 v[44:45], v104 offset:15360
    ds_read_b64_tr_b16 v[46:47], v104 offset:16000
    ds_read_b64_tr_b16 v[48:49], v104 offset:15392
    ds_read_b64_tr_b16 v[50:51], v104 offset:16032
    ds_read_b64_tr_b16 v[52:53], v104 offset:15424
    ds_read_b64_tr_b16 v[54:55], v104 offset:16064
    s_waitcnt lgkmcnt(8)
    v_mfma_f32_16x16x32_bf16 v[64:67], v[32:35], v[16:19], v[64:67]
    v_mfma_f32_16x16x32_bf16 v[76:79], v[32:35], v[20:23], v[76:79]
    v_mfma_f32_16x16x32_bf16 v[88:91], v[32:35], v[56:59], v[88:91]
    v_mfma_f32_16x16x32_bf16 v[68:71], v[36:39], v[16:19], v[68:71]
    v_mfma_f32_16x16x32_bf16 v[80:83], v[36:39], v[20:23], v[80:83]
    v_mfma_f32_16x16x32_bf16 v[92:95], v[36:39], v[56:59], v[92:95]
    v_mfma_f32_16x16x32_bf16 v[72:75], v[40:43], v[16:19], v[72:75]
    v_mfma_f32_16x16x32_bf16 v[84:87], v[40:43], v[20:23], v[84:87]
    v_mfma_f32_16x16x32_bf16 v[96:99], v[40:43], v[56:59], v[96:99]
    s_waitcnt lgkmcnt(0)
    v_add_u32 v100, 4294893568, v100
    v_add_u32 v101, 4294893568, v101
    v_add_u32 v102, 4294893568, v102
    v_add_u32 v103, 4294893568, v103
    v_add_u32 v104, 4294893568, v104
    v_mfma_f32_16x16x32_bf16 v[64:67], v[44:47], v[24:27], v[64:67]
    v_mfma_f32_16x16x32_bf16 v[76:79], v[44:47], v[28:31], v[76:79]
    v_mfma_f32_16x16x32_bf16 v[88:91], v[44:47], v[56:59], v[88:91]
    v_mfma_f32_16x16x32_bf16 v[68:71], v[48:51], v[24:27], v[68:71]
    v_mfma_f32_16x16x32_bf16 v[80:83], v[48:51], v[28:31], v[80:83]
    v_mfma_f32_16x16x32_bf16 v[92:95], v[48:51], v[56:59], v[92:95]
    v_mfma_f32_16x16x32_bf16 v[72:75], v[52:55], v[24:27], v[72:75]
    v_mfma_f32_16x16x32_bf16 v[84:87], v[52:55], v[28:31], v[84:87]
    v_mfma_f32_16x16x32_bf16 v[96:99], v[52:55], v[56:59], v[96:99]
    s_barrier
    ds_read_b128 v[16:19], v100 offset:0
    ds_read_b128 v[20:23], v100 offset:4096
    ds_read_b64_tr_b16 v[32:33], v104 offset:0
    ds_read_b64_tr_b16 v[34:35], v104 offset:640
    ds_read_b64_tr_b16 v[36:37], v104 offset:32
    ds_read_b64_tr_b16 v[38:39], v104 offset:672
    ds_read_b64_tr_b16 v[40:41], v104 offset:64
    ds_read_b64_tr_b16 v[42:43], v104 offset:704
    ds_read_b128 v[24:27], v101 offset:0
    ds_read_b128 v[28:31], v101 offset:4096
    ds_read_b64_tr_b16 v[44:45], v104 offset:5120
    ds_read_b64_tr_b16 v[46:47], v104 offset:5760
    ds_read_b64_tr_b16 v[48:49], v104 offset:5152
    ds_read_b64_tr_b16 v[50:51], v104 offset:5792
    ds_read_b64_tr_b16 v[52:53], v104 offset:5184
    ds_read_b64_tr_b16 v[54:55], v104 offset:5824
    s_waitcnt lgkmcnt(8)
    v_mfma_f32_16x16x32_bf16 v[64:67], v[32:35], v[16:19], v[64:67]
    v_mfma_f32_16x16x32_bf16 v[76:79], v[32:35], v[20:23], v[76:79]
    v_mfma_f32_16x16x32_bf16 v[88:91], v[32:35], v[56:59], v[88:91]
    v_mfma_f32_16x16x32_bf16 v[68:71], v[36:39], v[16:19], v[68:71]
    v_mfma_f32_16x16x32_bf16 v[80:83], v[36:39], v[20:23], v[80:83]
    v_mfma_f32_16x16x32_bf16 v[92:95], v[36:39], v[56:59], v[92:95]
    v_mfma_f32_16x16x32_bf16 v[72:75], v[40:43], v[16:19], v[72:75]
    v_mfma_f32_16x16x32_bf16 v[84:87], v[40:43], v[20:23], v[84:87]
    v_mfma_f32_16x16x32_bf16 v[96:99], v[40:43], v[56:59], v[96:99]
    ds_read_b128 v[16:19], v102 offset:0
    ds_read_b128 v[20:23], v102 offset:4096
    ds_read_b64_tr_b16 v[32:33], v104 offset:10240
    ds_read_b64_tr_b16 v[34:35], v104 offset:10880
    ds_read_b64_tr_b16 v[36:37], v104 offset:10272
    ds_read_b64_tr_b16 v[38:39], v104 offset:10912
    ds_read_b64_tr_b16 v[40:41], v104 offset:10304
    ds_read_b64_tr_b16 v[42:43], v104 offset:10944
    s_waitcnt lgkmcnt(8)
    v_mfma_f32_16x16x32_bf16 v[64:67], v[44:47], v[24:27], v[64:67]
    v_mfma_f32_16x16x32_bf16 v[76:79], v[44:47], v[28:31], v[76:79]
    v_mfma_f32_16x16x32_bf16 v[88:91], v[44:47], v[56:59], v[88:91]
    v_mfma_f32_16x16x32_bf16 v[68:71], v[48:51], v[24:27], v[68:71]
    v_mfma_f32_16x16x32_bf16 v[80:83], v[48:51], v[28:31], v[80:83]
    v_mfma_f32_16x16x32_bf16 v[92:95], v[48:51], v[56:59], v[92:95]
    v_mfma_f32_16x16x32_bf16 v[72:75], v[52:55], v[24:27], v[72:75]
    v_mfma_f32_16x16x32_bf16 v[84:87], v[52:55], v[28:31], v[84:87]
    v_mfma_f32_16x16x32_bf16 v[96:99], v[52:55], v[56:59], v[96:99]
    ds_read_b128 v[24:27], v103 offset:0
    ds_read_b128 v[28:31], v103 offset:4096
    ds_read_b64_tr_b16 v[44:45], v104 offset:15360
    ds_read_b64_tr_b16 v[46:47], v104 offset:16000
    ds_read_b64_tr_b16 v[48:49], v104 offset:15392
    ds_read_b64_tr_b16 v[50:51], v104 offset:16032
    ds_read_b64_tr_b16 v[52:53], v104 offset:15424
    ds_read_b64_tr_b16 v[54:55], v104 offset:16064
    s_waitcnt lgkmcnt(8)
    v_mfma_f32_16x16x32_bf16 v[64:67], v[32:35], v[16:19], v[64:67]
    v_mfma_f32_16x16x32_bf16 v[76:79], v[32:35], v[20:23], v[76:79]
    v_mfma_f32_16x16x32_bf16 v[88:91], v[32:35], v[56:59], v[88:91]
    v_mfma_f32_16x16x32_bf16 v[68:71], v[36:39], v[16:19], v[68:71]
    v_mfma_f32_16x16x32_bf16 v[80:83], v[36:39], v[20:23], v[80:83]
    v_mfma_f32_16x16x32_bf16 v[92:95], v[36:39], v[56:59], v[92:95]
    v_mfma_f32_16x16x32_bf16 v[72:75], v[40:43], v[16:19], v[72:75]
    v_mfma_f32_16x16x32_bf16 v[84:87], v[40:43], v[20:23], v[84:87]
    v_mfma_f32_16x16x32_bf16 v[96:99], v[40:43], v[56:59], v[96:99]
    s_waitcnt lgkmcnt(0)
    v_add_u32 v100, 36864, v100
    v_add_u32 v101, 36864, v101
    v_add_u32 v102, 36864, v102
    v_add_u32 v103, 36864, v103
    v_add_u32 v104, 36864, v104
    v_mfma_f32_16x16x32_bf16 v[64:67], v[44:47], v[24:27], v[64:67]
    v_mfma_f32_16x16x32_bf16 v[76:79], v[44:47], v[28:31], v[76:79]
    v_mfma_f32_16x16x32_bf16 v[88:91], v[44:47], v[56:59], v[88:91]
    v_mfma_f32_16x16x32_bf16 v[68:71], v[48:51], v[24:27], v[68:71]
    v_mfma_f32_16x16x32_bf16 v[80:83], v[48:51], v[28:31], v[80:83]
    v_mfma_f32_16x16x32_bf16 v[92:95], v[48:51], v[56:59], v[92:95]
    v_mfma_f32_16x16x32_bf16 v[72:75], v[52:55], v[24:27], v[72:75]
    v_mfma_f32_16x16x32_bf16 v[84:87], v[52:55], v[28:31], v[84:87]
    v_mfma_f32_16x16x32_bf16 v[96:99], v[52:55], v[56:59], v[96:99]
    s_barrier
    ds_read_b128 v[16:19], v100 offset:0
    ds_read_b128 v[20:23], v100 offset:4096
    ds_read_b64_tr_b16 v[32:33], v104 offset:0
    ds_read_b64_tr_b16 v[34:35], v104 offset:640
    ds_read_b64_tr_b16 v[36:37], v104 offset:32
    ds_read_b64_tr_b16 v[38:39], v104 offset:672
    ds_read_b64_tr_b16 v[40:41], v104 offset:64
    ds_read_b64_tr_b16 v[42:43], v104 offset:704
    ds_read_b128 v[24:27], v101 offset:0
    ds_read_b128 v[28:31], v101 offset:4096
    ds_read_b64_tr_b16 v[44:45], v104 offset:5120
    ds_read_b64_tr_b16 v[46:47], v104 offset:5760
    ds_read_b64_tr_b16 v[48:49], v104 offset:5152
    ds_read_b64_tr_b16 v[50:51], v104 offset:5792
    ds_read_b64_tr_b16 v[52:53], v104 offset:5184
    ds_read_b64_tr_b16 v[54:55], v104 offset:5824
    s_waitcnt lgkmcnt(8)
    v_mfma_f32_16x16x32_bf16 v[64:67], v[32:35], v[16:19], v[64:67]
    v_mfma_f32_16x16x32_bf16 v[76:79], v[32:35], v[20:23], v[76:79]
    v_mfma_f32_16x16x32_bf16 v[88:91], v[32:35], v[56:59], v[88:91]
    v_mfma_f32_16x16x32_bf16 v[68:71], v[36:39], v[16:19], v[68:71]
    v_mfma_f32_16x16x32_bf16 v[80:83], v[36:39], v[20:23], v[80:83]
    v_mfma_f32_16x16x32_bf16 v[92:95], v[36:39], v[56:59], v[92:95]
    v_mfma_f32_16x16x32_bf16 v[72:75], v[40:43], v[16:19], v[72:75]
    v_mfma_f32_16x16x32_bf16 v[84:87], v[40:43], v[20:23], v[84:87]
    v_mfma_f32_16x16x32_bf16 v[96:99], v[40:43], v[56:59], v[96:99]
    ds_read_b128 v[16:19], v102 offset:0
    ds_read_b128 v[20:23], v102 offset:4096
    ds_read_b64_tr_b16 v[32:33], v104 offset:10240
    ds_read_b64_tr_b16 v[34:35], v104 offset:10880
    ds_read_b64_tr_b16 v[36:37], v104 offset:10272
    ds_read_b64_tr_b16 v[38:39], v104 offset:10912
    ds_read_b64_tr_b16 v[40:41], v104 offset:10304
    ds_read_b64_tr_b16 v[42:43], v104 offset:10944
    s_waitcnt lgkmcnt(8)
    v_mfma_f32_16x16x32_bf16 v[64:67], v[44:47], v[24:27], v[64:67]
    v_mfma_f32_16x16x32_bf16 v[76:79], v[44:47], v[28:31], v[76:79]
    v_mfma_f32_16x16x32_bf16 v[88:91], v[44:47], v[56:59], v[88:91]
    v_mfma_f32_16x16x32_bf16 v[68:71], v[48:51], v[24:27], v[68:71]
    v_mfma_f32_16x16x32_bf16 v[80:83], v[48:51], v[28:31], v[80:83]
    v_mfma_f32_16x16x32_bf16 v[92:95], v[48:51], v[56:59], v[92:95]
    v_mfma_f32_16x16x32_bf16 v[72:75], v[52:55], v[24:27], v[72:75]
    v_mfma_f32_16x16x32_bf16 v[84:87], v[52:55], v[28:31], v[84:87]
    v_mfma_f32_16x16x32_bf16 v[96:99], v[52:55], v[56:59], v[96:99]
    ds_read_b128 v[24:27], v103 offset:0
    ds_read_b128 v[28:31], v103 offset:4096
    ds_read_b64_tr_b16 v[44:45], v104 offset:15360
    ds_read_b64_tr_b16 v[46:47], v104 offset:16000
    ds_read_b64_tr_b16 v[48:49], v104 offset:15392
    ds_read_b64_tr_b16 v[50:51], v104 offset:16032
    ds_read_b64_tr_b16 v[52:53], v104 offset:15424
    ds_read_b64_tr_b16 v[54:55], v104 offset:16064
    s_waitcnt lgkmcnt(8)
    v_mfma_f32_16x16x32_bf16 v[64:67], v[32:35], v[16:19], v[64:67]
    v_mfma_f32_16x16x32_bf16 v[76:79], v[32:35], v[20:23], v[76:79]
    v_mfma_f32_16x16x32_bf16 v[88:91], v[32:35], v[56:59], v[88:91]
    v_mfma_f32_16x16x32_bf16 v[68:71], v[36:39], v[16:19], v[68:71]
    v_mfma_f32_16x16x32_bf16 v[80:83], v[36:39], v[20:23], v[80:83]
    v_mfma_f32_16x16x32_bf16 v[92:95], v[36:39], v[56:59], v[92:95]
    v_mfma_f32_16x16x32_bf16 v[72:75], v[40:43], v[16:19], v[72:75]
    v_mfma_f32_16x16x32_bf16 v[84:87], v[40:43], v[20:23], v[84:87]
    v_mfma_f32_16x16x32_bf16 v[96:99], v[40:43], v[56:59], v[96:99]
    s_waitcnt lgkmcnt(0)
    v_mfma_f32_16x16x32_bf16 v[64:67], v[44:47], v[24:27], v[64:67]
    v_mfma_f32_16x16x32_bf16 v[76:79], v[44:47], v[28:31], v[76:79]
    v_mfma_f32_16x16x32_bf16 v[88:91], v[44:47], v[56:59], v[88:91]
    v_mfma_f32_16x16x32_bf16 v[68:71], v[48:51], v[24:27], v[68:71]
    v_mfma_f32_16x16x32_bf16 v[80:83], v[48:51], v[28:31], v[80:83]
    v_mfma_f32_16x16x32_bf16 v[92:95], v[48:51], v[56:59], v[92:95]
    v_mfma_f32_16x16x32_bf16 v[72:75], v[52:55], v[24:27], v[72:75]
    v_mfma_f32_16x16x32_bf16 v[84:87], v[52:55], v[28:31], v[84:87]
    v_mfma_f32_16x16x32_bf16 v[96:99], v[52:55], v[56:59], v[96:99]
    v_mul_u32_u24 v10, 160, v3
    v_lshl_add_u32 v10, v4, 3, v10
    s_and_b32 s46, s18, 1
    s_mul_i32 s46, s46, 5120
    s_add_u32 s46, s46, 153600
    v_add_u32 v10, s46, v10
    s_waitcnt vmcnt(0)
    s_nop 3
    v_mul_f32 v14, 0x3ea52b5c, v141
    v_mul_f32 v15, 0x3ea52b5c, v140
    v_mul_f32 v64, v64, v14
    v_fma_f32 v64, -v88, v15, v64
    v_mul_f32 v65, v65, v14
    v_fma_f32 v65, -v89, v15, v65
    v_mul_f32 v66, v66, v14
    v_fma_f32 v66, -v90, v15, v66
    v_mul_f32 v67, v67, v14
    v_fma_f32 v67, -v91, v15, v67
    v_cvt_pk_bf16_f32 v64, v64, v65
    v_cvt_pk_bf16_f32 v65, v66, v67
    ds_write_b64 v10, v[64:65] offset:0
    v_mul_f32 v68, v68, v14
    v_fma_f32 v68, -v92, v15, v68
    v_mul_f32 v69, v69, v14
    v_fma_f32 v69, -v93, v15, v69
    v_mul_f32 v70, v70, v14
    v_fma_f32 v70, -v94, v15, v70
    v_mul_f32 v71, v71, v14
    v_fma_f32 v71, -v95, v15, v71
    v_cvt_pk_bf16_f32 v68, v68, v69
    v_cvt_pk_bf16_f32 v69, v70, v71
    ds_write_b64 v10, v[68:69] offset:32
    v_mul_f32 v72, v72, v14
    v_fma_f32 v72, -v96, v15, v72
    v_mul_f32 v73, v73, v14
    v_fma_f32 v73, -v97, v15, v73
    v_mul_f32 v74, v74, v14
    v_fma_f32 v74, -v98, v15, v74
    v_mul_f32 v75, v75, v14
    v_fma_f32 v75, -v99, v15, v75
    v_cvt_pk_bf16_f32 v72, v72, v73
    v_cvt_pk_bf16_f32 v73, v74, v75
    ds_write_b64 v10, v[72:73] offset:64
    v_mul_f32 v14, 0x3ea52b5c, v143
    v_mul_f32 v15, 0x3ea52b5c, v142
    v_mul_f32 v76, v76, v14
    v_fma_f32 v76, -v88, v15, v76
    v_mul_f32 v77, v77, v14
    v_fma_f32 v77, -v89, v15, v77
    v_mul_f32 v78, v78, v14
    v_fma_f32 v78, -v90, v15, v78
    v_mul_f32 v79, v79, v14
    v_fma_f32 v79, -v91, v15, v79
    v_cvt_pk_bf16_f32 v76, v76, v77
    v_cvt_pk_bf16_f32 v77, v78, v79
    ds_write_b64 v10, v[76:77] offset:2560
    v_mul_f32 v80, v80, v14
    v_fma_f32 v80, -v92, v15, v80
    v_mul_f32 v81, v81, v14
    v_fma_f32 v81, -v93, v15, v81
    v_mul_f32 v82, v82, v14
    v_fma_f32 v82, -v94, v15, v82
    v_mul_f32 v83, v83, v14
    v_fma_f32 v83, -v95, v15, v83
    v_cvt_pk_bf16_f32 v80, v80, v81
    v_cvt_pk_bf16_f32 v81, v82, v83
    ds_write_b64 v10, v[80:81] offset:2592
    v_mul_f32 v84, v84, v14
    v_fma_f32 v84, -v96, v15, v84
    v_mul_f32 v85, v85, v14
    v_fma_f32 v85, -v97, v15, v85
    v_mul_f32 v86, v86, v14
    v_fma_f32 v86, -v98, v15, v86
    v_mul_f32 v87, v87, v14
    v_fma_f32 v87, -v99, v15, v87
    v_cvt_pk_bf16_f32 v84, v84, v85
    v_cvt_pk_bf16_f32 v85, v86, v87
    ds_write_b64 v10, v[84:85] offset:2624
    s_waitcnt lgkmcnt(0)
    s_branch attn_kernel_qrd
attn_kernel_mm1:
    v_lshlrev_b32 v6, 8, v3
    v_and_b32 v7, 3, v3
    v_xor_b32 v7, v7, v4
    v_lshl_add_u32 v6, v7, 4, v6
    s_and_b32 s46, s18, 1
    s_lshl_b32 s46, s46, 13
    s_add_u32 s46, s46, 53248
    v_add_u32 v6, s46, v6
    v_and_b32 v7, 12, v3
    v_xor_b32 v8, 0, v7
    v_lshl_add_u32 v100, v8, 4, v6
    v_xor_b32 v8, 4, v7
    v_lshl_add_u32 v101, v8, 4, v6
    v_xor_b32 v8, 8, v7
    v_lshl_add_u32 v102, v8, 4, v6
    v_xor_b32 v8, 12, v7
    v_lshl_add_u32 v103, v8, 4, v6
    v_lshrrev_b32 v12, 2, v1
    v_and_b32 v12, 3, v12
    v_lshl_add_u32 v12, v4, 3, v12
    v_and_b32 v13, 3, v1
    v_mul_u32_u24 v104, 160, v12
    v_lshl_add_u32 v104, v13, 3, v104
    v_add_u32 v104, 69632, v104
    v_mov_b32 v56, 0x3f803f80
    v_mov_b32 v57, 0x3f803f80
    v_mov_b32 v58, 0x3f803f80
    v_mov_b32 v59, 0x3f803f80
    s_barrier
    ds_read_b128 v[16:19], v100 offset:0
    ds_read_b128 v[20:23], v100 offset:4096
    ds_read_b64_tr_b16 v[32:33], v104 offset:96
    ds_read_b64_tr_b16 v[34:35], v104 offset:736
    ds_read_b64_tr_b16 v[36:37], v104 offset:128
    ds_read_b64_tr_b16 v[38:39], v104 offset:768
    ds_read_b128 v[24:27], v101 offset:0
    ds_read_b128 v[28:31], v101 offset:4096
    ds_read_b64_tr_b16 v[44:45], v104 offset:5216
    ds_read_b64_tr_b16 v[46:47], v104 offset:5856
    ds_read_b64_tr_b16 v[48:49], v104 offset:5248
    ds_read_b64_tr_b16 v[50:51], v104 offset:5888
    s_waitcnt lgkmcnt(6)
    v_mfma_f32_16x16x32_bf16 v[64:67], v[32:35], v[16:19], 0
    v_mfma_f32_16x16x32_bf16 v[76:79], v[32:35], v[20:23], 0
    v_mfma_f32_16x16x32_bf16 v[88:91], v[32:35], v[56:59], 0
    v_mfma_f32_16x16x32_bf16 v[68:71], v[36:39], v[16:19], 0
    v_mfma_f32_16x16x32_bf16 v[80:83], v[36:39], v[20:23], 0
    v_mfma_f32_16x16x32_bf16 v[92:95], v[36:39], v[56:59], 0
    ds_read_b128 v[16:19], v102 offset:0
    ds_read_b128 v[20:23], v102 offset:4096
    ds_read_b64_tr_b16 v[32:33], v104 offset:10336
    ds_read_b64_tr_b16 v[34:35], v104 offset:10976
    ds_read_b64_tr_b16 v[36:37], v104 offset:10368
    ds_read_b64_tr_b16 v[38:39], v104 offset:11008
    s_waitcnt lgkmcnt(6)
    v_mfma_f32_16x16x32_bf16 v[64:67], v[44:47], v[24:27], v[64:67]
    v_mfma_f32_16x16x32_bf16 v[76:79], v[44:47], v[28:31], v[76:79]
    v_mfma_f32_16x16x32_bf16 v[88:91], v[44:47], v[56:59], v[88:91]
    v_mfma_f32_16x16x32_bf16 v[68:71], v[48:51], v[24:27], v[68:71]
    v_mfma_f32_16x16x32_bf16 v[80:83], v[48:51], v[28:31], v[80:83]
    v_mfma_f32_16x16x32_bf16 v[92:95], v[48:51], v[56:59], v[92:95]
    ds_read_b128 v[24:27], v103 offset:0
    ds_read_b128 v[28:31], v103 offset:4096
    ds_read_b64_tr_b16 v[44:45], v104 offset:15456
    ds_read_b64_tr_b16 v[46:47], v104 offset:16096
    ds_read_b64_tr_b16 v[48:49], v104 offset:15488
    ds_read_b64_tr_b16 v[50:51], v104 offset:16128
    s_waitcnt lgkmcnt(6)
    v_mfma_f32_16x16x32_bf16 v[64:67], v[32:35], v[16:19], v[64:67]
    v_mfma_f32_16x16x32_bf16 v[76:79], v[32:35], v[20:23], v[76:79]
    v_mfma_f32_16x16x32_bf16 v[88:91], v[32:35], v[56:59], v[88:91]
    v_mfma_f32_16x16x32_bf16 v[68:71], v[36:39], v[16:19], v[68:71]
    v_mfma_f32_16x16x32_bf16 v[80:83], v[36:39], v[20:23], v[80:83]
    v_mfma_f32_16x16x32_bf16 v[92:95], v[36:39], v[56:59], v[92:95]
    s_waitcnt lgkmcnt(0)
    v_add_u32 v100, 36864, v100
    v_add_u32 v101, 36864, v101
    v_add_u32 v102, 36864, v102
    v_add_u32 v103, 36864, v103
    v_add_u32 v104, 36864, v104
    v_mfma_f32_16x16x32_bf16 v[64:67], v[44:47], v[24:27], v[64:67]
    v_mfma_f32_16x16x32_bf16 v[76:79], v[44:47], v[28:31], v[76:79]
    v_mfma_f32_16x16x32_bf16 v[88:91], v[44:47], v[56:59], v[88:91]
    v_mfma_f32_16x16x32_bf16 v[68:71], v[48:51], v[24:27], v[68:71]
    v_mfma_f32_16x16x32_bf16 v[80:83], v[48:51], v[28:31], v[80:83]
    v_mfma_f32_16x16x32_bf16 v[92:95], v[48:51], v[56:59], v[92:95]
    s_barrier
    ds_read_b128 v[16:19], v100 offset:0
    ds_read_b128 v[20:23], v100 offset:4096
    ds_read_b64_tr_b16 v[32:33], v104 offset:96
    ds_read_b64_tr_b16 v[34:35], v104 offset:736
    ds_read_b64_tr_b16 v[36:37], v104 offset:128
    ds_read_b64_tr_b16 v[38:39], v104 offset:768
    ds_read_b128 v[24:27], v101 offset:0
    ds_read_b128 v[28:31], v101 offset:4096
    ds_read_b64_tr_b16 v[44:45], v104 offset:5216
    ds_read_b64_tr_b16 v[46:47], v104 offset:5856
    ds_read_b64_tr_b16 v[48:49], v104 offset:5248
    ds_read_b64_tr_b16 v[50:51], v104 offset:5888
    s_waitcnt lgkmcnt(6)
    v_mfma_f32_16x16x32_bf16 v[64:67], v[32:35], v[16:19], v[64:67]
    v_mfma_f32_16x16x32_bf16 v[76:79], v[32:35], v[20:23], v[76:79]
    v_mfma_f32_16x16x32_bf16 v[88:91], v[32:35], v[56:59], v[88:91]
    v_mfma_f32_16x16x32_bf16 v[68:71], v[36:39], v[16:19], v[68:71]
    v_mfma_f32_16x16x32_bf16 v[80:83], v[36:39], v[20:23], v[80:83]
    v_mfma_f32_16x16x32_bf16 v[92:95], v[36:39], v[56:59], v[92:95]
    ds_read_b128 v[16:19], v102 offset:0
    ds_read_b128 v[20:23], v102 offset:4096
    ds_read_b64_tr_b16 v[32:33], v104 offset:10336
    ds_read_b64_tr_b16 v[34:35], v104 offset:10976
    ds_read_b64_tr_b16 v[36:37], v104 offset:10368
    ds_read_b64_tr_b16 v[38:39], v104 offset:11008
    s_waitcnt lgkmcnt(6)
    v_mfma_f32_16x16x32_bf16 v[64:67], v[44:47], v[24:27], v[64:67]
    v_mfma_f32_16x16x32_bf16 v[76:79], v[44:47], v[28:31], v[76:79]
    v_mfma_f32_16x16x32_bf16 v[88:91], v[44:47], v[56:59], v[88:91]
    v_mfma_f32_16x16x32_bf16 v[68:71], v[48:51], v[24:27], v[68:71]
    v_mfma_f32_16x16x32_bf16 v[80:83], v[48:51], v[28:31], v[80:83]
    v_mfma_f32_16x16x32_bf16 v[92:95], v[48:51], v[56:59], v[92:95]
    ds_read_b128 v[24:27], v103 offset:0
    ds_read_b128 v[28:31], v103 offset:4096
    ds_read_b64_tr_b16 v[44:45], v104 offset:15456
    ds_read_b64_tr_b16 v[46:47], v104 offset:16096
    ds_read_b64_tr_b16 v[48:49], v104 offset:15488
    ds_read_b64_tr_b16 v[50:51], v104 offset:16128
    s_waitcnt lgkmcnt(6)
    v_mfma_f32_16x16x32_bf16 v[64:67], v[32:35], v[16:19], v[64:67]
    v_mfma_f32_16x16x32_bf16 v[76:79], v[32:35], v[20:23], v[76:79]
    v_mfma_f32_16x16x32_bf16 v[88:91], v[32:35], v[56:59], v[88:91]
    v_mfma_f32_16x16x32_bf16 v[68:71], v[36:39], v[16:19], v[68:71]
    v_mfma_f32_16x16x32_bf16 v[80:83], v[36:39], v[20:23], v[80:83]
    v_mfma_f32_16x16x32_bf16 v[92:95], v[36:39], v[56:59], v[92:95]
    s_waitcnt lgkmcnt(0)
    v_add_u32 v100, 36864, v100
    v_add_u32 v101, 36864, v101
    v_add_u32 v102, 36864, v102
    v_add_u32 v103, 36864, v103
    v_add_u32 v104, 36864, v104
    v_mfma_f32_16x16x32_bf16 v[64:67], v[44:47], v[24:27], v[64:67]
    v_mfma_f32_16x16x32_bf16 v[76:79], v[44:47], v[28:31], v[76:79]
    v_mfma_f32_16x16x32_bf16 v[88:91], v[44:47], v[56:59], v[88:91]
    v_mfma_f32_16x16x32_bf16 v[68:71], v[48:51], v[24:27], v[68:71]
    v_mfma_f32_16x16x32_bf16 v[80:83], v[48:51], v[28:31], v[80:83]
    v_mfma_f32_16x16x32_bf16 v[92:95], v[48:51], v[56:59], v[92:95]
    s_barrier
    ds_read_b128 v[16:19], v100 offset:0
    ds_read_b128 v[20:23], v100 offset:4096
    ds_read_b64_tr_b16 v[32:33], v104 offset:96
    ds_read_b64_tr_b16 v[34:35], v104 offset:736
    ds_read_b64_tr_b16 v[36:37], v104 offset:128
    ds_read_b64_tr_b16 v[38:39], v104 offset:768
    ds_read_b128 v[24:27], v101 offset:0
    ds_read_b128 v[28:31], v101 offset:4096
    ds_read_b64_tr_b16 v[44:45], v104 offset:5216
    ds_read_b64_tr_b16 v[46:47], v104 offset:5856
    ds_read_b64_tr_b16 v[48:49], v104 offset:5248
    ds_read_b64_tr_b16 v[50:51], v104 offset:5888
    s_waitcnt lgkmcnt(6)
    v_mfma_f32_16x16x32_bf16 v[64:67], v[32:35], v[16:19], v[64:67]
    v_mfma_f32_16x16x32_bf16 v[76:79], v[32:35], v[20:23], v[76:79]
    v_mfma_f32_16x16x32_bf16 v[88:91], v[32:35], v[56:59], v[88:91]
    v_mfma_f32_16x16x32_bf16 v[68:71], v[36:39], v[16:19], v[68:71]
    v_mfma_f32_16x16x32_bf16 v[80:83], v[36:39], v[20:23], v[80:83]
    v_mfma_f32_16x16x32_bf16 v[92:95], v[36:39], v[56:59], v[92:95]
    ds_read_b128 v[16:19], v102 offset:0
    ds_read_b128 v[20:23], v102 offset:4096
    ds_read_b64_tr_b16 v[32:33], v104 offset:10336
    ds_read_b64_tr_b16 v[34:35], v104 offset:10976
    ds_read_b64_tr_b16 v[36:37], v104 offset:10368
    ds_read_b64_tr_b16 v[38:39], v104 offset:11008
    s_waitcnt lgkmcnt(6)
    v_mfma_f32_16x16x32_bf16 v[64:67], v[44:47], v[24:27], v[64:67]
    v_mfma_f32_16x16x32_bf16 v[76:79], v[44:47], v[28:31], v[76:79]
    v_mfma_f32_16x16x32_bf16 v[88:91], v[44:47], v[56:59], v[88:91]
    v_mfma_f32_16x16x32_bf16 v[68:71], v[48:51], v[24:27], v[68:71]
    v_mfma_f32_16x16x32_bf16 v[80:83], v[48:51], v[28:31], v[80:83]
    v_mfma_f32_16x16x32_bf16 v[92:95], v[48:51], v[56:59], v[92:95]
    ds_read_b128 v[24:27], v103 offset:0
    ds_read_b128 v[28:31], v103 offset:4096
    ds_read_b64_tr_b16 v[44:45], v104 offset:15456
    ds_read_b64_tr_b16 v[46:47], v104 offset:16096
    ds_read_b64_tr_b16 v[48:49], v104 offset:15488
    ds_read_b64_tr_b16 v[50:51], v104 offset:16128
    s_waitcnt lgkmcnt(6)
    v_mfma_f32_16x16x32_bf16 v[64:67], v[32:35], v[16:19], v[64:67]
    v_mfma_f32_16x16x32_bf16 v[76:79], v[32:35], v[20:23], v[76:79]
    v_mfma_f32_16x16x32_bf16 v[88:91], v[32:35], v[56:59], v[88:91]
    v_mfma_f32_16x16x32_bf16 v[68:71], v[36:39], v[16:19], v[68:71]
    v_mfma_f32_16x16x32_bf16 v[80:83], v[36:39], v[20:23], v[80:83]
    v_mfma_f32_16x16x32_bf16 v[92:95], v[36:39], v[56:59], v[92:95]
    s_waitcnt lgkmcnt(0)
    v_add_u32 v100, 4294893568, v100
    v_add_u32 v101, 4294893568, v101
    v_add_u32 v102, 4294893568, v102
    v_add_u32 v103, 4294893568, v103
    v_add_u32 v104, 4294893568, v104
    v_mfma_f32_16x16x32_bf16 v[64:67], v[44:47], v[24:27], v[64:67]
    v_mfma_f32_16x16x32_bf16 v[76:79], v[44:47], v[28:31], v[76:79]
    v_mfma_f32_16x16x32_bf16 v[88:91], v[44:47], v[56:59], v[88:91]
    v_mfma_f32_16x16x32_bf16 v[68:71], v[48:51], v[24:27], v[68:71]
    v_mfma_f32_16x16x32_bf16 v[80:83], v[48:51], v[28:31], v[80:83]
    v_mfma_f32_16x16x32_bf16 v[92:95], v[48:51], v[56:59], v[92:95]
    s_barrier
    ds_read_b128 v[16:19], v100 offset:0
    ds_read_b128 v[20:23], v100 offset:4096
    ds_read_b64_tr_b16 v[32:33], v104 offset:96
    ds_read_b64_tr_b16 v[34:35], v104 offset:736
    ds_read_b64_tr_b16 v[36:37], v104 offset:128
    ds_read_b64_tr_b16 v[38:39], v104 offset:768
    ds_read_b128 v[24:27], v101 offset:0
    ds_read_b128 v[28:31], v101 offset:4096
    ds_read_b64_tr_b16 v[44:45], v104 offset:5216
    ds_read_b64_tr_b16 v[46:47], v104 offset:5856
    ds_read_b64_tr_b16 v[48:49], v104 offset:5248
    ds_read_b64_tr_b16 v[50:51], v104 offset:5888
    s_waitcnt lgkmcnt(6)
    v_mfma_f32_16x16x32_bf16 v[64:67], v[32:35], v[16:19], v[64:67]
    v_mfma_f32_16x16x32_bf16 v[76:79], v[32:35], v[20:23], v[76:79]
    v_mfma_f32_16x16x32_bf16 v[88:91], v[32:35], v[56:59], v[88:91]
    v_mfma_f32_16x16x32_bf16 v[68:71], v[36:39], v[16:19], v[68:71]
    v_mfma_f32_16x16x32_bf16 v[80:83], v[36:39], v[20:23], v[80:83]
    v_mfma_f32_16x16x32_bf16 v[92:95], v[36:39], v[56:59], v[92:95]
    ds_read_b128 v[16:19], v102 offset:0
    ds_read_b128 v[20:23], v102 offset:4096
    ds_read_b64_tr_b16 v[32:33], v104 offset:10336
    ds_read_b64_tr_b16 v[34:35], v104 offset:10976
    ds_read_b64_tr_b16 v[36:37], v104 offset:10368
    ds_read_b64_tr_b16 v[38:39], v104 offset:11008
    s_waitcnt lgkmcnt(6)
    v_mfma_f32_16x16x32_bf16 v[64:67], v[44:47], v[24:27], v[64:67]
    v_mfma_f32_16x16x32_bf16 v[76:79], v[44:47], v[28:31], v[76:79]
    v_mfma_f32_16x16x32_bf16 v[88:91], v[44:47], v[56:59], v[88:91]
    v_mfma_f32_16x16x32_bf16 v[68:71], v[48:51], v[24:27], v[68:71]
    v_mfma_f32_16x16x32_bf16 v[80:83], v[48:51], v[28:31], v[80:83]
    v_mfma_f32_16x16x32_bf16 v[92:95], v[48:51], v[56:59], v[92:95]
    ds_read_b128 v[24:27], v103 offset:0
    ds_read_b128 v[28:31], v103 offset:4096
    ds_read_b64_tr_b16 v[44:45], v104 offset:15456
    ds_read_b64_tr_b16 v[46:47], v104 offset:16096
    ds_read_b64_tr_b16 v[48:49], v104 offset:15488
    ds_read_b64_tr_b16 v[50:51], v104 offset:16128
    s_waitcnt lgkmcnt(6)
    v_mfma_f32_16x16x32_bf16 v[64:67], v[32:35], v[16:19], v[64:67]
    v_mfma_f32_16x16x32_bf16 v[76:79], v[32:35], v[20:23], v[76:79]
    v_mfma_f32_16x16x32_bf16 v[88:91], v[32:35], v[56:59], v[88:91]
    v_mfma_f32_16x16x32_bf16 v[68:71], v[36:39], v[16:19], v[68:71]
    v_mfma_f32_16x16x32_bf16 v[80:83], v[36:39], v[20:23], v[80:83]
    v_mfma_f32_16x16x32_bf16 v[92:95], v[36:39], v[56:59], v[92:95]
    s_waitcnt lgkmcnt(0)
    v_add_u32 v100, 36864, v100
    v_add_u32 v101, 36864, v101
    v_add_u32 v102, 36864, v102
    v_add_u32 v103, 36864, v103
    v_add_u32 v104, 36864, v104
    v_mfma_f32_16x16x32_bf16 v[64:67], v[44:47], v[24:27], v[64:67]
    v_mfma_f32_16x16x32_bf16 v[76:79], v[44:47], v[28:31], v[76:79]
    v_mfma_f32_16x16x32_bf16 v[88:91], v[44:47], v[56:59], v[88:91]
    v_mfma_f32_16x16x32_bf16 v[68:71], v[48:51], v[24:27], v[68:71]
    v_mfma_f32_16x16x32_bf16 v[80:83], v[48:51], v[28:31], v[80:83]
    v_mfma_f32_16x16x32_bf16 v[92:95], v[48:51], v[56:59], v[92:95]
    s_barrier
    ds_read_b128 v[16:19], v100 offset:0
    ds_read_b128 v[20:23], v100 offset:4096
    ds_read_b64_tr_b16 v[32:33], v104 offset:96
    ds_read_b64_tr_b16 v[34:35], v104 offset:736
    ds_read_b64_tr_b16 v[36:37], v104 offset:128
    ds_read_b64_tr_b16 v[38:39], v104 offset:768
    ds_read_b128 v[24:27], v101 offset:0
    ds_read_b128 v[28:31], v101 offset:4096
    ds_read_b64_tr_b16 v[44:45], v104 offset:5216
    ds_read_b64_tr_b16 v[46:47], v104 offset:5856
    ds_read_b64_tr_b16 v[48:49], v104 offset:5248
    ds_read_b64_tr_b16 v[50:51], v104 offset:5888
    s_waitcnt lgkmcnt(6)
    v_mfma_f32_16x16x32_bf16 v[64:67], v[32:35], v[16:19], v[64:67]
    v_mfma_f32_16x16x32_bf16 v[76:79], v[32:35], v[20:23], v[76:79]
    v_mfma_f32_16x16x32_bf16 v[88:91], v[32:35], v[56:59], v[88:91]
    v_mfma_f32_16x16x32_bf16 v[68:71], v[36:39], v[16:19], v[68:71]
    v_mfma_f32_16x16x32_bf16 v[80:83], v[36:39], v[20:23], v[80:83]
    v_mfma_f32_16x16x32_bf16 v[92:95], v[36:39], v[56:59], v[92:95]
    ds_read_b128 v[16:19], v102 offset:0
    ds_read_b128 v[20:23], v102 offset:4096
    ds_read_b64_tr_b16 v[32:33], v104 offset:10336
    ds_read_b64_tr_b16 v[34:35], v104 offset:10976
    ds_read_b64_tr_b16 v[36:37], v104 offset:10368
    ds_read_b64_tr_b16 v[38:39], v104 offset:11008
    s_waitcnt lgkmcnt(6)
    v_mfma_f32_16x16x32_bf16 v[64:67], v[44:47], v[24:27], v[64:67]
    v_mfma_f32_16x16x32_bf16 v[76:79], v[44:47], v[28:31], v[76:79]
    v_mfma_f32_16x16x32_bf16 v[88:91], v[44:47], v[56:59], v[88:91]
    v_mfma_f32_16x16x32_bf16 v[68:71], v[48:51], v[24:27], v[68:71]
    v_mfma_f32_16x16x32_bf16 v[80:83], v[48:51], v[28:31], v[80:83]
    v_mfma_f32_16x16x32_bf16 v[92:95], v[48:51], v[56:59], v[92:95]
    ds_read_b128 v[24:27], v103 offset:0
    ds_read_b128 v[28:31], v103 offset:4096
    ds_read_b64_tr_b16 v[44:45], v104 offset:15456
    ds_read_b64_tr_b16 v[46:47], v104 offset:16096
    ds_read_b64_tr_b16 v[48:49], v104 offset:15488
    ds_read_b64_tr_b16 v[50:51], v104 offset:16128
    s_waitcnt lgkmcnt(6)
    v_mfma_f32_16x16x32_bf16 v[64:67], v[32:35], v[16:19], v[64:67]
    v_mfma_f32_16x16x32_bf16 v[76:79], v[32:35], v[20:23], v[76:79]
    v_mfma_f32_16x16x32_bf16 v[88:91], v[32:35], v[56:59], v[88:91]
    v_mfma_f32_16x16x32_bf16 v[68:71], v[36:39], v[16:19], v[68:71]
    v_mfma_f32_16x16x32_bf16 v[80:83], v[36:39], v[20:23], v[80:83]
    v_mfma_f32_16x16x32_bf16 v[92:95], v[36:39], v[56:59], v[92:95]
    s_waitcnt lgkmcnt(0)
    v_mfma_f32_16x16x32_bf16 v[64:67], v[44:47], v[24:27], v[64:67]
    v_mfma_f32_16x16x32_bf16 v[76:79], v[44:47], v[28:31], v[76:79]
    v_mfma_f32_16x16x32_bf16 v[88:91], v[44:47], v[56:59], v[88:91]
    v_mfma_f32_16x16x32_bf16 v[68:71], v[48:51], v[24:27], v[68:71]
    v_mfma_f32_16x16x32_bf16 v[80:83], v[48:51], v[28:31], v[80:83]
    v_mfma_f32_16x16x32_bf16 v[92:95], v[48:51], v[56:59], v[92:95]
    v_mul_u32_u24 v10, 160, v3
    v_lshl_add_u32 v10, v4, 3, v10
    s_and_b32 s46, s18, 1
    s_mul_i32 s46, s46, 5120
    s_add_u32 s46, s46, 153600
    v_add_u32 v10, s46, v10
    s_waitcnt vmcnt(0)
    s_nop 3
    v_mul_f32 v14, 0x3ea52b5c, v141
    v_mul_f32 v15, 0x3ea52b5c, v140
    v_mul_f32 v64, v64, v14
    v_fma_f32 v64, -v88, v15, v64
    v_mul_f32 v65, v65, v14
    v_fma_f32 v65, -v89, v15, v65
    v_mul_f32 v66, v66, v14
    v_fma_f32 v66, -v90, v15, v66
    v_mul_f32 v67, v67, v14
    v_fma_f32 v67, -v91, v15, v67
    v_cvt_pk_bf16_f32 v64, v64, v65
    v_cvt_pk_bf16_f32 v65, v66, v67
    ds_write_b64 v10, v[64:65] offset:96
    v_mul_f32 v68, v68, v14
    v_fma_f32 v68, -v92, v15, v68
    v_mul_f32 v69, v69, v14
    v_fma_f32 v69, -v93, v15, v69
    v_mul_f32 v70, v70, v14
    v_fma_f32 v70, -v94, v15, v70
    v_mul_f32 v71, v71, v14
    v_fma_f32 v71, -v95, v15, v71
    v_cvt_pk_bf16_f32 v68, v68, v69
    v_cvt_pk_bf16_f32 v69, v70, v71
    ds_write_b64 v10, v[68:69] offset:128
    v_mul_f32 v14, 0x3ea52b5c, v143
    v_mul_f32 v15, 0x3ea52b5c, v142
    v_mul_f32 v76, v76, v14
    v_fma_f32 v76, -v88, v15, v76
    v_mul_f32 v77, v77, v14
    v_fma_f32 v77, -v89, v15, v77
    v_mul_f32 v78, v78, v14
    v_fma_f32 v78, -v90, v15, v78
    v_mul_f32 v79, v79, v14
    v_fma_f32 v79, -v91, v15, v79
    v_cvt_pk_bf16_f32 v76, v76, v77
    v_cvt_pk_bf16_f32 v77, v78, v79
    ds_write_b64 v10, v[76:77] offset:2656
    v_mul_f32 v80, v80, v14
    v_fma_f32 v80, -v92, v15, v80
    v_mul_f32 v81, v81, v14
    v_fma_f32 v81, -v93, v15, v81
    v_mul_f32 v82, v82, v14
    v_fma_f32 v82, -v94, v15, v82
    v_mul_f32 v83, v83, v14
    v_fma_f32 v83, -v95, v15, v83
    v_cvt_pk_bf16_f32 v80, v80, v81
    v_cvt_pk_bf16_f32 v81, v82, v83
    ds_write_b64 v10, v[80:81] offset:2688
    s_waitcnt lgkmcnt(0)
attn_kernel_qrd:
    s_barrier
    ds_read_b64 v[8:9], v126
    ds_read_b64 v[10:11], v126 offset:8
    ds_read_b64 v[12:13], v125 offset:32
    v_and_b32 v3, 31, v1
    v_lshrrev_b32 v4, 5, v1
    v_mov_b32 v78, 0x3f803f80
    v_mov_b32 v79, 0x00003f80
    v_mov_b32 v86, 0x3f803f80
    v_mov_b32 v87, 0x00003f80
    v_cmp_eq_u32 vcc, 20, v3
    v_mov_b32 v110, 0x3f803f80
    s_nop 1
    v_cndmask_b32 v110, 0, v110, vcc
    v_mov_b32 v88, v110
    v_mov_b32 v89, v110
    v_mov_b32 v90, v110
    v_mov_b32 v91, v110
    v_mov_b32 v92, v110
    v_mov_b32 v93, v110
    v_mov_b32 v94, v110
    v_mov_b32 v95, v110
    v_mov_b32 v96, v110
    v_mov_b32 v97, v110
    v_mov_b32 v98, v110
    v_mov_b32 v99, v110
    v_mov_b32 v100, v110
    v_mov_b32 v101, v110
    v_mov_b32 v102, v110
    v_mov_b32 v103, v110
    v_mov_b32 v48, 0
    v_mov_b32 v49, 0
    v_mov_b32 v50, 0
    v_mov_b32 v51, 0
    v_mov_b32 v52, 0
    v_mov_b32 v53, 0
    v_mov_b32 v54, 0
    v_mov_b32 v55, 0
    v_mov_b32 v56, 0
    v_mov_b32 v57, 0
    v_mov_b32 v58, 0
    v_mov_b32 v59, 0
    v_mov_b32 v60, 0
    v_mov_b32 v61, 0
    v_mov_b32 v62, 0
    v_mov_b32 v63, 0
    v_mov_b32 v68, 0
    v_mov_b32 v69, 0
    v_mov_b32 v70, 0
    v_mov_b32 v71, 0
    v_cmp_eq_u32 vcc, 0, v4
    s_waitcnt lgkmcnt(0)
    v_cndmask_b32 v12, 0, v12, vcc
    v_cndmask_b32 v13, 0, v13, vcc
    v_mov_b32 v14, 0
    v_mov_b32 v15, 0
    v_mov_b32 v111, 0
    v_dot2_f32_bf16 v111, v8, v8, v111
    v_dot2_f32_bf16 v111, v9, v9, v111
    v_dot2_f32_bf16 v111, v10, v10, v111
    v_dot2_f32_bf16 v111, v11, v11, v111
    v_dot2_f32_bf16 v111, v12, v12, v111
    v_dot2_f32_bf16 v111, v13, v13, v111
    s_nop 3
    v_mov_b32 v112, v111
    v_mov_b32 v113, v111
    s_nop 1
    v_permlane32_swap_b32 v112, v113
    s_nop 1
    v_add_f32 v111, v112, v113
    v_mul_f32 v111, v111, v127
    v_sqrt_f32 v111, v111
    s_nop 0
    v_mul_f32 v111, 0x3f8147ae, v111
    v_mov_b32 v114, 0x42480000
    v_cmp_nle_f32 vcc, v111, v114
    s_barrier
    s_cbranch_vccnz attn_kernel_slow
    v_xor_b32 v111, 0x80000000, v111
    v_and_b32 v112, 0xffff0000, v111
    v_sub_f32 v113, v111, v112
    v_and_b32 v114, 0xffff0000, v113
    v_sub_f32 v113, v113, v114
    v_lshrrev_b32 v112, 16, v112
    v_or_b32 v112, v112, v114
    v_lshrrev_b32 v113, 16, v113
    v_cmp_eq_u32 vcc, 0, v4
    s_nop 1
    v_cndmask_b32 v14, 0, v112, vcc
    v_cndmask_b32 v15, 0, v113, vcc
    ds_read_b128 v[72:75], v136 offset:0
    ds_read_b64 v[76:77], v137 offset:1024
    ds_read_b128 v[80:83], v136 offset:2560
    ds_read_b64 v[84:85], v137 offset:3584
    s_mov_b64 exec, s[40:41]
    ds_read_b128 v[88:91], v138 offset:1280
    ds_read_b128 v[92:95], v138 offset:1920
    s_mov_b64 exec, -1
    s_waitcnt lgkmcnt(4)
    v_mfma_f32_32x32x16_bf16 v[16:31], v[72:75], v[8:11], 0
    v_mfma_f32_32x32x16_bf16 v[16:31], v[76:79], v[12:15], v[16:31]
    s_nop 7
    s_nop 3
    s_waitcnt lgkmcnt(0)
    v_exp_f32 v16, v16
    v_exp_f32 v17, v17
    v_mfma_f32_32x32x16_bf16 v[48:63], v[100:103], v[68:71], v[48:63]
    ds_read_b128 v[72:75], v136 offset:5120
    ds_read_b64 v[76:77], v137 offset:6144
    s_mov_b64 exec, s[40:41]
    ds_read_b128 v[96:99], v138 offset:3840
    ds_read_b128 v[100:103], v138 offset:4480
    s_mov_b64 exec, -1
    v_exp_f32 v18, v18
    v_exp_f32 v19, v19
    v_exp_f32 v20, v20
    v_mfma_f32_32x32x16_bf16 v[32:47], v[80:83], v[8:11], 0
    v_exp_f32 v21, v21
    v_exp_f32 v22, v22
    v_exp_f32 v23, v23
    v_cvt_pk_bf16_f32 v64, v16, v17
    v_cvt_pk_bf16_f32 v65, v18, v19
    v_cvt_pk_bf16_f32 v66, v20, v21
    v_cvt_pk_bf16_f32 v67, v22, v23
    v_exp_f32 v24, v24
    v_mfma_f32_32x32x16_bf16 v[32:47], v[84:87], v[12:15], v[32:47]
    s_mov_b32 m0, s52
    s_nop 0
    buffer_load_dwordx4 v132, s[56:59], s52 offen lds
    s_add_u32 s52, s52, 8192
    v_exp_f32 v25, v25
    v_exp_f32 v26, v26
    v_exp_f32 v27, v27
    v_mfma_f32_32x32x16_bf16 v[48:63], v[88:91], v[64:67], v[48:63]
    s_mov_b32 m0, s52
    s_nop 0
    buffer_load_dwordx4 v132, s[56:59], s52 offen lds
    s_add_u32 s52, s52, 8192
    v_exp_f32 v28, v28
    v_exp_f32 v29, v29
    v_exp_f32 v30, v30
    v_exp_f32 v31, v31
    v_cvt_pk_bf16_f32 v68, v24, v25
    v_cvt_pk_bf16_f32 v69, v26, v27
    v_cvt_pk_bf16_f32 v70, v28, v29
    v_cvt_pk_bf16_f32 v71, v30, v31
    s_waitcnt lgkmcnt(0)
    v_exp_f32 v32, v32
    v_exp_f32 v33, v33
    v_mfma_f32_32x32x16_bf16 v[48:63], v[92:95], v[68:71], v[48:63]
    ds_read_b128 v[80:83], v136 offset:7680
    ds_read_b64 v[84:85], v137 offset:8704
    s_mov_b64 exec, s[40:41]
    ds_read_b128 v[88:91], v138 offset:6400
    ds_read_b128 v[92:95], v138 offset:7040
    s_mov_b64 exec, -1
    v_exp_f32 v34, v34
    v_exp_f32 v35, v35
    v_exp_f32 v36, v36
    v_mfma_f32_32x32x16_bf16 v[16:31], v[72:75], v[8:11], 0
    v_exp_f32 v37, v37
    v_exp_f32 v38, v38
    v_exp_f32 v39, v39
    v_cvt_pk_bf16_f32 v64, v32, v33
    v_cvt_pk_bf16_f32 v65, v34, v35
    v_cvt_pk_bf16_f32 v66, v36, v37
    v_cvt_pk_bf16_f32 v67, v38, v39
    v_exp_f32 v40, v40
    v_mfma_f32_32x32x16_bf16 v[16:31], v[76:79], v[12:15], v[16:31]
    s_mov_b32 m0, s52
    s_nop 0
    buffer_load_dwordx4 v132, s[56:59], s52 offen lds
    s_add_u32 s52, s52, 8192
    v_exp_f32 v41, v41
    v_exp_f32 v42, v42
    v_exp_f32 v43, v43
    v_mfma_f32_32x32x16_bf16 v[48:63], v[96:99], v[64:67], v[48:63]
    s_mov_b32 m0, s52
    s_nop 0
    buffer_load_dwordx4 v132, s[56:59], s52 offen lds
    s_add_u32 s52, s52, 8192
    v_exp_f32 v44, v44
    v_exp_f32 v45, v45
    v_exp_f32 v46, v46
    v_exp_f32 v47, v47
    v_cvt_pk_bf16_f32 v68, v40, v41
    v_cvt_pk_bf16_f32 v69, v42, v43
    v_cvt_pk_bf16_f32 v70, v44, v45
    v_cvt_pk_bf16_f32 v71, v46, v47
    s_waitcnt lgkmcnt(0)
    v_exp_f32 v16, v16
    v_exp_f32 v17, v17
    v_mfma_f32_32x32x16_bf16 v[48:63], v[100:103], v[68:71], v[48:63]
    ds_read_b128 v[72:75], v136 offset:10240
    ds_read_b64 v[76:77], v137 offset:11264
    s_mov_b64 exec, s[40:41]
    ds_read_b128 v[96:99], v138 offset:8960
    ds_read_b128 v[100:103], v138 offset:9600
    s_mov_b64 exec, -1
    v_exp_f32 v18, v18
    v_exp_f32 v19, v19
    v_exp_f32 v20, v20
    v_mfma_f32_32x32x16_bf16 v[32:47], v[80:83], v[8:11], 0
    v_exp_f32 v21, v21
    v_exp_f32 v22, v22
    v_exp_f32 v23, v23
    v_cvt_pk_bf16_f32 v64, v16, v17
    v_cvt_pk_bf16_f32 v65, v18, v19
    v_cvt_pk_bf16_f32 v66, v20, v21
    v_cvt_pk_bf16_f32 v67, v22, v23
    v_exp_f32 v24, v24
    v_mfma_f32_32x32x16_bf16 v[32:47], v[84:87], v[12:15], v[32:47]
    s_mov_b32 m0, s52
    s_nop 0
    buffer_load_dwordx4 v132, s[56:59], s52 offen lds
    s_add_u32 s52, s52, 8192
    v_exp_f32 v25, v25
    v_exp_f32 v26, v26
    v_exp_f32 v27, v27
    v_mfma_f32_32x32x16_bf16 v[48:63], v[88:91], v[64:67], v[48:63]
    s_mov_b32 m0, s52
    s_nop 0
    buffer_load_dwordx4 v132, s[56:59], s52 offen lds
    s_add_u32 s52, s52, 8192
    v_exp_f32 v28, v28
    v_exp_f32 v29, v29
    v_exp_f32 v30, v30
    v_exp_f32 v31, v31
    v_cvt_pk_bf16_f32 v68, v24, v25
    v_cvt_pk_bf16_f32 v69, v26, v27
    v_cvt_pk_bf16_f32 v70, v28, v29
    v_cvt_pk_bf16_f32 v71, v30, v31
    s_waitcnt lgkmcnt(0)
    v_exp_f32 v32, v32
    v_exp_f32 v33, v33
    v_mfma_f32_32x32x16_bf16 v[48:63], v[92:95], v[68:71], v[48:63]
    ds_read_b128 v[80:83], v136 offset:12800
    ds_read_b64 v[84:85], v137 offset:13824
    s_mov_b64 exec, s[40:41]
    ds_read_b128 v[88:91], v138 offset:11520
    ds_read_b128 v[92:95], v138 offset:12160
    s_mov_b64 exec, -1
    v_exp_f32 v34, v34
    v_exp_f32 v35, v35
    v_exp_f32 v36, v36
    v_mfma_f32_32x32x16_bf16 v[16:31], v[72:75], v[8:11], 0
    v_exp_f32 v37, v37
    v_exp_f32 v38, v38
    v_exp_f32 v39, v39
    v_cvt_pk_bf16_f32 v64, v32, v33
    v_cvt_pk_bf16_f32 v65, v34, v35
    v_cvt_pk_bf16_f32 v66, v36, v37
    v_cvt_pk_bf16_f32 v67, v38, v39
    v_exp_f32 v40, v40
    v_mfma_f32_32x32x16_bf16 v[16:31], v[76:79], v[12:15], v[16:31]
    s_mov_b32 m0, s52
    s_nop 0
    buffer_load_dwordx4 v132, s[56:59], s52 offen lds
    s_add_u32 s52, s52, 8192
    v_exp_f32 v41, v41
    v_exp_f32 v42, v42
    v_exp_f32 v43, v43
    v_mfma_f32_32x32x16_bf16 v[48:63], v[96:99], v[64:67], v[48:63]
    s_mov_b32 m0, s52
    s_nop 0
    buffer_load_dwordx4 v132, s[56:59], s52 offen lds
    s_add_u32 s52, s52, 8192
    v_exp_f32 v44, v44
    v_exp_f32 v45, v45
    v_exp_f32 v46, v46
    v_exp_f32 v47, v47
    v_cvt_pk_bf16_f32 v68, v40, v41
    v_cvt_pk_bf16_f32 v69, v42, v43
    v_cvt_pk_bf16_f32 v70, v44, v45
    v_cvt_pk_bf16_f32 v71, v46, v47
    s_waitcnt lgkmcnt(0)
    v_exp_f32 v16, v16
    v_exp_f32 v17, v17
    v_mfma_f32_32x32x16_bf16 v[48:63], v[100:103], v[68:71], v[48:63]
    ds_read_b128 v[72:75], v136 offset:15360
    ds_read_b64 v[76:77], v137 offset:16384
    s_mov_b64 exec, s[40:41]
    ds_read_b128 v[96:99], v138 offset:14080
    ds_read_b128 v[100:103], v138 offset:14720
    s_mov_b64 exec, -1
    v_exp_f32 v18, v18
    v_exp_f32 v19, v19
    v_exp_f32 v20, v20
    v_mfma_f32_32x32x16_bf16 v[32:47], v[80:83], v[8:11], 0
    v_exp_f32 v21, v21
    v_exp_f32 v22, v22
    v_exp_f32 v23, v23
    v_cvt_pk_bf16_f32 v64, v16, v17
    v_cvt_pk_bf16_f32 v65, v18, v19
    v_cvt_pk_bf16_f32 v66, v20, v21
    v_cvt_pk_bf16_f32 v67, v22, v23
    v_exp_f32 v24, v24
    v_mfma_f32_32x32x16_bf16 v[32:47], v[84:87], v[12:15], v[32:47]
    s_mov_b32 m0, s52
    s_nop 0
    buffer_load_dwordx4 v132, s[56:59], s52 offen lds
    s_add_u32 s52, s52, 8192
    v_exp_f32 v25, v25
    v_exp_f32 v26, v26
    v_exp_f32 v27, v27
    v_mfma_f32_32x32x16_bf16 v[48:63], v[88:91], v[64:67], v[48:63]
    s_mov_b32 m0, s52
    s_nop 0
    buffer_load_dwordx4 v132, s[56:59], s52 offen lds
    s_add_u32 s52, s52, 8192
    v_exp_f32 v28, v28
    v_exp_f32 v29, v29
    v_exp_f32 v30, v30
    v_exp_f32 v31, v31
    v_cvt_pk_bf16_f32 v68, v24, v25
    v_cvt_pk_bf16_f32 v69, v26, v27
    v_cvt_pk_bf16_f32 v70, v28, v29
    v_cvt_pk_bf16_f32 v71, v30, v31
    s_waitcnt lgkmcnt(0)
    v_exp_f32 v32, v32
    v_exp_f32 v33, v33
    v_mfma_f32_32x32x16_bf16 v[48:63], v[92:95], v[68:71], v[48:63]
    ds_read_b128 v[80:83], v136 offset:17920
    ds_read_b64 v[84:85], v137 offset:18944
    s_mov_b64 exec, s[40:41]
    ds_read_b128 v[88:91], v138 offset:16640
    ds_read_b128 v[92:95], v138 offset:17280
    s_mov_b64 exec, -1
    v_exp_f32 v34, v34
    v_exp_f32 v35, v35
    v_exp_f32 v36, v36
    v_mfma_f32_32x32x16_bf16 v[16:31], v[72:75], v[8:11], 0
    v_exp_f32 v37, v37
    v_exp_f32 v38, v38
    v_exp_f32 v39, v39
    v_cvt_pk_bf16_f32 v64, v32, v33
    v_cvt_pk_bf16_f32 v65, v34, v35
    v_cvt_pk_bf16_f32 v66, v36, v37
    v_cvt_pk_bf16_f32 v67, v38, v39
    v_exp_f32 v40, v40
    v_mfma_f32_32x32x16_bf16 v[16:31], v[76:79], v[12:15], v[16:31]
    s_mov_b32 m0, s52
    s_nop 0
    buffer_load_dwordx4 v132, s[56:59], s52 offen lds
    s_add_u32 s52, s52, 8192
    v_exp_f32 v41, v41
    v_exp_f32 v42, v42
    v_exp_f32 v43, v43
    v_mfma_f32_32x32x16_bf16 v[48:63], v[96:99], v[64:67], v[48:63]
    s_mov_b32 m0, s52
    s_nop 0
    buffer_load_dwordx4 v132, s[56:59], s52 offen lds
    s_add_u32 s52, s52, 8192
    v_exp_f32 v44, v44
    v_exp_f32 v45, v45
    v_exp_f32 v46, v46
    v_exp_f32 v47, v47
    v_cvt_pk_bf16_f32 v68, v40, v41
    v_cvt_pk_bf16_f32 v69, v42, v43
    v_cvt_pk_bf16_f32 v70, v44, v45
    v_cvt_pk_bf16_f32 v71, v46, v47
    s_waitcnt lgkmcnt(0)
    v_exp_f32 v16, v16
    v_exp_f32 v17, v17
    v_mfma_f32_32x32x16_bf16 v[48:63], v[100:103], v[68:71], v[48:63]
    ds_read_b128 v[72:75], v136 offset:20480
    ds_read_b64 v[76:77], v137 offset:21504
    s_mov_b64 exec, s[40:41]
    ds_read_b128 v[96:99], v138 offset:19200
    ds_read_b128 v[100:103], v138 offset:19840
    s_mov_b64 exec, -1
    v_exp_f32 v18, v18
    v_exp_f32 v19, v19
    v_exp_f32 v20, v20
    v_mfma_f32_32x32x16_bf16 v[32:47], v[80:83], v[8:11], 0
    v_exp_f32 v21, v21
    v_exp_f32 v22, v22
    v_exp_f32 v23, v23
    v_cvt_pk_bf16_f32 v64, v16, v17
    v_cvt_pk_bf16_f32 v65, v18, v19
    v_cvt_pk_bf16_f32 v66, v20, v21
    v_cvt_pk_bf16_f32 v67, v22, v23
    v_exp_f32 v24, v24
    v_mfma_f32_32x32x16_bf16 v[32:47], v[84:87], v[12:15], v[32:47]
    s_mov_b32 m0, s52
    s_nop 0
    buffer_load_dwordx4 v132, s[56:59], s52 offen lds
    s_add_u32 s52, s52, 8192
    v_exp_f32 v25, v25
    v_exp_f32 v26, v26
    v_exp_f32 v27, v27
    v_mfma_f32_32x32x16_bf16 v[48:63], v[88:91], v[64:67], v[48:63]
    s_mov_b32 m0, s52
    s_nop 0
    buffer_load_dwordx4 v132, s[56:59], s52 offen lds
    s_add_u32 s52, s52, 8192
    v_exp_f32 v28, v28
    v_exp_f32 v29, v29
    v_exp_f32 v30, v30
    v_exp_f32 v31, v31
    v_cvt_pk_bf16_f32 v68, v24, v25
    v_cvt_pk_bf16_f32 v69, v26, v27
    v_cvt_pk_bf16_f32 v70, v28, v29
    v_cvt_pk_bf16_f32 v71, v30, v31
    s_waitcnt lgkmcnt(0)
    v_exp_f32 v32, v32
    v_exp_f32 v33, v33
    v_mfma_f32_32x32x16_bf16 v[48:63], v[92:95], v[68:71], v[48:63]
    ds_read_b128 v[80:83], v136 offset:23040
    ds_read_b64 v[84:85], v137 offset:24064
    s_mov_b64 exec, s[40:41]
    ds_read_b128 v[88:91], v138 offset:21760
    ds_read_b128 v[92:95], v138 offset:22400
    s_mov_b64 exec, -1
    v_exp_f32 v34, v34
    v_exp_f32 v35, v35
    v_exp_f32 v36, v36
    v_mfma_f32_32x32x16_bf16 v[16:31], v[72:75], v[8:11], 0
    v_exp_f32 v37, v37
    v_exp_f32 v38, v38
    v_exp_f32 v39, v39
    v_cvt_pk_bf16_f32 v64, v32, v33
    v_cvt_pk_bf16_f32 v65, v34, v35
    v_cvt_pk_bf16_f32 v66, v36, v37
    v_cvt_pk_bf16_f32 v67, v38, v39
    v_exp_f32 v40, v40
    v_mfma_f32_32x32x16_bf16 v[16:31], v[76:79], v[12:15], v[16:31]
    v_exp_f32 v41, v41
    v_exp_f32 v42, v42
    v_exp_f32 v43, v43
    v_mfma_f32_32x32x16_bf16 v[48:63], v[96:99], v[64:67], v[48:63]
    v_exp_f32 v44, v44
    v_exp_f32 v45, v45
    v_exp_f32 v46, v46
    v_exp_f32 v47, v47
    v_cvt_pk_bf16_f32 v68, v40, v41
    v_cvt_pk_bf16_f32 v69, v42, v43
    v_cvt_pk_bf16_f32 v70, v44, v45
    v_cvt_pk_bf16_f32 v71, v46, v47
    v_add_u32 v136, 20480, v136
    v_add_u32 v137, 20480, v137
    v_add_u32 v138, 20480, v138
    s_mov_b32 s42, 7
    s_mov_b32 s53, 7
    s_branch attn_kernel_loop
attn_kernel_slow:
    s_mov_b32 m0, s52
    s_nop 0
    buffer_load_dwordx4 v132, s[56:59], s52 offen lds
    s_add_u32 s52, s52, 8192
    s_mov_b32 m0, s52
    s_nop 0
    buffer_load_dwordx4 v132, s[56:59], s52 offen lds
    s_add_u32 s52, s52, 8192
    s_mov_b32 m0, s52
    s_nop 0
    buffer_load_dwordx4 v132, s[56:59], s52 offen lds
    s_add_u32 s52, s52, 8192
    s_mov_b32 m0, s52
    s_nop 0
    buffer_load_dwordx4 v132, s[56:59], s52 offen lds
    s_add_u32 s52, s52, 8192
    s_mov_b32 m0, s52
    s_nop 0
    buffer_load_dwordx4 v132, s[56:59], s52 offen lds
    s_add_u32 s52, s52, 8192
    s_mov_b32 m0, s52
    s_nop 0
    buffer_load_dwordx4 v132, s[56:59], s52 offen lds
    s_add_u32 s52, s52, 8192
    s_mov_b32 m0, s52
    s_nop 0
    buffer_load_dwordx4 v132, s[56:59], s52 offen lds
    s_add_u32 s52, s52, 8192
    s_mov_b32 m0, s52
    s_nop 0
    buffer_load_dwordx4 v132, s[56:59], s52 offen lds
    s_add_u32 s52, s52, 8192
    s_mov_b32 m0, s52
    s_nop 0
    buffer_load_dwordx4 v132, s[56:59], s52 offen lds
    s_add_u32 s52, s52, 8192
    s_mov_b32 m0, s52
    s_nop 0
    buffer_load_dwordx4 v132, s[56:59], s52 offen lds
    s_add_u32 s52, s52, 8192
    s_mov_b32 m0, s52
    s_nop 0
    buffer_load_dwordx4 v132, s[56:59], s52 offen lds
    s_add_u32 s52, s52, 8192
    s_mov_b32 m0, s52
    s_nop 0
    buffer_load_dwordx4 v132, s[56:59], s52 offen lds
    s_add_u32 s52, s52, 8192
    s_mov_b32 m0, s52
    s_nop 0
    buffer_load_dwordx4 v132, s[56:59], s52 offen lds
    s_add_u32 s52, s52, 8192
    s_mov_b32 m0, s52
    s_nop 0
    buffer_load_dwordx4 v132, s[56:59], s52 offen lds
    s_add_u32 s52, s52, 8192
    s_waitcnt vmcnt(0)
    s_barrier
    v_mov_b32 v111, 0xff800000
    s_mov_b32 s42, 64
attn_kernel_maxloop:
    ds_read_b128 v[72:75], v136 offset:0
    ds_read_b64 v[76:77], v137 offset:1024
    v_add_u32 v136, 2560, v136
    v_add_u32 v137, 2560, v137
    s_waitcnt lgkmcnt(0)
    v_mfma_f32_32x32x16_bf16 v[16:31], v[72:75], v[8:11], 0
    v_mfma_f32_32x32x16_bf16 v[16:31], v[76:79], v[12:15], v[16:31]
    s_nop 15
    s_nop 3
    v_max3_f32 v111, v16, v17, v111
    v_max3_f32 v111, v18, v19, v111
    v_max3_f32 v111, v20, v21, v111
    v_max3_f32 v111, v22, v23, v111
    v_max3_f32 v111, v24, v25, v111
    v_max3_f32 v111, v26, v27, v111
    v_max3_f32 v111, v28, v29, v111
    v_max3_f32 v111, v30, v31, v111
    s_sub_u32 s42, s42, 1
    s_cmp_lg_u32 s42, 0
    s_cbranch_scc1 attn_kernel_maxloop
    v_mov_b32 v112, v111
    v_mov_b32 v113, v111
    s_nop 1
    v_permlane32_swap_b32 v112, v113
    s_nop 1
    v_max_f32 v111, v112, v113
    v_lshlrev_b32 v136, 4, v1
    v_lshlrev_b32 v137, 3, v3
    v_xor_b32 v111, 0x80000000, v111
    v_and_b32 v112, 0xffff0000, v111
    v_sub_f32 v113, v111, v112
    v_and_b32 v114, 0xffff0000, v113
    v_sub_f32 v113, v113, v114
    v_lshrrev_b32 v112, 16, v112
    v_or_b32 v112, v112, v114
    v_lshrrev_b32 v113, 16, v113
    v_cmp_eq_u32 vcc, 0, v4
    s_nop 1
    v_cndmask_b32 v14, 0, v112, vcc
    v_cndmask_b32 v15, 0, v113, vcc
    ds_read_b128 v[72:75], v136 offset:0
    ds_read_b64 v[76:77], v137 offset:1024
    ds_read_b128 v[80:83], v136 offset:2560
    ds_read_b64 v[84:85], v137 offset:3584
    s_mov_b64 exec, s[40:41]
    ds_read_b128 v[88:91], v138 offset:1280
    ds_read_b128 v[92:95], v138 offset:1920
    s_mov_b64 exec, -1
    s_waitcnt lgkmcnt(4)
    v_mfma_f32_32x32x16_bf16 v[16:31], v[72:75], v[8:11], 0
    v_mfma_f32_32x32x16_bf16 v[16:31], v[76:79], v[12:15], v[16:31]
    s_nop 7
    s_nop 3
    s_mov_b32 s42, 8
    s_mov_b32 s53, 100
attn_kernel_loop:
    s_waitcnt lgkmcnt(0)
    v_exp_f32 v16, v16
    v_exp_f32 v17, v17
    v_mfma_f32_32x32x16_bf16 v[48:63], v[100:103], v[68:71], v[48:63]
    ds_read_b128 v[72:75], v136 offset:5120
    ds_read_b64 v[76:77], v137 offset:6144
    s_mov_b64 exec, s[40:41]
    ds_read_b128 v[96:99], v138 offset:3840
    ds_read_b128 v[100:103], v138 offset:4480
    s_mov_b64 exec, -1
    v_exp_f32 v18, v18
    v_exp_f32 v19, v19
    v_exp_f32 v20, v20
    v_mfma_f32_32x32x16_bf16 v[32:47], v[80:83], v[8:11], 0
    v_exp_f32 v21, v21
    v_exp_f32 v22, v22
    v_exp_f32 v23, v23
    v_cvt_pk_bf16_f32 v64, v16, v17
    v_cvt_pk_bf16_f32 v65, v18, v19
    v_cvt_pk_bf16_f32 v66, v20, v21
    v_cvt_pk_bf16_f32 v67, v22, v23
    v_exp_f32 v24, v24
    v_mfma_f32_32x32x16_bf16 v[32:47], v[84:87], v[12:15], v[32:47]
    v_exp_f32 v25, v25
    v_exp_f32 v26, v26
    v_exp_f32 v27, v27
    v_mfma_f32_32x32x16_bf16 v[48:63], v[88:91], v[64:67], v[48:63]
    v_exp_f32 v28, v28
    v_exp_f32 v29, v29
    v_exp_f32 v30, v30
    v_exp_f32 v31, v31
    v_cvt_pk_bf16_f32 v68, v24, v25
    v_cvt_pk_bf16_f32 v69, v26, v27
    v_cvt_pk_bf16_f32 v70, v28, v29
    v_cvt_pk_bf16_f32 v71, v30, v31
    s_waitcnt lgkmcnt(0)
    v_exp_f32 v32, v32
    v_exp_f32 v33, v33
    v_mfma_f32_32x32x16_bf16 v[48:63], v[92:95], v[68:71], v[48:63]
    ds_read_b128 v[80:83], v136 offset:7680
    ds_read_b64 v[84:85], v137 offset:8704
    s_mov_b64 exec, s[40:41]
    ds_read_b128 v[88:91], v138 offset:6400
    ds_read_b128 v[92:95], v138 offset:7040
    s_mov_b64 exec, -1
    v_exp_f32 v34, v34
    v_exp_f32 v35, v35
    v_exp_f32 v36, v36
    v_mfma_f32_32x32x16_bf16 v[16:31], v[72:75], v[8:11], 0
    v_exp_f32 v37, v37
    v_exp_f32 v38, v38
    v_exp_f32 v39, v39
    v_cvt_pk_bf16_f32 v64, v32, v33
    v_cvt_pk_bf16_f32 v65, v34, v35
    v_cvt_pk_bf16_f32 v66, v36, v37
    v_cvt_pk_bf16_f32 v67, v38, v39
    v_exp_f32 v40, v40
    v_mfma_f32_32x32x16_bf16 v[16:31], v[76:79], v[12:15], v[16:31]
    v_exp_f32 v41, v41
    v_exp_f32 v42, v42
    v_exp_f32 v43, v43
    v_mfma_f32_32x32x16_bf16 v[48:63], v[96:99], v[64:67], v[48:63]
    v_exp_f32 v44, v44
    v_exp_f32 v45, v45
    v_exp_f32 v46, v46
    v_exp_f32 v47, v47
    v_cvt_pk_bf16_f32 v68, v40, v41
    v_cvt_pk_bf16_f32 v69, v42, v43
    v_cvt_pk_bf16_f32 v70, v44, v45
    v_cvt_pk_bf16_f32 v71, v46, v47
    s_waitcnt lgkmcnt(0)
    v_exp_f32 v16, v16
    v_exp_f32 v17, v17
    v_mfma_f32_32x32x16_bf16 v[48:63], v[100:103], v[68:71], v[48:63]
    ds_read_b128 v[72:75], v136 offset:10240
    ds_read_b64 v[76:77], v137 offset:11264
    s_mov_b64 exec, s[40:41]
    ds_read_b128 v[96:99], v138 offset:8960
    ds_read_b128 v[100:103], v138 offset:9600
    s_mov_b64 exec, -1
    v_exp_f32 v18, v18
    v_exp_f32 v19, v19
    v_exp_f32 v20, v20
    v_mfma_f32_32x32x16_bf16 v[32:47], v[80:83], v[8:11], 0
    v_exp_f32 v21, v21
    v_exp_f32 v22, v22
    v_exp_f32 v23, v23
    v_cvt_pk_bf16_f32 v64, v16, v17
    v_cvt_pk_bf16_f32 v65, v18, v19
    v_cvt_pk_bf16_f32 v66, v20, v21
    v_cvt_pk_bf16_f32 v67, v22, v23
    v_exp_f32 v24, v24
    v_mfma_f32_32x32x16_bf16 v[32:47], v[84:87], v[12:15], v[32:47]
    v_exp_f32 v25, v25
    v_exp_f32 v26, v26
    v_exp_f32 v27, v27
    v_mfma_f32_32x32x16_bf16 v[48:63], v[88:91], v[64:67], v[48:63]
    v_exp_f32 v28, v28
    v_exp_f32 v29, v29
    v_exp_f32 v30, v30
    v_exp_f32 v31, v31
    v_cvt_pk_bf16_f32 v68, v24, v25
    v_cvt_pk_bf16_f32 v69, v26, v27
    v_cvt_pk_bf16_f32 v70, v28, v29
    v_cvt_pk_bf16_f32 v71, v30, v31
    s_waitcnt lgkmcnt(0)
    v_exp_f32 v32, v32
    v_exp_f32 v33, v33
    v_mfma_f32_32x32x16_bf16 v[48:63], v[92:95], v[68:71], v[48:63]
    ds_read_b128 v[80:83], v136 offset:12800
    ds_read_b64 v[84:85], v137 offset:13824
    s_mov_b64 exec, s[40:41]
    ds_read_b128 v[88:91], v138 offset:11520
    ds_read_b128 v[92:95], v138 offset:12160
    s_mov_b64 exec, -1
    v_exp_f32 v34, v34
    v_exp_f32 v35, v35
    v_exp_f32 v36, v36
    v_mfma_f32_32x32x16_bf16 v[16:31], v[72:75], v[8:11], 0
    v_exp_f32 v37, v37
    v_exp_f32 v38, v38
    v_exp_f32 v39, v39
    v_cvt_pk_bf16_f32 v64, v32, v33
    v_cvt_pk_bf16_f32 v65, v34, v35
    v_cvt_pk_bf16_f32 v66, v36, v37
    v_cvt_pk_bf16_f32 v67, v38, v39
    v_exp_f32 v40, v40
    v_mfma_f32_32x32x16_bf16 v[16:31], v[76:79], v[12:15], v[16:31]
    v_exp_f32 v41, v41
    v_exp_f32 v42, v42
    v_exp_f32 v43, v43
    v_mfma_f32_32x32x16_bf16 v[48:63], v[96:99], v[64:67], v[48:63]
    v_exp_f32 v44, v44
    v_exp_f32 v45, v45
    v_exp_f32 v46, v46
    v_exp_f32 v47, v47
    v_cvt_pk_bf16_f32 v68, v40, v41
    v_cvt_pk_bf16_f32 v69, v42, v43
    v_cvt_pk_bf16_f32 v70, v44, v45
    v_cvt_pk_bf16_f32 v71, v46, v47
    s_waitcnt lgkmcnt(0)
    v_exp_f32 v16, v16
    v_exp_f32 v17, v17
    v_mfma_f32_32x32x16_bf16 v[48:63], v[100:103], v[68:71], v[48:63]
    ds_read_b128 v[72:75], v136 offset:15360
    ds_read_b64 v[76:77], v137 offset:16384
    s_mov_b64 exec, s[40:41]
    ds_read_b128 v[96:99], v138 offset:14080
    ds_read_b128 v[100:103], v138 offset:14720
    s_mov_b64 exec, -1
    v_exp_f32 v18, v18
    v_exp_f32 v19, v19
    v_exp_f32 v20, v20
    v_mfma_f32_32x32x16_bf16 v[32:47], v[80:83], v[8:11], 0
    v_exp_f32 v21, v21
    v_exp_f32 v22, v22
    v_exp_f32 v23, v23
    v_cvt_pk_bf16_f32 v64, v16, v17
    v_cvt_pk_bf16_f32 v65, v18, v19
    v_cvt_pk_bf16_f32 v66, v20, v21
    v_cvt_pk_bf16_f32 v67, v22, v23
    v_exp_f32 v24, v24
    v_mfma_f32_32x32x16_bf16 v[32:47], v[84:87], v[12:15], v[32:47]
    v_exp_f32 v25, v25
    v_exp_f32 v26, v26
    v_exp_f32 v27, v27
    v_mfma_f32_32x32x16_bf16 v[48:63], v[88:91], v[64:67], v[48:63]
    v_exp_f32 v28, v28
    v_exp_f32 v29, v29
    v_exp_f32 v30, v30
    v_exp_f32 v31, v31
    v_cvt_pk_bf16_f32 v68, v24, v25
    v_cvt_pk_bf16_f32 v69, v26, v27
    v_cvt_pk_bf16_f32 v70, v28, v29
    v_cvt_pk_bf16_f32 v71, v30, v31
    s_waitcnt lgkmcnt(0)
    v_exp_f32 v32, v32
    v_exp_f32 v33, v33
    v_mfma_f32_32x32x16_bf16 v[48:63], v[92:95], v[68:71], v[48:63]
    ds_read_b128 v[80:83], v136 offset:17920
    ds_read_b64 v[84:85], v137 offset:18944
    s_mov_b64 exec, s[40:41]
    ds_read_b128 v[88:91], v138 offset:16640
    ds_read_b128 v[92:95], v138 offset:17280
    s_mov_b64 exec, -1
    v_exp_f32 v34, v34
    v_exp_f32 v35, v35
    v_exp_f32 v36, v36
    v_mfma_f32_32x32x16_bf16 v[16:31], v[72:75], v[8:11], 0
    v_exp_f32 v37, v37
    v_exp_f32 v38, v38
    v_exp_f32 v39, v39
    v_cvt_pk_bf16_f32 v64, v32, v33
    v_cvt_pk_bf16_f32 v65, v34, v35
    v_cvt_pk_bf16_f32 v66, v36, v37
    v_cvt_pk_bf16_f32 v67, v38, v39
    v_exp_f32 v40, v40
    v_mfma_f32_32x32x16_bf16 v[16:31], v[76:79], v[12:15], v[16:31]
    v_exp_f32 v41, v41
    v_exp_f32 v42, v42
    v_exp_f32 v43, v43
    v_mfma_f32_32x32x16_bf16 v[48:63], v[96:99], v[64:67], v[48:63]
    v_exp_f32 v44, v44
    v_exp_f32 v45, v45
    v_exp_f32 v46, v46
    v_exp_f32 v47, v47
    v_cvt_pk_bf16_f32 v68, v40, v41
    v_cvt_pk_bf16_f32 v69, v42, v43
    v_cvt_pk_bf16_f32 v70, v44, v45
    v_cvt_pk_bf16_f32 v71, v46, v47
    s_waitcnt lgkmcnt(0)
    v_exp_f32 v16, v16
    v_exp_f32 v17, v17
    v_mfma_f32_32x32x16_bf16 v[48:63], v[100:103], v[68:71], v[48:63]
    ds_read_b128 v[72:75], v136 offset:20480
    ds_read_b64 v[76:77], v137 offset:21504
    s_mov_b64 exec, s[40:41]
    ds_read_b128 v[96:99], v138 offset:19200
    ds_read_b128 v[100:103], v138 offset:19840
    s_mov_b64 exec, -1
    v_exp_f32 v18, v18
    v_exp_f32 v19, v19
    v_exp_f32 v20, v20
    v_mfma_f32_32x32x16_bf16 v[32:47], v[80:83], v[8:11], 0
    v_exp_f32 v21, v21
    v_exp_f32 v22, v22
    v_exp_f32 v23, v23
    v_cvt_pk_bf16_f32 v64, v16, v17
    v_cvt_pk_bf16_f32 v65, v18, v19
    v_cvt_pk_bf16_f32 v66, v20, v21
    v_cvt_pk_bf16_f32 v67, v22, v23
    v_exp_f32 v24, v24
    v_mfma_f32_32x32x16_bf16 v[32:47], v[84:87], v[12:15], v[32:47]
    v_exp_f32 v25, v25
    v_exp_f32 v26, v26
    v_exp_f32 v27, v27
    v_mfma_f32_32x32x16_bf16 v[48:63], v[88:91], v[64:67], v[48:63]
    v_exp_f32 v28, v28
    v_exp_f32 v29, v29
    v_exp_f32 v30, v30
    v_exp_f32 v31, v31
    v_cvt_pk_bf16_f32 v68, v24, v25
    v_cvt_pk_bf16_f32 v69, v26, v27
    v_cvt_pk_bf16_f32 v70, v28, v29
    v_cvt_pk_bf16_f32 v71, v30, v31
    s_waitcnt lgkmcnt(0)
    v_exp_f32 v32, v32
    v_exp_f32 v33, v33
    v_mfma_f32_32x32x16_bf16 v[48:63], v[92:95], v[68:71], v[48:63]
    ds_read_b128 v[80:83], v136 offset:23040
    ds_read_b64 v[84:85], v137 offset:24064
    s_mov_b64 exec, s[40:41]
    ds_read_b128 v[88:91], v138 offset:21760
    ds_read_b128 v[92:95], v138 offset:22400
    s_mov_b64 exec, -1
    v_exp_f32 v34, v34
    v_exp_f32 v35, v35
    v_exp_f32 v36, v36
    v_mfma_f32_32x32x16_bf16 v[16:31], v[72:75], v[8:11], 0
    v_exp_f32 v37, v37
    v_exp_f32 v38, v38
    v_exp_f32 v39, v39
    v_cvt_pk_bf16_f32 v64, v32, v33
    v_cvt_pk_bf16_f32 v65, v34, v35
    v_cvt_pk_bf16_f32 v66, v36, v37
    v_cvt_pk_bf16_f32 v67, v38, v39
    v_exp_f32 v40, v40
    v_mfma_f32_32x32x16_bf16 v[16:31], v[76:79], v[12:15], v[16:31]
    v_exp_f32 v41, v41
    v_exp_f32 v42, v42
    v_exp_f32 v43, v43
    v_mfma_f32_32x32x16_bf16 v[48:63], v[96:99], v[64:67], v[48:63]
    v_exp_f32 v44, v44
    v_exp_f32 v45, v45
    v_exp_f32 v46, v46
    v_exp_f32 v47, v47
    v_cvt_pk_bf16_f32 v68, v40, v41
    v_cvt_pk_bf16_f32 v69, v42, v43
    v_cvt_pk_bf16_f32 v70, v44, v45
    v_cvt_pk_bf16_f32 v71, v46, v47
    v_add_u32 v136, 20480, v136
    v_add_u32 v137, 20480, v137
    v_add_u32 v138, 20480, v138
    s_cmp_eq_u32 s42, s53
    s_cbranch_scc0 attn_kernel_nobar
    s_waitcnt vmcnt(0)
    s_barrier
attn_kernel_nobar:
    s_sub_u32 s42, s42, 1
    s_cmp_lg_u32 s42, 0
    s_cbranch_scc1 attn_kernel_loop
    s_nop 1
    v_mfma_f32_32x32x16_bf16 v[48:63], v[100:103], v[68:71], v[48:63]
    s_nop 15
    s_nop 3
    v_mov_b32 v108, v56
    v_mov_b32 v109, v56
    s_nop 1
    v_permlane32_swap_b32 v108, v109
    s_nop 1
    v_rcp_f32 v109, v109
    s_nop 0
    v_mul_f32 v48, v48, v109
    v_mul_f32 v49, v49, v109
    v_mul_f32 v50, v50, v109
    v_mul_f32 v51, v51, v109
    v_mul_f32 v52, v52, v109
    v_mul_f32 v53, v53, v109
    v_mul_f32 v54, v54, v109
    v_mul_f32 v55, v55, v109
    v_mul_f32 v56, v56, v109
    v_mul_f32 v57, v57, v109
    v_mul_f32 v58, v58, v109
    v_mul_f32 v59, v59, v109
    v_cvt_pk_bf16_f32 v64, v48, v49
    v_cvt_pk_bf16_f32 v65, v50, v51
    v_cvt_pk_bf16_f32 v66, v52, v53
    v_cvt_pk_bf16_f32 v67, v54, v55
    v_cvt_pk_bf16_f32 v68, v56, v57
    v_cvt_pk_bf16_f32 v69, v58, v59
    v_lshl_add_u32 v6, v4, 3, v139
    s_nop 0
    v_permlane32_swap_b32 v64, v66
    v_permlane32_swap_b32 v65, v67
    s_nop 1
    buffer_store_dwordx4 v[64:67], v6, s[32:35], s19 offen
    s_mov_b32 exec_hi, 0
    buffer_store_dwordx2 v[68:69], v139, s[32:35], s19 offen offset:32
attn_kernel_end:
attn_kernel_exit:
    s_endpgm
.globl oproj_kernel
.p2align 8
.type oproj_kernel,@function
oproj_kernel:
    s_cmp_ge_u32 s2, 256
    s_cbranch_scc1 oproj_kernel_exit
    s_load_dwordx2 s[4:5], s[0:1], 0
    s_load_dwordx2 s[12:13], s[0:1], 96
    s_load_dwordx2 s[14:15], s[0:1], 48
    v_and_b32 v1, 63, v0
    v_lshrrev_b32 v2, 6, v0
    s_lshr_b32 s16, s2, 5
    s_and_b32 s17, s2, 7
    s_lshl_b32 s17, s17, 2
    s_bfe_u32 s44, s2, 0x20003
    s_add_u32 s17, s17, s44
    v_readfirstlane_b32 s18, v2
    v_and_b32 v3, 15, v1
    v_lshrrev_b32 v4, 4, v1
    s_waitcnt lgkmcnt(0)
    s_add_u32 s20, s12, 8388608
    s_addc_u32 s21, s13, 0
    s_mov_b32 s22, 2621440
    s_mov_b32 s23, 0x00020000
    s_mul_i32 s44, s16, 102400
    s_add_u32 s44, s44, 26214400
    s_add_u32 s24, s12, s44
    s_addc_u32 s25, s13, 0
    s_mov_b32 s26, 102400
    s_mov_b32 s27, 0x00020000
    s_mov_b32 s28, s4
    s_mov_b32 s29, s5
    s_mov_b32 s30, 2621440
    s_mov_b32 s31, 0x00020000
    s_mov_b32 s32, s14
    s_mov_b32 s33, s15
    s_mov_b32 s34, 1280
    s_mov_b32 s35, 0x00020000
    s_add_u32 s36, s12, 12582912
    s_addc_u32 s37, s13, 0
    s_mov_b32 s38, 2621440
    s_mov_b32 s39, 0x00020000
    s_add_u32 s40, s12, 16777216
    s_addc_u32 s41, s13, 0
    s_mov_b32 s42, 32768
    s_mov_b32 s43, 0x00020000
    s_cmp_lt_u32 s18, 4
    s_cbranch_scc0 oproj_kernel_idle
    s_lshl_b32 s45, s17, 6
    s_and_b32 s46, s18, 1
    s_lshl_b32 s46, s46, 5
    s_add_u32 s45, s45, s46
    v_add_u32 v5, s45, v3
    v_mul_u32_u24 v10, 1280, v5
    v_lshl_add_u32 v10, v4, 3, v10
    v_lshlrev_b32 v11, 3, v4
    s_mul_i32 s59, s16, 160
    s_add_u32 s58, s59, 20480
    s_cmp_lt_u32 s18, 2
    s_cbranch_scc0 oproj_kernel_mm1
    buffer_load_dwordx2 v[88:89], v10, s[28:31], s59 offen offset:0
    buffer_load_dwordx2 v[94:95], v10, s[28:31], s58 offen offset:0
    buffer_load_dwordx2 v[112:113], v11, s[32:35], s59 offen offset:0
    buffer_load_dwordx2 v[90:91], v10, s[28:31], s59 offen offset:32
    buffer_load_dwordx2 v[96:97], v10, s[28:31], s58 offen offset:32
    buffer_load_dwordx2 v[114:115], v11, s[32:35], s59 offen offset:32
    buffer_load_dwordx2 v[92:93], v10, s[28:31], s59 offen offset:64
    buffer_load_dwordx2 v[98:99], v10, s[28:31], s58 offen offset:64
    buffer_load_dwordx2 v[116:117], v11, s[32:35], s59 offen offset:64
    v_lshlrev_b32 v6, 8, v3
    v_and_b32 v7, 3, v3
    v_xor_b32 v7, v7, v4
    v_lshl_add_u32 v6, v7, 4, v6
    s_and_b32 s46, s18, 1
    s_lshl_b32 s46, s46, 13
    s_add_u32 s46, s46, 0
    v_add_u32 v6, s46, v6
    v_and_b32 v7, 12, v3
    v_xor_b32 v8, 0, v7
    v_lshl_add_u32 v100, v8, 4, v6
    v_xor_b32 v8, 4, v7
    v_lshl_add_u32 v101, v8, 4, v6
    v_xor_b32 v8, 8, v7
    v_lshl_add_u32 v102, v8, 4, v6
    v_xor_b32 v8, 12, v7
    v_lshl_add_u32 v103, v8, 4, v6
    v_lshrrev_b32 v12, 2, v1
    v_and_b32 v12, 3, v12
    v_lshl_add_u32 v12, v4, 3, v12
    v_and_b32 v13, 3, v1
    v_mul_u32_u24 v104, 160, v12
    v_lshl_add_u32 v104, v13, 3, v104
    v_add_u32 v104, 16384, v104
    s_barrier
    ds_read_b128 v[16:19], v100 offset:0
    ds_read_b128 v[20:23], v100 offset:4096
    ds_read_b64_tr_b16 v[32:33], v104 offset:0
    ds_read_b64_tr_b16 v[34:35], v104 offset:640
    ds_read_b64_tr_b16 v[36:37], v104 offset:32
    ds_read_b64_tr_b16 v[38:39], v104 offset:672
    ds_read_b64_tr_b16 v[40:41], v104 offset:64
    ds_read_b64_tr_b16 v[42:43], v104 offset:704
    ds_read_b128 v[24:27], v101 offset:0
    ds_read_b128 v[28:31], v101 offset:4096
    ds_read_b64_tr_b16 v[44:45], v104 offset:5120
    ds_read_b64_tr_b16 v[46:47], v104 offset:5760
    ds_read_b64_tr_b16 v[48:49], v104 offset:5152
    ds_read_b64_tr_b16 v[50:51], v104 offset:5792
    ds_read_b64_tr_b16 v[52:53], v104 offset:5184
    ds_read_b64_tr_b16 v[54:55], v104 offset:5824
    s_waitcnt lgkmcnt(8)
    v_mfma_f32_16x16x32_bf16 v[64:67], v[32:35], v[16:19], 0
    v_mfma_f32_16x16x32_bf16 v[76:79], v[32:35], v[20:23], 0
    v_mfma_f32_16x16x32_bf16 v[68:71], v[36:39], v[16:19], 0
    v_mfma_f32_16x16x32_bf16 v[80:83], v[36:39], v[20:23], 0
    v_mfma_f32_16x16x32_bf16 v[72:75], v[40:43], v[16:19], 0
    v_mfma_f32_16x16x32_bf16 v[84:87], v[40:43], v[20:23], 0
    ds_read_b128 v[16:19], v102 offset:0
    ds_read_b128 v[20:23], v102 offset:4096
    ds_read_b64_tr_b16 v[32:33], v104 offset:10240
    ds_read_b64_tr_b16 v[34:35], v104 offset:10880
    ds_read_b64_tr_b16 v[36:37], v104 offset:10272
    ds_read_b64_tr_b16 v[38:39], v104 offset:10912
    ds_read_b64_tr_b16 v[40:41], v104 offset:10304
    ds_read_b64_tr_b16 v[42:43], v104 offset:10944
    s_waitcnt lgkmcnt(8)
    v_mfma_f32_16x16x32_bf16 v[64:67], v[44:47], v[24:27], v[64:67]
    v_mfma_f32_16x16x32_bf16 v[76:79], v[44:47], v[28:31], v[76:79]
    v_mfma_f32_16x16x32_bf16 v[68:71], v[48:51], v[24:27], v[68:71]
    v_mfma_f32_16x16x32_bf16 v[80:83], v[48:51], v[28:31], v[80:83]
    v_mfma_f32_16x16x32_bf16 v[72:75], v[52:55], v[24:27], v[72:75]
    v_mfma_f32_16x16x32_bf16 v[84:87], v[52:55], v[28:31], v[84:87]
    ds_read_b128 v[24:27], v103 offset:0
    ds_read_b128 v[28:31], v103 offset:4096
    ds_read_b64_tr_b16 v[44:45], v104 offset:15360
    ds_read_b64_tr_b16 v[46:47], v104 offset:16000
    ds_read_b64_tr_b16 v[48:49], v104 offset:15392
    ds_read_b64_tr_b16 v[50:51], v104 offset:16032
    ds_read_b64_tr_b16 v[52:53], v104 offset:15424
    ds_read_b64_tr_b16 v[54:55], v104 offset:16064
    s_waitcnt lgkmcnt(8)
    v_mfma_f32_16x16x32_bf16 v[64:67], v[32:35], v[16:19], v[64:67]
    v_mfma_f32_16x16x32_bf16 v[76:79], v[32:35], v[20:23], v[76:79]
    v_mfma_f32_16x16x32_bf16 v[68:71], v[36:39], v[16:19], v[68:71]
    v_mfma_f32_16x16x32_bf16 v[80:83], v[36:39], v[20:23], v[80:83]
    v_mfma_f32_16x16x32_bf16 v[72:75], v[40:43], v[16:19], v[72:75]
    v_mfma_f32_16x16x32_bf16 v[84:87], v[40:43], v[20:23], v[84:87]
    s_waitcnt lgkmcnt(0)
    v_add_u32 v100, 36864, v100
    v_add_u32 v101, 36864, v101
    v_add_u32 v102, 36864, v102
    v_add_u32 v103, 36864, v103
    v_add_u32 v104, 36864, v104
    v_mfma_f32_16x16x32_bf16 v[64:67], v[44:47], v[24:27], v[64:67]
    v_mfma_f32_16x16x32_bf16 v[76:79], v[44:47], v[28:31], v[76:79]
    v_mfma_f32_16x16x32_bf16 v[68:71], v[48:51], v[24:27], v[68:71]
    v_mfma_f32_16x16x32_bf16 v[80:83], v[48:51], v[28:31], v[80:83]
    v_mfma_f32_16x16x32_bf16 v[72:75], v[52:55], v[24:27], v[72:75]
    v_mfma_f32_16x16x32_bf16 v[84:87], v[52:55], v[28:31], v[84:87]
    s_barrier
    ds_read_b128 v[16:19], v100 offset:0
    ds_read_b128 v[20:23], v100 offset:4096
    ds_read_b64_tr_b16 v[32:33], v104 offset:0
    ds_read_b64_tr_b16 v[34:35], v104 offset:640
    ds_read_b64_tr_b16 v[36:37], v104 offset:32
    ds_read_b64_tr_b16 v[38:39], v104 offset:672
    ds_read_b64_tr_b16 v[40:41], v104 offset:64
    ds_read_b64_tr_b16 v[42:43], v104 offset:704
    ds_read_b128 v[24:27], v101 offset:0
    ds_read_b128 v[28:31], v101 offset:4096
    ds_read_b64_tr_b16 v[44:45], v104 offset:5120
    ds_read_b64_tr_b16 v[46:47], v104 offset:5760
    ds_read_b64_tr_b16 v[48:49], v104 offset:5152
    ds_read_b64_tr_b16 v[50:51], v104 offset:5792
    ds_read_b64_tr_b16 v[52:53], v104 offset:5184
    ds_read_b64_tr_b16 v[54:55], v104 offset:5824
    s_waitcnt lgkmcnt(8)
    v_mfma_f32_16x16x32_bf16 v[64:67], v[32:35], v[16:19], v[64:67]
    v_mfma_f32_16x16x32_bf16 v[76:79], v[32:35], v[20:23], v[76:79]
    v_mfma_f32_16x16x32_bf16 v[68:71], v[36:39], v[16:19], v[68:71]
    v_mfma_f32_16x16x32_bf16 v[80:83], v[36:39], v[20:23], v[80:83]
    v_mfma_f32_16x16x32_bf16 v[72:75], v[40:43], v[16:19], v[72:75]
    v_mfma_f32_16x16x32_bf16 v[84:87], v[40:43], v[20:23], v[84:87]
    ds_read_b128 v[16:19], v102 offset:0
    ds_read_b128 v[20:23], v102 offset:4096
    ds_read_b64_tr_b16 v[32:33], v104 offset:10240
    ds_read_b64_tr_b16 v[34:35], v104 offset:10880
    ds_read_b64_tr_b16 v[36:37], v104 offset:10272
    ds_read_b64_tr_b16 v[38:39], v104 offset:10912
    ds_read_b64_tr_b16 v[40:41], v104 offset:10304
    ds_read_b64_tr_b16 v[42:43], v104 offset:10944
    s_waitcnt lgkmcnt(8)
    v_mfma_f32_16x16x32_bf16 v[64:67], v[44:47], v[24:27], v[64:67]
    v_mfma_f32_16x16x32_bf16 v[76:79], v[44:47], v[28:31], v[76:79]
    v_mfma_f32_16x16x32_bf16 v[68:71], v[48:51], v[24:27], v[68:71]
    v_mfma_f32_16x16x32_bf16 v[80:83], v[48:51], v[28:31], v[80:83]
    v_mfma_f32_16x16x32_bf16 v[72:75], v[52:55], v[24:27], v[72:75]
    v_mfma_f32_16x16x32_bf16 v[84:87], v[52:55], v[28:31], v[84:87]
    ds_read_b128 v[24:27], v103 offset:0
    ds_read_b128 v[28:31], v103 offset:4096
    ds_read_b64_tr_b16 v[44:45], v104 offset:15360
    ds_read_b64_tr_b16 v[46:47], v104 offset:16000
    ds_read_b64_tr_b16 v[48:49], v104 offset:15392
    ds_read_b64_tr_b16 v[50:51], v104 offset:16032
    ds_read_b64_tr_b16 v[52:53], v104 offset:15424
    ds_read_b64_tr_b16 v[54:55], v104 offset:16064
    s_waitcnt lgkmcnt(8)
    v_mfma_f32_16x16x32_bf16 v[64:67], v[32:35], v[16:19], v[64:67]
    v_mfma_f32_16x16x32_bf16 v[76:79], v[32:35], v[20:23], v[76:79]
    v_mfma_f32_16x16x32_bf16 v[68:71], v[36:39], v[16:19], v[68:71]
    v_mfma_f32_16x16x32_bf16 v[80:83], v[36:39], v[20:23], v[80:83]
    v_mfma_f32_16x16x32_bf16 v[72:75], v[40:43], v[16:19], v[72:75]
    v_mfma_f32_16x16x32_bf16 v[84:87], v[40:43], v[20:23], v[84:87]
    s_waitcnt lgkmcnt(0)
    v_add_u32 v100, 36864, v100
    v_add_u32 v101, 36864, v101
    v_add_u32 v102, 36864, v102
    v_add_u32 v103, 36864, v103
    v_add_u32 v104, 36864, v104
    v_mfma_f32_16x16x32_bf16 v[64:67], v[44:47], v[24:27], v[64:67]
    v_mfma_f32_16x16x32_bf16 v[76:79], v[44:47], v[28:31], v[76:79]
    v_mfma_f32_16x16x32_bf16 v[68:71], v[48:51], v[24:27], v[68:71]
    v_mfma_f32_16x16x32_bf16 v[80:83], v[48:51], v[28:31], v[80:83]
    v_mfma_f32_16x16x32_bf16 v[72:75], v[52:55], v[24:27], v[72:75]
    v_mfma_f32_16x16x32_bf16 v[84:87], v[52:55], v[28:31], v[84:87]
    s_barrier
    ds_read_b128 v[16:19], v100 offset:0
    ds_read_b128 v[20:23], v100 offset:4096
    ds_read_b64_tr_b16 v[32:33], v104 offset:0
    ds_read_b64_tr_b16 v[34:35], v104 offset:640
    ds_read_b64_tr_b16 v[36:37], v104 offset:32
    ds_read_b64_tr_b16 v[38:39], v104 offset:672
    ds_read_b64_tr_b16 v[40:41], v104 offset:64
    ds_read_b64_tr_b16 v[42:43], v104 offset:704
    ds_read_b128 v[24:27], v101 offset:0
    ds_read_b128 v[28:31], v101 offset:4096
    ds_read_b64_tr_b16 v[44:45], v104 offset:5120
    ds_read_b64_tr_b16 v[46:47], v104 offset:5760
    ds_read_b64_tr_b16 v[48:49], v104 offset:5152
    ds_read_b64_tr_b16 v[50:51], v104 offset:5792
    ds_read_b64_tr_b16 v[52:53], v104 offset:5184
    ds_read_b64_tr_b16 v[54:55], v104 offset:5824
    s_waitcnt lgkmcnt(8)
    v_mfma_f32_16x16x32_bf16 v[64:67], v[32:35], v[16:19], v[64:67]
    v_mfma_f32_16x16x32_bf16 v[76:79], v[32:35], v[20:23], v[76:79]
    v_mfma_f32_16x16x32_bf16 v[68:71], v[36:39], v[16:19], v[68:71]
    v_mfma_f32_16x16x32_bf16 v[80:83], v[36:39], v[20:23], v[80:83]
    v_mfma_f32_16x16x32_bf16 v[72:75], v[40:43], v[16:19], v[72:75]
    v_mfma_f32_16x16x32_bf16 v[84:87], v[40:43], v[20:23], v[84:87]
    ds_read_b128 v[16:19], v102 offset:0
    ds_read_b128 v[20:23], v102 offset:4096
    ds_read_b64_tr_b16 v[32:33], v104 offset:10240
    ds_read_b64_tr_b16 v[34:35], v104 offset:10880
    ds_read_b64_tr_b16 v[36:37], v104 offset:10272
    ds_read_b64_tr_b16 v[38:39], v104 offset:10912
    ds_read_b64_tr_b16 v[40:41], v104 offset:10304
    ds_read_b64_tr_b16 v[42:43], v104 offset:10944
    s_waitcnt lgkmcnt(8)
    v_mfma_f32_16x16x32_bf16 v[64:67], v[44:47], v[24:27], v[64:67]
    v_mfma_f32_16x16x32_bf16 v[76:79], v[44:47], v[28:31], v[76:79]
    v_mfma_f32_16x16x32_bf16 v[68:71], v[48:51], v[24:27], v[68:71]
    v_mfma_f32_16x16x32_bf16 v[80:83], v[48:51], v[28:31], v[80:83]
    v_mfma_f32_16x16x32_bf16 v[72:75], v[52:55], v[24:27], v[72:75]
    v_mfma_f32_16x16x32_bf16 v[84:87], v[52:55], v[28:31], v[84:87]
    ds_read_b128 v[24:27], v103 offset:0
    ds_read_b128 v[28:31], v103 offset:4096
    ds_read_b64_tr_b16 v[44:45], v104 offset:15360
    ds_read_b64_tr_b16 v[46:47], v104 offset:16000
    ds_read_b64_tr_b16 v[48:49], v104 offset:15392
    ds_read_b64_tr_b16 v[50:51], v104 offset:16032
    ds_read_b64_tr_b16 v[52:53], v104 offset:15424
    ds_read_b64_tr_b16 v[54:55], v104 offset:16064
    s_waitcnt lgkmcnt(8)
    v_mfma_f32_16x16x32_bf16 v[64:67], v[32:35], v[16:19], v[64:67]
    v_mfma_f32_16x16x32_bf16 v[76:79], v[32:35], v[20:23], v[76:79]
    v_mfma_f32_16x16x32_bf16 v[68:71], v[36:39], v[16:19], v[68:71]
    v_mfma_f32_16x16x32_bf16 v[80:83], v[36:39], v[20:23], v[80:83]
    v_mfma_f32_16x16x32_bf16 v[72:75], v[40:43], v[16:19], v[72:75]
    v_mfma_f32_16x16x32_bf16 v[84:87], v[40:43], v[20:23], v[84:87]
    s_waitcnt lgkmcnt(0)
    v_add_u32 v100, 4294893568, v100
    v_add_u32 v101, 4294893568, v101
    v_add_u32 v102, 4294893568, v102
    v_add_u32 v103, 4294893568, v103
    v_add_u32 v104, 4294893568, v104
    v_mfma_f32_16x16x32_bf16 v[64:67], v[44:47], v[24:27], v[64:67]
    v_mfma_f32_16x16x32_bf16 v[76:79], v[44:47], v[28:31], v[76:79]
    v_mfma_f32_16x16x32_bf16 v[68:71], v[48:51], v[24:27], v[68:71]
    v_mfma_f32_16x16x32_bf16 v[80:83], v[48:51], v[28:31], v[80:83]
    v_mfma_f32_16x16x32_bf16 v[72:75], v[52:55], v[24:27], v[72:75]
    v_mfma_f32_16x16x32_bf16 v[84:87], v[52:55], v[28:31], v[84:87]
    s_barrier
    ds_read_b128 v[16:19], v100 offset:0
    ds_read_b128 v[20:23], v100 offset:4096
    ds_read_b64_tr_b16 v[32:33], v104 offset:0
    ds_read_b64_tr_b16 v[34:35], v104 offset:640
    ds_read_b64_tr_b16 v[36:37], v104 offset:32
    ds_read_b64_tr_b16 v[38:39], v104 offset:672
    ds_read_b64_tr_b16 v[40:41], v104 offset:64
    ds_read_b64_tr_b16 v[42:43], v104 offset:704
    ds_read_b128 v[24:27], v101 offset:0
    ds_read_b128 v[28:31], v101 offset:4096
    ds_read_b64_tr_b16 v[44:45], v104 offset:5120
    ds_read_b64_tr_b16 v[46:47], v104 offset:5760
    ds_read_b64_tr_b16 v[48:49], v104 offset:5152
    ds_read_b64_tr_b16 v[50:51], v104 offset:5792
    ds_read_b64_tr_b16 v[52:53], v104 offset:5184
    ds_read_b64_tr_b16 v[54:55], v104 offset:5824
    s_waitcnt lgkmcnt(8)
    v_mfma_f32_16x16x32_bf16 v[64:67], v[32:35], v[16:19], v[64:67]
    v_mfma_f32_16x16x32_bf16 v[76:79], v[32:35], v[20:23], v[76:79]
    v_mfma_f32_16x16x32_bf16 v[68:71], v[36:39], v[16:19], v[68:71]
    v_mfma_f32_16x16x32_bf16 v[80:83], v[36:39], v[20:23], v[80:83]
    v_mfma_f32_16x16x32_bf16 v[72:75], v[40:43], v[16:19], v[72:75]
    v_mfma_f32_16x16x32_bf16 v[84:87], v[40:43], v[20:23], v[84:87]
    ds_read_b128 v[16:19], v102 offset:0
    ds_read_b128 v[20:23], v102 offset:4096
    ds_read_b64_tr_b16 v[32:33], v104 offset:10240
    ds_read_b64_tr_b16 v[34:35], v104 offset:10880
    ds_read_b64_tr_b16 v[36:37], v104 offset:10272
    ds_read_b64_tr_b16 v[38:39], v104 offset:10912
    ds_read_b64_tr_b16 v[40:41], v104 offset:10304
    ds_read_b64_tr_b16 v[42:43], v104 offset:10944
    s_waitcnt lgkmcnt(8)
    v_mfma_f32_16x16x32_bf16 v[64:67], v[44:47], v[24:27], v[64:67]
    v_mfma_f32_16x16x32_bf16 v[76:79], v[44:47], v[28:31], v[76:79]
    v_mfma_f32_16x16x32_bf16 v[68:71], v[48:51], v[24:27], v[68:71]
    v_mfma_f32_16x16x32_bf16 v[80:83], v[48:51], v[28:31], v[80:83]
    v_mfma_f32_16x16x32_bf16 v[72:75], v[52:55], v[24:27], v[72:75]
    v_mfma_f32_16x16x32_bf16 v[84:87], v[52:55], v[28:31], v[84:87]
    ds_read_b128 v[24:27], v103 offset:0
    ds_read_b128 v[28:31], v103 offset:4096
    ds_read_b64_tr_b16 v[44:45], v104 offset:15360
    ds_read_b64_tr_b16 v[46:47], v104 offset:16000
    ds_read_b64_tr_b16 v[48:49], v104 offset:15392
    ds_read_b64_tr_b16 v[50:51], v104 offset:16032
    ds_read_b64_tr_b16 v[52:53], v104 offset:15424
    ds_read_b64_tr_b16 v[54:55], v104 offset:16064
    s_waitcnt lgkmcnt(8)
    v_mfma_f32_16x16x32_bf16 v[64:67], v[32:35], v[16:19], v[64:67]
    v_mfma_f32_16x16x32_bf16 v[76:79], v[32:35], v[20:23], v[76:79]
    v_mfma_f32_16x16x32_bf16 v[68:71], v[36:39], v[16:19], v[68:71]
    v_mfma_f32_16x16x32_bf16 v[80:83], v[36:39], v[20:23], v[80:83]
    v_mfma_f32_16x16x32_bf16 v[72:75], v[40:43], v[16:19], v[72:75]
    v_mfma_f32_16x16x32_bf16 v[84:87], v[40:43], v[20:23], v[84:87]
    s_waitcnt lgkmcnt(0)
    v_add_u32 v100, 36864, v100
    v_add_u32 v101, 36864, v101
    v_add_u32 v102, 36864, v102
    v_add_u32 v103, 36864, v103
    v_add_u32 v104, 36864, v104
    v_mfma_f32_16x16x32_bf16 v[64:67], v[44:47], v[24:27], v[64:67]
    v_mfma_f32_16x16x32_bf16 v[76:79], v[44:47], v[28:31], v[76:79]
    v_mfma_f32_16x16x32_bf16 v[68:71], v[48:51], v[24:27], v[68:71]
    v_mfma_f32_16x16x32_bf16 v[80:83], v[48:51], v[28:31], v[80:83]
    v_mfma_f32_16x16x32_bf16 v[72:75], v[52:55], v[24:27], v[72:75]
    v_mfma_f32_16x16x32_bf16 v[84:87], v[52:55], v[28:31], v[84:87]
    s_barrier
    ds_read_b128 v[16:19], v100 offset:0
    ds_read_b128 v[20:23], v100 offset:4096
    ds_read_b64_tr_b16 v[32:33], v104 offset:0
    ds_read_b64_tr_b16 v[34:35], v104 offset:640
    ds_read_b64_tr_b16 v[36:37], v104 offset:32
    ds_read_b64_tr_b16 v[38:39], v104 offset:672
    ds_read_b64_tr_b16 v[40:41], v104 offset:64
    ds_read_b64_tr_b16 v[42:43], v104 offset:704
    ds_read_b128 v[24:27], v101 offset:0
    ds_read_b128 v[28:31], v101 offset:4096
    ds_read_b64_tr_b16 v[44:45], v104 offset:5120
    ds_read_b64_tr_b16 v[46:47], v104 offset:5760
    ds_read_b64_tr_b16 v[48:49], v104 offset:5152
    ds_read_b64_tr_b16 v[50:51], v104 offset:5792
    ds_read_b64_tr_b16 v[52:53], v104 offset:5184
    ds_read_b64_tr_b16 v[54:55], v104 offset:5824
    s_waitcnt lgkmcnt(8)
    v_mfma_f32_16x16x32_bf16 v[64:67], v[32:35], v[16:19], v[64:67]
    v_mfma_f32_16x16x32_bf16 v[76:79], v[32:35], v[20:23], v[76:79]
    v_mfma_f32_16x16x32_bf16 v[68:71], v[36:39], v[16:19], v[68:71]
    v_mfma_f32_16x16x32_bf16 v[80:83], v[36:39], v[20:23], v[80:83]
    v_mfma_f32_16x16x32_bf16 v[72:75], v[40:43], v[16:19], v[72:75]
    v_mfma_f32_16x16x32_bf16 v[84:87], v[40:43], v[20:23], v[84:87]
    ds_read_b128 v[16:19], v102 offset:0
    ds_read_b128 v[20:23], v102 offset:4096
    ds_read_b64_tr_b16 v[32:33], v104 offset:10240
    ds_read_b64_tr_b16 v[34:35], v104 offset:10880
    ds_read_b64_tr_b16 v[36:37], v104 offset:10272
    ds_read_b64_tr_b16 v[38:39], v104 offset:10912
    ds_read_b64_tr_b16 v[40:41], v104 offset:10304
    ds_read_b64_tr_b16 v[42:43], v104 offset:10944
    s_waitcnt lgkmcnt(8)
    v_mfma_f32_16x16x32_bf16 v[64:67], v[44:47], v[24:27], v[64:67]
    v_mfma_f32_16x16x32_bf16 v[76:79], v[44:47], v[28:31], v[76:79]
    v_mfma_f32_16x16x32_bf16 v[68:71], v[48:51], v[24:27], v[68:71]
    v_mfma_f32_16x16x32_bf16 v[80:83], v[48:51], v[28:31], v[80:83]
    v_mfma_f32_16x16x32_bf16 v[72:75], v[52:55], v[24:27], v[72:75]
    v_mfma_f32_16x16x32_bf16 v[84:87], v[52:55], v[28:31], v[84:87]
    ds_read_b128 v[24:27], v103 offset:0
    ds_read_b128 v[28:31], v103 offset:4096
    ds_read_b64_tr_b16 v[44:45], v104 offset:15360
    ds_read_b64_tr_b16 v[46:47], v104 offset:16000
    ds_read_b64_tr_b16 v[48:49], v104 offset:15392
    ds_read_b64_tr_b16 v[50:51], v104 offset:16032
    ds_read_b64_tr_b16 v[52:53], v104 offset:15424
    ds_read_b64_tr_b16 v[54:55], v104 offset:16064
    s_waitcnt lgkmcnt(8)
    v_mfma_f32_16x16x32_bf16 v[64:67], v[32:35], v[16:19], v[64:67]
    v_mfma_f32_16x16x32_bf16 v[76:79], v[32:35], v[20:23], v[76:79]
    v_mfma_f32_16x16x32_bf16 v[68:71], v[36:39], v[16:19], v[68:71]
    v_mfma_f32_16x16x32_bf16 v[80:83], v[36:39], v[20:23], v[80:83]
    v_mfma_f32_16x16x32_bf16 v[72:75], v[40:43], v[16:19], v[72:75]
    v_mfma_f32_16x16x32_bf16 v[84:87], v[40:43], v[20:23], v[84:87]
    s_waitcnt lgkmcnt(0)
    v_mfma_f32_16x16x32_bf16 v[64:67], v[44:47], v[24:27], v[64:67]
    v_mfma_f32_16x16x32_bf16 v[76:79], v[44:47], v[28:31], v[76:79]
    v_mfma_f32_16x16x32_bf16 v[68:71], v[48:51], v[24:27], v[68:71]
    v_mfma_f32_16x16x32_bf16 v[80:83], v[48:51], v[28:31], v[80:83]
    v_mfma_f32_16x16x32_bf16 v[72:75], v[52:55], v[24:27], v[72:75]
    v_mfma_f32_16x16x32_bf16 v[84:87], v[52:55], v[28:31], v[84:87]
    s_waitcnt vmcnt(0)
    s_nop 7
    v_mov_b32 v15, 0x3f803f80
    v_mov_b32 v118, 0
    v_mov_b32 v119, 0
    v_mov_b32 v120, 0
    v_mov_b32 v121, 0
    v_cvt_pk_bf16_f32 v64, v64, v65
    v_cvt_pk_bf16_f32 v65, v66, v67
    v_lshlrev_b32 v12, 16, v64
    v_and_b32 v13, 0xffff0000, v64
    v_lshlrev_b32 v6, 16, v88
    v_and_b32 v7, 0xffff0000, v88
    v_add_f32 v12, v12, v6
    v_add_f32 v13, v13, v7
    v_cvt_pk_bf16_f32 v64, v12, v13
    v_dot2_f32_bf16 v118, v64, v15, v118
    v_dot2_f32_bf16 v119, v64, v64, v119
    v_dot2_f32_bf16 v120, v64, v112, v120
    v_lshlrev_b32 v12, 16, v65
    v_and_b32 v13, 0xffff0000, v65
    v_lshlrev_b32 v6, 16, v89
    v_and_b32 v7, 0xffff0000, v89
    v_add_f32 v12, v12, v6
    v_add_f32 v13, v13, v7
    v_cvt_pk_bf16_f32 v65, v12, v13
    v_dot2_f32_bf16 v118, v65, v15, v118
    v_dot2_f32_bf16 v119, v65, v65, v119
    v_dot2_f32_bf16 v120, v65, v113, v120
    buffer_store_dwordx2 v[64:65], v10, s[36:39], s59 offen offset:0
    v_cvt_pk_bf16_f32 v68, v68, v69
    v_cvt_pk_bf16_f32 v69, v70, v71
    v_lshlrev_b32 v12, 16, v68
    v_and_b32 v13, 0xffff0000, v68
    v_lshlrev_b32 v6, 16, v90
    v_and_b32 v7, 0xffff0000, v90
    v_add_f32 v12, v12, v6
    v_add_f32 v13, v13, v7
    v_cvt_pk_bf16_f32 v68, v12, v13
    v_dot2_f32_bf16 v118, v68, v15, v118
    v_dot2_f32_bf16 v119, v68, v68, v119
    v_dot2_f32_bf16 v120, v68, v114, v120
    v_lshlrev_b32 v12, 16, v69
    v_and_b32 v13, 0xffff0000, v69
    v_lshlrev_b32 v6, 16, v91
    v_and_b32 v7, 0xffff0000, v91
    v_add_f32 v12, v12, v6
    v_add_f32 v13, v13, v7
    v_cvt_pk_bf16_f32 v69, v12, v13
    v_dot2_f32_bf16 v118, v69, v15, v118
    v_dot2_f32_bf16 v119, v69, v69, v119
    v_dot2_f32_bf16 v120, v69, v115, v120
    buffer_store_dwordx2 v[68:69], v10, s[36:39], s59 offen offset:32
    v_cvt_pk_bf16_f32 v72, v72, v73
    v_cvt_pk_bf16_f32 v73, v74, v75
    v_lshlrev_b32 v12, 16, v72
    v_and_b32 v13, 0xffff0000, v72
    v_lshlrev_b32 v6, 16, v92
    v_and_b32 v7, 0xffff0000, v92
    v_add_f32 v12, v12, v6
    v_add_f32 v13, v13, v7
    v_cvt_pk_bf16_f32 v72, v12, v13
    v_dot2_f32_bf16 v118, v72, v15, v118
    v_dot2_f32_bf16 v119, v72, v72, v119
    v_dot2_f32_bf16 v120, v72, v116, v120
    v_lshlrev_b32 v12, 16, v73
    v_and_b32 v13, 0xffff0000, v73
    v_lshlrev_b32 v6, 16, v93
    v_and_b32 v7, 0xffff0000, v93
    v_add_f32 v12, v12, v6
    v_add_f32 v13, v13, v7
    v_cvt_pk_bf16_f32 v73, v12, v13
    v_dot2_f32_bf16 v118, v73, v15, v118
    v_dot2_f32_bf16 v119, v73, v73, v119
    v_dot2_f32_bf16 v120, v73, v117, v120
    buffer_store_dwordx2 v[72:73], v10, s[36:39], s59 offen offset:64
    v_mov_b32 v122, 0
    v_mov_b32 v123, 0
    v_mov_b32 v124, 0
    v_mov_b32 v125, 0
    v_cvt_pk_bf16_f32 v76, v76, v77
    v_cvt_pk_bf16_f32 v77, v78, v79
    v_lshlrev_b32 v12, 16, v76
    v_and_b32 v13, 0xffff0000, v76
    v_lshlrev_b32 v6, 16, v94
    v_and_b32 v7, 0xffff0000, v94
    v_add_f32 v12, v12, v6
    v_add_f32 v13, v13, v7
    v_cvt_pk_bf16_f32 v76, v12, v13
    v_dot2_f32_bf16 v122, v76, v15, v122
    v_dot2_f32_bf16 v123, v76, v76, v123
    v_dot2_f32_bf16 v124, v76, v112, v124
    v_lshlrev_b32 v12, 16, v77
    v_and_b32 v13, 0xffff0000, v77
    v_lshlrev_b32 v6, 16, v95
    v_and_b32 v7, 0xffff0000, v95
    v_add_f32 v12, v12, v6
    v_add_f32 v13, v13, v7
    v_cvt_pk_bf16_f32 v77, v12, v13
    v_dot2_f32_bf16 v122, v77, v15, v122
    v_dot2_f32_bf16 v123, v77, v77, v123
    v_dot2_f32_bf16 v124, v77, v113, v124
    buffer_store_dwordx2 v[76:77], v10, s[36:39], s58 offen offset:0
    v_cvt_pk_bf16_f32 v80, v80, v81
    v_cvt_pk_bf16_f32 v81, v82, v83
    v_lshlrev_b32 v12, 16, v80
    v_and_b32 v13, 0xffff0000, v80
    v_lshlrev_b32 v6, 16, v96
    v_and_b32 v7, 0xffff0000, v96
    v_add_f32 v12, v12, v6
    v_add_f32 v13, v13, v7
    v_cvt_pk_bf16_f32 v80, v12, v13
    v_dot2_f32_bf16 v122, v80, v15, v122
    v_dot2_f32_bf16 v123, v80, v80, v123
    v_dot2_f32_bf16 v124, v80, v114, v124
    v_lshlrev_b32 v12, 16, v81
    v_and_b32 v13, 0xffff0000, v81
    v_lshlrev_b32 v6, 16, v97
    v_and_b32 v7, 0xffff0000, v97
    v_add_f32 v12, v12, v6
    v_add_f32 v13, v13, v7
    v_cvt_pk_bf16_f32 v81, v12, v13
    v_dot2_f32_bf16 v122, v81, v15, v122
    v_dot2_f32_bf16 v123, v81, v81, v123
    v_dot2_f32_bf16 v124, v81, v115, v124
    buffer_store_dwordx2 v[80:81], v10, s[36:39], s58 offen offset:32
    v_cvt_pk_bf16_f32 v84, v84, v85
    v_cvt_pk_bf16_f32 v85, v86, v87
    v_lshlrev_b32 v12, 16, v84
    v_and_b32 v13, 0xffff0000, v84
    v_lshlrev_b32 v6, 16, v98
    v_and_b32 v7, 0xffff0000, v98
    v_add_f32 v12, v12, v6
    v_add_f32 v13, v13, v7
    v_cvt_pk_bf16_f32 v84, v12, v13
    v_dot2_f32_bf16 v122, v84, v15, v122
    v_dot2_f32_bf16 v123, v84, v84, v123
    v_dot2_f32_bf16 v124, v84, v116, v124
    v_lshlrev_b32 v12, 16, v85
    v_and_b32 v13, 0xffff0000, v85
    v_lshlrev_b32 v6, 16, v99
    v_and_b32 v7, 0xffff0000, v99
    v_add_f32 v12, v12, v6
    v_add_f32 v13, v13, v7
    v_cvt_pk_bf16_f32 v85, v12, v13
    v_dot2_f32_bf16 v122, v85, v15, v122
    v_dot2_f32_bf16 v123, v85, v85, v123
    v_dot2_f32_bf16 v124, v85, v117, v124
    buffer_store_dwordx2 v[84:85], v10, s[36:39], s58 offen offset:64
    s_nop 3
    ds_swizzle_b32 v16, v118 offset:0x401F
    ds_swizzle_b32 v17, v119 offset:0x401F
    ds_swizzle_b32 v18, v120 offset:0x401F
    ds_swizzle_b32 v19, v122 offset:0x401F
    ds_swizzle_b32 v20, v123 offset:0x401F
    ds_swizzle_b32 v21, v124 offset:0x401F
    s_waitcnt lgkmcnt(0)
    v_add_f32 v118, v118, v16
    v_mov_b32 v16, v118
    v_add_f32 v119, v119, v17
    v_mov_b32 v17, v119
    v_add_f32 v120, v120, v18
    v_mov_b32 v18, v120
    v_add_f32 v122, v122, v19
    v_mov_b32 v19, v122
    v_add_f32 v123, v123, v20
    v_mov_b32 v20, v123
    v_add_f32 v124, v124, v21
    v_mov_b32 v21, v124
    s_nop 1
    v_permlane32_swap_b32 v16, v118
    v_permlane32_swap_b32 v17, v119
    v_permlane32_swap_b32 v18, v120
    v_permlane32_swap_b32 v19, v122
    v_permlane32_swap_b32 v20, v123
    v_permlane32_swap_b32 v21, v124
    s_nop 1
    v_add_f32 v118, v118, v16
    v_add_f32 v119, v119, v17
    v_add_f32 v120, v120, v18
    v_add_f32 v122, v122, v19
    v_add_f32 v123, v123, v20
    v_add_f32 v124, v124, v21
    v_lshlrev_b32 v14, 4, v5
    v_lshl_add_u32 v14, v4, 2, v14
    v_cmp_eq_u32 vcc, 1, v4
    v_cmp_eq_u32 s[46:47], 2, v4
    v_cmp_eq_u32 s[48:49], 3, v4
    s_nop 1
    v_cndmask_b32 v118, v118, v119, vcc
    v_cndmask_b32 v118, v118, v120, s[46:47]
    v_cndmask_b32 v118, v118, v121, s[48:49]
    buffer_atomic_add_f32 v118, v14, s[40:43], 0 offen offset:0
    v_cndmask_b32 v122, v122, v123, vcc
    v_cndmask_b32 v122, v122, v124, s[46:47]
    v_cndmask_b32 v122, v122, v125, s[48:49]
    buffer_atomic_add_f32 v122, v14, s[40:43], 0 offen offset:256
    s_branch oproj_kernel_end
oproj_kernel_mm1:
    buffer_load_dwordx2 v[88:89], v10, s[28:31], s59 offen offset:96
    buffer_load_dwordx2 v[94:95], v10, s[28:31], s58 offen offset:96
    buffer_load_dwordx2 v[112:113], v11, s[32:35], s59 offen offset:96
    buffer_load_dwordx2 v[90:91], v10, s[28:31], s59 offen offset:128
    buffer_load_dwordx2 v[96:97], v10, s[28:31], s58 offen offset:128
    buffer_load_dwordx2 v[114:115], v11, s[32:35], s59 offen offset:128
    v_lshlrev_b32 v6, 8, v3
    v_and_b32 v7, 3, v3
    v_xor_b32 v7, v7, v4
    v_lshl_add_u32 v6, v7, 4, v6
    s_and_b32 s46, s18, 1
    s_lshl_b32 s46, s46, 13
    s_add_u32 s46, s46, 0
    v_add_u32 v6, s46, v6
    v_and_b32 v7, 12, v3
    v_xor_b32 v8, 0, v7
    v_lshl_add_u32 v100, v8, 4, v6
    v_xor_b32 v8, 4, v7
    v_lshl_add_u32 v101, v8, 4, v6
    v_xor_b32 v8, 8, v7
    v_lshl_add_u32 v102, v8, 4, v6
    v_xor_b32 v8, 12, v7
    v_lshl_add_u32 v103, v8, 4, v6
    v_lshrrev_b32 v12, 2, v1
    v_and_b32 v12, 3, v12
    v_lshl_add_u32 v12, v4, 3, v12
    v_and_b32 v13, 3, v1
    v_mul_u32_u24 v104, 160, v12
    v_lshl_add_u32 v104, v13, 3, v104
    v_add_u32 v104, 16384, v104
    s_barrier
    ds_read_b128 v[16:19], v100 offset:0
    ds_read_b128 v[20:23], v100 offset:4096
    ds_read_b64_tr_b16 v[32:33], v104 offset:96
    ds_read_b64_tr_b16 v[34:35], v104 offset:736
    ds_read_b64_tr_b16 v[36:37], v104 offset:128
    ds_read_b64_tr_b16 v[38:39], v104 offset:768
    ds_read_b128 v[24:27], v101 offset:0
    ds_read_b128 v[28:31], v101 offset:4096
    ds_read_b64_tr_b16 v[44:45], v104 offset:5216
    ds_read_b64_tr_b16 v[46:47], v104 offset:5856
    ds_read_b64_tr_b16 v[48:49], v104 offset:5248
    ds_read_b64_tr_b16 v[50:51], v104 offset:5888
    s_waitcnt lgkmcnt(6)
    v_mfma_f32_16x16x32_bf16 v[64:67], v[32:35], v[16:19], 0
    v_mfma_f32_16x16x32_bf16 v[76:79], v[32:35], v[20:23], 0
    v_mfma_f32_16x16x32_bf16 v[68:71], v[36:39], v[16:19], 0
    v_mfma_f32_16x16x32_bf16 v[80:83], v[36:39], v[20:23], 0
    ds_read_b128 v[16:19], v102 offset:0
    ds_read_b128 v[20:23], v102 offset:4096
    ds_read_b64_tr_b16 v[32:33], v104 offset:10336
    ds_read_b64_tr_b16 v[34:35], v104 offset:10976
    ds_read_b64_tr_b16 v[36:37], v104 offset:10368
    ds_read_b64_tr_b16 v[38:39], v104 offset:11008
    s_waitcnt lgkmcnt(6)
    v_mfma_f32_16x16x32_bf16 v[64:67], v[44:47], v[24:27], v[64:67]
    v_mfma_f32_16x16x32_bf16 v[76:79], v[44:47], v[28:31], v[76:79]
    v_mfma_f32_16x16x32_bf16 v[68:71], v[48:51], v[24:27], v[68:71]
    v_mfma_f32_16x16x32_bf16 v[80:83], v[48:51], v[28:31], v[80:83]
    ds_read_b128 v[24:27], v103 offset:0
    ds_read_b128 v[28:31], v103 offset:4096
    ds_read_b64_tr_b16 v[44:45], v104 offset:15456
    ds_read_b64_tr_b16 v[46:47], v104 offset:16096
    ds_read_b64_tr_b16 v[48:49], v104 offset:15488
    ds_read_b64_tr_b16 v[50:51], v104 offset:16128
    s_waitcnt lgkmcnt(6)
    v_mfma_f32_16x16x32_bf16 v[64:67], v[32:35], v[16:19], v[64:67]
    v_mfma_f32_16x16x32_bf16 v[76:79], v[32:35], v[20:23], v[76:79]
    v_mfma_f32_16x16x32_bf16 v[68:71], v[36:39], v[16:19], v[68:71]
    v_mfma_f32_16x16x32_bf16 v[80:83], v[36:39], v[20:23], v[80:83]
    s_waitcnt lgkmcnt(0)
    v_add_u32 v100, 36864, v100
    v_add_u32 v101, 36864, v101
    v_add_u32 v102, 36864, v102
    v_add_u32 v103, 36864, v103
    v_add_u32 v104, 36864, v104
    v_mfma_f32_16x16x32_bf16 v[64:67], v[44:47], v[24:27], v[64:67]
    v_mfma_f32_16x16x32_bf16 v[76:79], v[44:47], v[28:31], v[76:79]
    v_mfma_f32_16x16x32_bf16 v[68:71], v[48:51], v[24:27], v[68:71]
    v_mfma_f32_16x16x32_bf16 v[80:83], v[48:51], v[28:31], v[80:83]
    s_barrier
    ds_read_b128 v[16:19], v100 offset:0
    ds_read_b128 v[20:23], v100 offset:4096
    ds_read_b64_tr_b16 v[32:33], v104 offset:96
    ds_read_b64_tr_b16 v[34:35], v104 offset:736
    ds_read_b64_tr_b16 v[36:37], v104 offset:128
    ds_read_b64_tr_b16 v[38:39], v104 offset:768
    ds_read_b128 v[24:27], v101 offset:0
    ds_read_b128 v[28:31], v101 offset:4096
    ds_read_b64_tr_b16 v[44:45], v104 offset:5216
    ds_read_b64_tr_b16 v[46:47], v104 offset:5856
    ds_read_b64_tr_b16 v[48:49], v104 offset:5248
    ds_read_b64_tr_b16 v[50:51], v104 offset:5888
    s_waitcnt lgkmcnt(6)
    v_mfma_f32_16x16x32_bf16 v[64:67], v[32:35], v[16:19], v[64:67]
    v_mfma_f32_16x16x32_bf16 v[76:79], v[32:35], v[20:23], v[76:79]
    v_mfma_f32_16x16x32_bf16 v[68:71], v[36:39], v[16:19], v[68:71]
    v_mfma_f32_16x16x32_bf16 v[80:83], v[36:39], v[20:23], v[80:83]
    ds_read_b128 v[16:19], v102 offset:0
    ds_read_b128 v[20:23], v102 offset:4096
    ds_read_b64_tr_b16 v[32:33], v104 offset:10336
    ds_read_b64_tr_b16 v[34:35], v104 offset:10976
    ds_read_b64_tr_b16 v[36:37], v104 offset:10368
    ds_read_b64_tr_b16 v[38:39], v104 offset:11008
    s_waitcnt lgkmcnt(6)
    v_mfma_f32_16x16x32_bf16 v[64:67], v[44:47], v[24:27], v[64:67]
    v_mfma_f32_16x16x32_bf16 v[76:79], v[44:47], v[28:31], v[76:79]
    v_mfma_f32_16x16x32_bf16 v[68:71], v[48:51], v[24:27], v[68:71]
    v_mfma_f32_16x16x32_bf16 v[80:83], v[48:51], v[28:31], v[80:83]
    ds_read_b128 v[24:27], v103 offset:0
    ds_read_b128 v[28:31], v103 offset:4096
    ds_read_b64_tr_b16 v[44:45], v104 offset:15456
    ds_read_b64_tr_b16 v[46:47], v104 offset:16096
    ds_read_b64_tr_b16 v[48:49], v104 offset:15488
    ds_read_b64_tr_b16 v[50:51], v104 offset:16128
    s_waitcnt lgkmcnt(6)
    v_mfma_f32_16x16x32_bf16 v[64:67], v[32:35], v[16:19], v[64:67]
    v_mfma_f32_16x16x32_bf16 v[76:79], v[32:35], v[20:23], v[76:79]
    v_mfma_f32_16x16x32_bf16 v[68:71], v[36:39], v[16:19], v[68:71]
    v_mfma_f32_16x16x32_bf16 v[80:83], v[36:39], v[20:23], v[80:83]
    s_waitcnt lgkmcnt(0)
    v_add_u32 v100, 36864, v100
    v_add_u32 v101, 36864, v101
    v_add_u32 v102, 36864, v102
    v_add_u32 v103, 36864, v103
    v_add_u32 v104, 36864, v104
    v_mfma_f32_16x16x32_bf16 v[64:67], v[44:47], v[24:27], v[64:67]
    v_mfma_f32_16x16x32_bf16 v[76:79], v[44:47], v[28:31], v[76:79]
    v_mfma_f32_16x16x32_bf16 v[68:71], v[48:51], v[24:27], v[68:71]
    v_mfma_f32_16x16x32_bf16 v[80:83], v[48:51], v[28:31], v[80:83]
    s_barrier
    ds_read_b128 v[16:19], v100 offset:0
    ds_read_b128 v[20:23], v100 offset:4096
    ds_read_b64_tr_b16 v[32:33], v104 offset:96
    ds_read_b64_tr_b16 v[34:35], v104 offset:736
    ds_read_b64_tr_b16 v[36:37], v104 offset:128
    ds_read_b64_tr_b16 v[38:39], v104 offset:768
    ds_read_b128 v[24:27], v101 offset:0
    ds_read_b128 v[28:31], v101 offset:4096
    ds_read_b64_tr_b16 v[44:45], v104 offset:5216
    ds_read_b64_tr_b16 v[46:47], v104 offset:5856
    ds_read_b64_tr_b16 v[48:49], v104 offset:5248
    ds_read_b64_tr_b16 v[50:51], v104 offset:5888
    s_waitcnt lgkmcnt(6)
    v_mfma_f32_16x16x32_bf16 v[64:67], v[32:35], v[16:19], v[64:67]
    v_mfma_f32_16x16x32_bf16 v[76:79], v[32:35], v[20:23], v[76:79]
    v_mfma_f32_16x16x32_bf16 v[68:71], v[36:39], v[16:19], v[68:71]
    v_mfma_f32_16x16x32_bf16 v[80:83], v[36:39], v[20:23], v[80:83]
    ds_read_b128 v[16:19], v102 offset:0
    ds_read_b128 v[20:23], v102 offset:4096
    ds_read_b64_tr_b16 v[32:33], v104 offset:10336
    ds_read_b64_tr_b16 v[34:35], v104 offset:10976
    ds_read_b64_tr_b16 v[36:37], v104 offset:10368
    ds_read_b64_tr_b16 v[38:39], v104 offset:11008
    s_waitcnt lgkmcnt(6)
    v_mfma_f32_16x16x32_bf16 v[64:67], v[44:47], v[24:27], v[64:67]
    v_mfma_f32_16x16x32_bf16 v[76:79], v[44:47], v[28:31], v[76:79]
    v_mfma_f32_16x16x32_bf16 v[68:71], v[48:51], v[24:27], v[68:71]
    v_mfma_f32_16x16x32_bf16 v[80:83], v[48:51], v[28:31], v[80:83]
    ds_read_b128 v[24:27], v103 offset:0
    ds_read_b128 v[28:31], v103 offset:4096
    ds_read_b64_tr_b16 v[44:45], v104 offset:15456
    ds_read_b64_tr_b16 v[46:47], v104 offset:16096
    ds_read_b64_tr_b16 v[48:49], v104 offset:15488
    ds_read_b64_tr_b16 v[50:51], v104 offset:16128
    s_waitcnt lgkmcnt(6)
    v_mfma_f32_16x16x32_bf16 v[64:67], v[32:35], v[16:19], v[64:67]
    v_mfma_f32_16x16x32_bf16 v[76:79], v[32:35], v[20:23], v[76:79]
    v_mfma_f32_16x16x32_bf16 v[68:71], v[36:39], v[16:19], v[68:71]
    v_mfma_f32_16x16x32_bf16 v[80:83], v[36:39], v[20:23], v[80:83]
    s_waitcnt lgkmcnt(0)
    v_add_u32 v100, 4294893568, v100
    v_add_u32 v101, 4294893568, v101
    v_add_u32 v102, 4294893568, v102
    v_add_u32 v103, 4294893568, v103
    v_add_u32 v104, 4294893568, v104
    v_mfma_f32_16x16x32_bf16 v[64:67], v[44:47], v[24:27], v[64:67]
    v_mfma_f32_16x16x32_bf16 v[76:79], v[44:47], v[28:31], v[76:79]
    v_mfma_f32_16x16x32_bf16 v[68:71], v[48:51], v[24:27], v[68:71]
    v_mfma_f32_16x16x32_bf16 v[80:83], v[48:51], v[28:31], v[80:83]
    s_barrier
    ds_read_b128 v[16:19], v100 offset:0
    ds_read_b128 v[20:23], v100 offset:4096
    ds_read_b64_tr_b16 v[32:33], v104 offset:96
    ds_read_b64_tr_b16 v[34:35], v104 offset:736
    ds_read_b64_tr_b16 v[36:37], v104 offset:128
    ds_read_b64_tr_b16 v[38:39], v104 offset:768
    ds_read_b128 v[24:27], v101 offset:0
    ds_read_b128 v[28:31], v101 offset:4096
    ds_read_b64_tr_b16 v[44:45], v104 offset:5216
    ds_read_b64_tr_b16 v[46:47], v104 offset:5856
    ds_read_b64_tr_b16 v[48:49], v104 offset:5248
    ds_read_b64_tr_b16 v[50:51], v104 offset:5888
    s_waitcnt lgkmcnt(6)
    v_mfma_f32_16x16x32_bf16 v[64:67], v[32:35], v[16:19], v[64:67]
    v_mfma_f32_16x16x32_bf16 v[76:79], v[32:35], v[20:23], v[76:79]
    v_mfma_f32_16x16x32_bf16 v[68:71], v[36:39], v[16:19], v[68:71]
    v_mfma_f32_16x16x32_bf16 v[80:83], v[36:39], v[20:23], v[80:83]
    ds_read_b128 v[16:19], v102 offset:0
    ds_read_b128 v[20:23], v102 offset:4096
    ds_read_b64_tr_b16 v[32:33], v104 offset:10336
    ds_read_b64_tr_b16 v[34:35], v104 offset:10976
    ds_read_b64_tr_b16 v[36:37], v104 offset:10368
    ds_read_b64_tr_b16 v[38:39], v104 offset:11008
    s_waitcnt lgkmcnt(6)
    v_mfma_f32_16x16x32_bf16 v[64:67], v[44:47], v[24:27], v[64:67]
    v_mfma_f32_16x16x32_bf16 v[76:79], v[44:47], v[28:31], v[76:79]
    v_mfma_f32_16x16x32_bf16 v[68:71], v[48:51], v[24:27], v[68:71]
    v_mfma_f32_16x16x32_bf16 v[80:83], v[48:51], v[28:31], v[80:83]
    ds_read_b128 v[24:27], v103 offset:0
    ds_read_b128 v[28:31], v103 offset:4096
    ds_read_b64_tr_b16 v[44:45], v104 offset:15456
    ds_read_b64_tr_b16 v[46:47], v104 offset:16096
    ds_read_b64_tr_b16 v[48:49], v104 offset:15488
    ds_read_b64_tr_b16 v[50:51], v104 offset:16128
    s_waitcnt lgkmcnt(6)
    v_mfma_f32_16x16x32_bf16 v[64:67], v[32:35], v[16:19], v[64:67]
    v_mfma_f32_16x16x32_bf16 v[76:79], v[32:35], v[20:23], v[76:79]
    v_mfma_f32_16x16x32_bf16 v[68:71], v[36:39], v[16:19], v[68:71]
    v_mfma_f32_16x16x32_bf16 v[80:83], v[36:39], v[20:23], v[80:83]
    s_waitcnt lgkmcnt(0)
    v_add_u32 v100, 36864, v100
    v_add_u32 v101, 36864, v101
    v_add_u32 v102, 36864, v102
    v_add_u32 v103, 36864, v103
    v_add_u32 v104, 36864, v104
    v_mfma_f32_16x16x32_bf16 v[64:67], v[44:47], v[24:27], v[64:67]
    v_mfma_f32_16x16x32_bf16 v[76:79], v[44:47], v[28:31], v[76:79]
    v_mfma_f32_16x16x32_bf16 v[68:71], v[48:51], v[24:27], v[68:71]
    v_mfma_f32_16x16x32_bf16 v[80:83], v[48:51], v[28:31], v[80:83]
    s_barrier
    ds_read_b128 v[16:19], v100 offset:0
    ds_read_b128 v[20:23], v100 offset:4096
    ds_read_b64_tr_b16 v[32:33], v104 offset:96
    ds_read_b64_tr_b16 v[34:35], v104 offset:736
    ds_read_b64_tr_b16 v[36:37], v104 offset:128
    ds_read_b64_tr_b16 v[38:39], v104 offset:768
    ds_read_b128 v[24:27], v101 offset:0
    ds_read_b128 v[28:31], v101 offset:4096
    ds_read_b64_tr_b16 v[44:45], v104 offset:5216
    ds_read_b64_tr_b16 v[46:47], v104 offset:5856
    ds_read_b64_tr_b16 v[48:49], v104 offset:5248
    ds_read_b64_tr_b16 v[50:51], v104 offset:5888
    s_waitcnt lgkmcnt(6)
    v_mfma_f32_16x16x32_bf16 v[64:67], v[32:35], v[16:19], v[64:67]
    v_mfma_f32_16x16x32_bf16 v[76:79], v[32:35], v[20:23], v[76:79]
    v_mfma_f32_16x16x32_bf16 v[68:71], v[36:39], v[16:19], v[68:71]
    v_mfma_f32_16x16x32_bf16 v[80:83], v[36:39], v[20:23], v[80:83]
    ds_read_b128 v[16:19], v102 offset:0
    ds_read_b128 v[20:23], v102 offset:4096
    ds_read_b64_tr_b16 v[32:33], v104 offset:10336
    ds_read_b64_tr_b16 v[34:35], v104 offset:10976
    ds_read_b64_tr_b16 v[36:37], v104 offset:10368
    ds_read_b64_tr_b16 v[38:39], v104 offset:11008
    s_waitcnt lgkmcnt(6)
    v_mfma_f32_16x16x32_bf16 v[64:67], v[44:47], v[24:27], v[64:67]
    v_mfma_f32_16x16x32_bf16 v[76:79], v[44:47], v[28:31], v[76:79]
    v_mfma_f32_16x16x32_bf16 v[68:71], v[48:51], v[24:27], v[68:71]
    v_mfma_f32_16x16x32_bf16 v[80:83], v[48:51], v[28:31], v[80:83]
    ds_read_b128 v[24:27], v103 offset:0
    ds_read_b128 v[28:31], v103 offset:4096
    ds_read_b64_tr_b16 v[44:45], v104 offset:15456
    ds_read_b64_tr_b16 v[46:47], v104 offset:16096
    ds_read_b64_tr_b16 v[48:49], v104 offset:15488
    ds_read_b64_tr_b16 v[50:51], v104 offset:16128
    s_waitcnt lgkmcnt(6)
    v_mfma_f32_16x16x32_bf16 v[64:67], v[32:35], v[16:19], v[64:67]
    v_mfma_f32_16x16x32_bf16 v[76:79], v[32:35], v[20:23], v[76:79]
    v_mfma_f32_16x16x32_bf16 v[68:71], v[36:39], v[16:19], v[68:71]
    v_mfma_f32_16x16x32_bf16 v[80:83], v[36:39], v[20:23], v[80:83]
    s_waitcnt lgkmcnt(0)
    v_mfma_f32_16x16x32_bf16 v[64:67], v[44:47], v[24:27], v[64:67]
    v_mfma_f32_16x16x32_bf16 v[76:79], v[44:47], v[28:31], v[76:79]
    v_mfma_f32_16x16x32_bf16 v[68:71], v[48:51], v[24:27], v[68:71]
    v_mfma_f32_16x16x32_bf16 v[80:83], v[48:51], v[28:31], v[80:83]
    s_waitcnt vmcnt(0)
    s_nop 7
    v_mov_b32 v15, 0x3f803f80
    v_mov_b32 v118, 0
    v_mov_b32 v119, 0
    v_mov_b32 v120, 0
    v_mov_b32 v121, 0
    v_cvt_pk_bf16_f32 v64, v64, v65
    v_cvt_pk_bf16_f32 v65, v66, v67
    v_lshlrev_b32 v12, 16, v64
    v_and_b32 v13, 0xffff0000, v64
    v_lshlrev_b32 v6, 16, v88
    v_and_b32 v7, 0xffff0000, v88
    v_add_f32 v12, v12, v6
    v_add_f32 v13, v13, v7
    v_cvt_pk_bf16_f32 v64, v12, v13
    v_dot2_f32_bf16 v118, v64, v15, v118
    v_dot2_f32_bf16 v119, v64, v64, v119
    v_dot2_f32_bf16 v120, v64, v112, v120
    v_lshlrev_b32 v12, 16, v65
    v_and_b32 v13, 0xffff0000, v65
    v_lshlrev_b32 v6, 16, v89
    v_and_b32 v7, 0xffff0000, v89
    v_add_f32 v12, v12, v6
    v_add_f32 v13, v13, v7
    v_cvt_pk_bf16_f32 v65, v12, v13
    v_dot2_f32_bf16 v118, v65, v15, v118
    v_dot2_f32_bf16 v119, v65, v65, v119
    v_dot2_f32_bf16 v120, v65, v113, v120
    buffer_store_dwordx2 v[64:65], v10, s[36:39], s59 offen offset:96
    v_cvt_pk_bf16_f32 v68, v68, v69
    v_cvt_pk_bf16_f32 v69, v70, v71
    v_lshlrev_b32 v12, 16, v68
    v_and_b32 v13, 0xffff0000, v68
    v_lshlrev_b32 v6, 16, v90
    v_and_b32 v7, 0xffff0000, v90
    v_add_f32 v12, v12, v6
    v_add_f32 v13, v13, v7
    v_cvt_pk_bf16_f32 v68, v12, v13
    v_dot2_f32_bf16 v118, v68, v15, v118
    v_dot2_f32_bf16 v119, v68, v68, v119
    v_dot2_f32_bf16 v120, v68, v114, v120
    v_lshlrev_b32 v12, 16, v69
    v_and_b32 v13, 0xffff0000, v69
    v_lshlrev_b32 v6, 16, v91
    v_and_b32 v7, 0xffff0000, v91
    v_add_f32 v12, v12, v6
    v_add_f32 v13, v13, v7
    v_cvt_pk_bf16_f32 v69, v12, v13
    v_dot2_f32_bf16 v118, v69, v15, v118
    v_dot2_f32_bf16 v119, v69, v69, v119
    v_dot2_f32_bf16 v120, v69, v115, v120
    buffer_store_dwordx2 v[68:69], v10, s[36:39], s59 offen offset:128
    v_mov_b32 v122, 0
    v_mov_b32 v123, 0
    v_mov_b32 v124, 0
    v_mov_b32 v125, 0
    v_cvt_pk_bf16_f32 v76, v76, v77
    v_cvt_pk_bf16_f32 v77, v78, v79
    v_lshlrev_b32 v12, 16, v76
    v_and_b32 v13, 0xffff0000, v76
    v_lshlrev_b32 v6, 16, v94
    v_and_b32 v7, 0xffff0000, v94
    v_add_f32 v12, v12, v6
    v_add_f32 v13, v13, v7
    v_cvt_pk_bf16_f32 v76, v12, v13
    v_dot2_f32_bf16 v122, v76, v15, v122
    v_dot2_f32_bf16 v123, v76, v76, v123
    v_dot2_f32_bf16 v124, v76, v112, v124
    v_lshlrev_b32 v12, 16, v77
    v_and_b32 v13, 0xffff0000, v77
    v_lshlrev_b32 v6, 16, v95
    v_and_b32 v7, 0xffff0000, v95
    v_add_f32 v12, v12, v6
    v_add_f32 v13, v13, v7
    v_cvt_pk_bf16_f32 v77, v12, v13
    v_dot2_f32_bf16 v122, v77, v15, v122
    v_dot2_f32_bf16 v123, v77, v77, v123
    v_dot2_f32_bf16 v124, v77, v113, v124
    buffer_store_dwordx2 v[76:77], v10, s[36:39], s58 offen offset:96
    v_cvt_pk_bf16_f32 v80, v80, v81
    v_cvt_pk_bf16_f32 v81, v82, v83
    v_lshlrev_b32 v12, 16, v80
    v_and_b32 v13, 0xffff0000, v80
    v_lshlrev_b32 v6, 16, v96
    v_and_b32 v7, 0xffff0000, v96
    v_add_f32 v12, v12, v6
    v_add_f32 v13, v13, v7
    v_cvt_pk_bf16_f32 v80, v12, v13
    v_dot2_f32_bf16 v122, v80, v15, v122
    v_dot2_f32_bf16 v123, v80, v80, v123
    v_dot2_f32_bf16 v124, v80, v114, v124
    v_lshlrev_b32 v12, 16, v81
    v_and_b32 v13, 0xffff0000, v81
    v_lshlrev_b32 v6, 16, v97
    v_and_b32 v7, 0xffff0000, v97
    v_add_f32 v12, v12, v6
    v_add_f32 v13, v13, v7
    v_cvt_pk_bf16_f32 v81, v12, v13
    v_dot2_f32_bf16 v122, v81, v15, v122
    v_dot2_f32_bf16 v123, v81, v81, v123
    v_dot2_f32_bf16 v124, v81, v115, v124
    buffer_store_dwordx2 v[80:81], v10, s[36:39], s58 offen offset:128
    s_nop 3
    ds_swizzle_b32 v16, v118 offset:0x401F
    ds_swizzle_b32 v17, v119 offset:0x401F
    ds_swizzle_b32 v18, v120 offset:0x401F
    ds_swizzle_b32 v19, v122 offset:0x401F
    ds_swizzle_b32 v20, v123 offset:0x401F
    ds_swizzle_b32 v21, v124 offset:0x401F
    s_waitcnt lgkmcnt(0)
    v_add_f32 v118, v118, v16
    v_mov_b32 v16, v118
    v_add_f32 v119, v119, v17
    v_mov_b32 v17, v119
    v_add_f32 v120, v120, v18
    v_mov_b32 v18, v120
    v_add_f32 v122, v122, v19
    v_mov_b32 v19, v122
    v_add_f32 v123, v123, v20
    v_mov_b32 v20, v123
    v_add_f32 v124, v124, v21
    v_mov_b32 v21, v124
    s_nop 1
    v_permlane32_swap_b32 v16, v118
    v_permlane32_swap_b32 v17, v119
    v_permlane32_swap_b32 v18, v120
    v_permlane32_swap_b32 v19, v122
    v_permlane32_swap_b32 v20, v123
    v_permlane32_swap_b32 v21, v124
    s_nop 1
    v_add_f32 v118, v118, v16
    v_add_f32 v119, v119, v17
    v_add_f32 v120, v120, v18
    v_add_f32 v122, v122, v19
    v_add_f32 v123, v123, v20
    v_add_f32 v124, v124, v21
    v_lshlrev_b32 v14, 4, v5
    v_lshl_add_u32 v14, v4, 2, v14
    v_cmp_eq_u32 vcc, 1, v4
    v_cmp_eq_u32 s[46:47], 2, v4
    v_cmp_eq_u32 s[48:49], 3, v4
    s_nop 1
    v_cndmask_b32 v118, v118, v119, vcc
    v_cndmask_b32 v118, v118, v120, s[46:47]
    v_cndmask_b32 v118, v118, v121, s[48:49]
    buffer_atomic_add_f32 v118, v14, s[40:43], 0 offen offset:0
    v_cndmask_b32 v122, v122, v123, vcc
    v_cndmask_b32 v122, v122, v124, s[46:47]
    v_cndmask_b32 v122, v122, v125, s[48:49]
    buffer_atomic_add_f32 v122, v14, s[40:43], 0 offen offset:256
    s_branch oproj_kernel_end
oproj_kernel_idle:
    s_cmp_eq_u32 s18, 4
    s_cbranch_scc1 oproj_kernel_exit
    s_cmp_eq_u32 s18, 5
    s_cbranch_scc0 oproj_kernel_ld1
    s_lshl_b32 s45, s17, 6
    v_add_u32 v6, 0, v4
    v_and_b32 v7, 15, v6
    v_xor_b32 v7, v7, v3
    v_add_u32 v6, s45, v6
    v_mul_u32_u24 v6, 1280, v6
    v_lshl_add_u32 v16, v7, 4, v6
    v_add_u32 v6, 4, v4
    v_and_b32 v7, 15, v6
    v_xor_b32 v7, v7, v3
    v_add_u32 v6, s45, v6
    v_mul_u32_u24 v6, 1280, v6
    v_lshl_add_u32 v17, v7, 4, v6
    v_add_u32 v6, 8, v4
    v_and_b32 v7, 15, v6
    v_xor_b32 v7, v7, v3
    v_add_u32 v6, s45, v6
    v_mul_u32_u24 v6, 1280, v6
    v_lshl_add_u32 v18, v7, 4, v6
    v_add_u32 v6, 12, v4
    v_and_b32 v7, 15, v6
    v_xor_b32 v7, v7, v3
    v_add_u32 v6, s45, v6
    v_mul_u32_u24 v6, 1280, v6
    v_lshl_add_u32 v19, v7, 4, v6
    v_add_u32 v6, 16, v4
    v_and_b32 v7, 15, v6
    v_xor_b32 v7, v7, v3
    v_add_u32 v6, s45, v6
    v_mul_u32_u24 v6, 1280, v6
    v_lshl_add_u32 v20, v7, 4, v6
    v_add_u32 v6, 20, v4
    v_and_b32 v7, 15, v6
    v_xor_b32 v7, v7, v3
    v_add_u32 v6, s45, v6
    v_mul_u32_u24 v6, 1280, v6
    v_lshl_add_u32 v21, v7, 4, v6
    v_add_u32 v6, 24, v4
    v_and_b32 v7, 15, v6
    v_xor_b32 v7, v7, v3
    v_add_u32 v6, s45, v6
    v_mul_u32_u24 v6, 1280, v6
    v_lshl_add_u32 v22, v7, 4, v6
    v_add_u32 v6, 28, v4
    v_and_b32 v7, 15, v6
    v_xor_b32 v7, v7, v3
    v_add_u32 v6, s45, v6
    v_mul_u32_u24 v6, 1280, v6
    v_lshl_add_u32 v23, v7, 4, v6
    v_add_u32 v6, 32, v4
    v_and_b32 v7, 15, v6
    v_xor_b32 v7, v7, v3
    v_add_u32 v6, s45, v6
    v_mul_u32_u24 v6, 1280, v6
    v_lshl_add_u32 v24, v7, 4, v6
    v_add_u32 v6, 36, v4
    v_and_b32 v7, 15, v6
    v_xor_b32 v7, v7, v3
    v_add_u32 v6, s45, v6
    v_mul_u32_u24 v6, 1280, v6
    v_lshl_add_u32 v25, v7, 4, v6
    v_add_u32 v6, 40, v4
    v_and_b32 v7, 15, v6
    v_xor_b32 v7, v7, v3
    v_add_u32 v6, s45, v6
    v_mul_u32_u24 v6, 1280, v6
    v_lshl_add_u32 v26, v7, 4, v6
    v_add_u32 v6, 44, v4
    v_and_b32 v7, 15, v6
    v_xor_b32 v7, v7, v3
    v_add_u32 v6, s45, v6
    v_mul_u32_u24 v6, 1280, v6
    v_lshl_add_u32 v27, v7, 4, v6
    s_mov_b32 s46, 0
    s_mov_b32 s47, 0
    s_mov_b32 m0, 0
    s_nop 0
    buffer_load_dwordx4 v16, s[20:23], s46 offen lds
    s_mov_b32 m0, 1024
    s_nop 0
    buffer_load_dwordx4 v17, s[20:23], s46 offen lds
    s_mov_b32 m0, 2048
    s_nop 0
    buffer_load_dwordx4 v18, s[20:23], s46 offen lds
    s_mov_b32 m0, 3072
    s_nop 0
    buffer_load_dwordx4 v19, s[20:23], s46 offen lds
    s_mov_b32 m0, 4096
    s_nop 0
    buffer_load_dwordx4 v20, s[20:23], s46 offen lds
    s_mov_b32 m0, 5120
    s_nop 0
    buffer_load_dwordx4 v21, s[20:23], s46 offen lds
    s_mov_b32 m0, 6144
    s_nop 0
    buffer_load_dwordx4 v22, s[20:23], s46 offen lds
    s_mov_b32 m0, 7168
    s_nop 0
    buffer_load_dwordx4 v23, s[20:23], s46 offen lds
    s_mov_b32 m0, 8192
    s_nop 0
    buffer_load_dwordx4 v24, s[20:23], s46 offen lds
    s_mov_b32 m0, 9216
    s_nop 0
    buffer_load_dwordx4 v25, s[20:23], s46 offen lds
    s_mov_b32 m0, 10240
    s_nop 0
    buffer_load_dwordx4 v26, s[20:23], s46 offen lds
    s_mov_b32 m0, 11264
    s_nop 0
    buffer_load_dwordx4 v27, s[20:23], s46 offen lds
    s_mov_b32 s46, 256
    s_mov_b32 s47, 20480
    s_mov_b32 m0, 36864
    s_nop 0
    buffer_load_dwordx4 v16, s[20:23], s46 offen lds
    s_mov_b32 m0, 37888
    s_nop 0
    buffer_load_dwordx4 v17, s[20:23], s46 offen lds
    s_mov_b32 m0, 38912
    s_nop 0
    buffer_load_dwordx4 v18, s[20:23], s46 offen lds
    s_mov_b32 m0, 39936
    s_nop 0
    buffer_load_dwordx4 v19, s[20:23], s46 offen lds
    s_mov_b32 m0, 40960
    s_nop 0
    buffer_load_dwordx4 v20, s[20:23], s46 offen lds
    s_mov_b32 m0, 41984
    s_nop 0
    buffer_load_dwordx4 v21, s[20:23], s46 offen lds
    s_mov_b32 m0, 43008
    s_nop 0
    buffer_load_dwordx4 v22, s[20:23], s46 offen lds
    s_mov_b32 m0, 44032
    s_nop 0
    buffer_load_dwordx4 v23, s[20:23], s46 offen lds
    s_mov_b32 m0, 45056
    s_nop 0
    buffer_load_dwordx4 v24, s[20:23], s46 offen lds
    s_mov_b32 m0, 46080
    s_nop 0
    buffer_load_dwordx4 v25, s[20:23], s46 offen lds
    s_mov_b32 m0, 47104
    s_nop 0
    buffer_load_dwordx4 v26, s[20:23], s46 offen lds
    s_mov_b32 m0, 48128
    s_nop 0
    buffer_load_dwordx4 v27, s[20:23], s46 offen lds
    s_waitcnt vmcnt(12)
    s_barrier
    s_mov_b32 s46, 512
    s_mov_b32 s47, 40960
    s_mov_b32 m0, 73728
    s_nop 0
    buffer_load_dwordx4 v16, s[20:23], s46 offen lds
    s_mov_b32 m0, 74752
    s_nop 0
    buffer_load_dwordx4 v17, s[20:23], s46 offen lds
    s_mov_b32 m0, 75776
    s_nop 0
    buffer_load_dwordx4 v18, s[20:23], s46 offen lds
    s_mov_b32 m0, 76800
    s_nop 0
    buffer_load_dwordx4 v19, s[20:23], s46 offen lds
    s_mov_b32 m0, 77824
    s_nop 0
    buffer_load_dwordx4 v20, s[20:23], s46 offen lds
    s_mov_b32 m0, 78848
    s_nop 0
    buffer_load_dwordx4 v21, s[20:23], s46 offen lds
    s_mov_b32 m0, 79872
    s_nop 0
    buffer_load_dwordx4 v22, s[20:23], s46 offen lds
    s_mov_b32 m0, 80896
    s_nop 0
    buffer_load_dwordx4 v23, s[20:23], s46 offen lds
    s_mov_b32 m0, 81920
    s_nop 0
    buffer_load_dwordx4 v24, s[20:23], s46 offen lds
    s_mov_b32 m0, 82944
    s_nop 0
    buffer_load_dwordx4 v25, s[20:23], s46 offen lds
    s_mov_b32 m0, 83968
    s_nop 0
    buffer_load_dwordx4 v26, s[20:23], s46 offen lds
    s_mov_b32 m0, 84992
    s_nop 0
    buffer_load_dwordx4 v27, s[20:23], s46 offen lds
    s_waitcnt vmcnt(12)
    s_barrier
    s_mov_b32 s46, 768
    s_mov_b32 s47, 61440
    s_mov_b32 m0, 0
    s_nop 0
    buffer_load_dwordx4 v16, s[20:23], s46 offen lds
    s_mov_b32 m0, 1024
    s_nop 0
    buffer_load_dwordx4 v17, s[20:23], s46 offen lds
    s_mov_b32 m0, 2048
    s_nop 0
    buffer_load_dwordx4 v18, s[20:23], s46 offen lds
    s_mov_b32 m0, 3072
    s_nop 0
    buffer_load_dwordx4 v19, s[20:23], s46 offen lds
    s_mov_b32 m0, 4096
    s_nop 0
    buffer_load_dwordx4 v20, s[20:23], s46 offen lds
    s_mov_b32 m0, 5120
    s_nop 0
    buffer_load_dwordx4 v21, s[20:23], s46 offen lds
    s_mov_b32 m0, 6144
    s_nop 0
    buffer_load_dwordx4 v22, s[20:23], s46 offen lds
    s_mov_b32 m0, 7168
    s_nop 0
    buffer_load_dwordx4 v23, s[20:23], s46 offen lds
    s_mov_b32 m0, 8192
    s_nop 0
    buffer_load_dwordx4 v24, s[20:23], s46 offen lds
    s_mov_b32 m0, 9216
    s_nop 0
    buffer_load_dwordx4 v25, s[20:23], s46 offen lds
    s_mov_b32 m0, 10240
    s_nop 0
    buffer_load_dwordx4 v26, s[20:23], s46 offen lds
    s_mov_b32 m0, 11264
    s_nop 0
    buffer_load_dwordx4 v27, s[20:23], s46 offen lds
    s_waitcnt vmcnt(12)
    s_barrier
    s_mov_b32 s46, 1024
    s_mov_b32 s47, 81920
    s_mov_b32 m0, 36864
    s_nop 0
    buffer_load_dwordx4 v16, s[20:23], s46 offen lds
    s_mov_b32 m0, 37888
    s_nop 0
    buffer_load_dwordx4 v17, s[20:23], s46 offen lds
    s_mov_b32 m0, 38912
    s_nop 0
    buffer_load_dwordx4 v18, s[20:23], s46 offen lds
    s_mov_b32 m0, 39936
    s_nop 0
    buffer_load_dwordx4 v19, s[20:23], s46 offen lds
    s_mov_b32 m0, 40960
    s_nop 0
    buffer_load_dwordx4 v20, s[20:23], s46 offen lds
    s_mov_b32 m0, 41984
    s_nop 0
    buffer_load_dwordx4 v21, s[20:23], s46 offen lds
    s_mov_b32 m0, 43008
    s_nop 0
    buffer_load_dwordx4 v22, s[20:23], s46 offen lds
    s_mov_b32 m0, 44032
    s_nop 0
    buffer_load_dwordx4 v23, s[20:23], s46 offen lds
    s_mov_b32 m0, 45056
    s_nop 0
    buffer_load_dwordx4 v24, s[20:23], s46 offen lds
    s_mov_b32 m0, 46080
    s_nop 0
    buffer_load_dwordx4 v25, s[20:23], s46 offen lds
    s_mov_b32 m0, 47104
    s_nop 0
    buffer_load_dwordx4 v26, s[20:23], s46 offen lds
    s_mov_b32 m0, 48128
    s_nop 0
    buffer_load_dwordx4 v27, s[20:23], s46 offen lds
    s_waitcnt vmcnt(12)
    s_barrier
    s_waitcnt vmcnt(0)
    s_barrier
    s_waitcnt vmcnt(0)
    s_branch oproj_kernel_end
oproj_kernel_ld1:
    s_cmp_eq_u32 s18, 6
    s_cbranch_scc0 oproj_kernel_ld2
    s_lshl_b32 s45, s17, 6
    v_add_u32 v6, 48, v4
    v_and_b32 v7, 15, v6
    v_xor_b32 v7, v7, v3
    v_add_u32 v6, s45, v6
    v_mul_u32_u24 v6, 1280, v6
    v_lshl_add_u32 v16, v7, 4, v6
    v_add_u32 v6, 52, v4
    v_and_b32 v7, 15, v6
    v_xor_b32 v7, v7, v3
    v_add_u32 v6, s45, v6
    v_mul_u32_u24 v6, 1280, v6
    v_lshl_add_u32 v17, v7, 4, v6
    v_add_u32 v6, 56, v4
    v_and_b32 v7, 15, v6
    v_xor_b32 v7, v7, v3
    v_add_u32 v6, s45, v6
    v_mul_u32_u24 v6, 1280, v6
    v_lshl_add_u32 v18, v7, 4, v6
    v_add_u32 v6, 60, v4
    v_and_b32 v7, 15, v6
    v_xor_b32 v7, v7, v3
    v_add_u32 v6, s45, v6
    v_mul_u32_u24 v6, 1280, v6
    v_lshl_add_u32 v19, v7, 4, v6
    v_add_u32 v6, 0, v1
    v_lshlrev_b32 v20, 4, v6
    v_add_u32 v6, 64, v1
    v_lshlrev_b32 v21, 4, v6
    v_add_u32 v6, 128, v1
    v_lshlrev_b32 v22, 4, v6
    v_add_u32 v6, 192, v1
    v_lshlrev_b32 v23, 4, v6
    v_add_u32 v6, 256, v1
    v_lshlrev_b32 v24, 4, v6
    v_add_u32 v6, 320, v1
    v_lshlrev_b32 v25, 4, v6
    v_add_u32 v6, 384, v1
    v_lshlrev_b32 v26, 4, v6
    v_add_u32 v6, 448, v1
    v_lshlrev_b32 v27, 4, v6
    s_mov_b32 s46, 0
    s_mov_b32 s47, 0
    s_mov_b32 m0, 12288
    s_nop 0
    buffer_load_dwordx4 v16, s[20:23], s46 offen lds
    s_mov_b32 m0, 13312
    s_nop 0
    buffer_load_dwordx4 v17, s[20:23], s46 offen lds
    s_mov_b32 m0, 14336
    s_nop 0
    buffer_load_dwordx4 v18, s[20:23], s46 offen lds
    s_mov_b32 m0, 15360
    s_nop 0
    buffer_load_dwordx4 v19, s[20:23], s46 offen lds
    s_mov_b32 m0, 16384
    s_nop 0
    buffer_load_dwordx4 v20, s[24:27], s47 offen lds
    s_mov_b32 m0, 17408
    s_nop 0
    buffer_load_dwordx4 v21, s[24:27], s47 offen lds
    s_mov_b32 m0, 18432
    s_nop 0
    buffer_load_dwordx4 v22, s[24:27], s47 offen lds
    s_mov_b32 m0, 19456
    s_nop 0
    buffer_load_dwordx4 v23, s[24:27], s47 offen lds
    s_mov_b32 m0, 20480
    s_nop 0
    buffer_load_dwordx4 v24, s[24:27], s47 offen lds
    s_mov_b32 m0, 21504
    s_nop 0
    buffer_load_dwordx4 v25, s[24:27], s47 offen lds
    s_mov_b32 m0, 22528
    s_nop 0
    buffer_load_dwordx4 v26, s[24:27], s47 offen lds
    s_mov_b32 m0, 23552
    s_nop 0
    buffer_load_dwordx4 v27, s[24:27], s47 offen lds
    s_mov_b32 s46, 256
    s_mov_b32 s47, 20480
    s_mov_b32 m0, 49152
    s_nop 0
    buffer_load_dwordx4 v16, s[20:23], s46 offen lds
    s_mov_b32 m0, 50176
    s_nop 0
    buffer_load_dwordx4 v17, s[20:23], s46 offen lds
    s_mov_b32 m0, 51200
    s_nop 0
    buffer_load_dwordx4 v18, s[20:23], s46 offen lds
    s_mov_b32 m0, 52224
    s_nop 0
    buffer_load_dwordx4 v19, s[20:23], s46 offen lds
    s_mov_b32 m0, 53248
    s_nop 0
    buffer_load_dwordx4 v20, s[24:27], s47 offen lds
    s_mov_b32 m0, 54272
    s_nop 0
    buffer_load_dwordx4 v21, s[24:27], s47 offen lds
    s_mov_b32 m0, 55296
    s_nop 0
    buffer_load_dwordx4 v22, s[24:27], s47 offen lds
    s_mov_b32 m0, 56320
    s_nop 0
    buffer_load_dwordx4 v23, s[24:27], s47 offen lds
    s_mov_b32 m0, 57344
    s_nop 0
    buffer_load_dwordx4 v24, s[24:27], s47 offen lds
    s_mov_b32 m0, 58368
    s_nop 0
    buffer_load_dwordx4 v25, s[24:27], s47 offen lds
    s_mov_b32 m0, 59392
    s_nop 0
    buffer_load_dwordx4 v26, s[24:27], s47 offen lds
    s_mov_b32 m0, 60416
    s_nop 0
    buffer_load_dwordx4 v27, s[24:27], s47 offen lds
    s_waitcnt vmcnt(12)
    s_barrier
    s_mov_b32 s46, 512
    s_mov_b32 s47, 40960
    s_mov_b32 m0, 86016
    s_nop 0
    buffer_load_dwordx4 v16, s[20:23], s46 offen lds
    s_mov_b32 m0, 87040
    s_nop 0
    buffer_load_dwordx4 v17, s[20:23], s46 offen lds
    s_mov_b32 m0, 88064
    s_nop 0
    buffer_load_dwordx4 v18, s[20:23], s46 offen lds
    s_mov_b32 m0, 89088
    s_nop 0
    buffer_load_dwordx4 v19, s[20:23], s46 offen lds
    s_mov_b32 m0, 90112
    s_nop 0
    buffer_load_dwordx4 v20, s[24:27], s47 offen lds
    s_mov_b32 m0, 91136
    s_nop 0
    buffer_load_dwordx4 v21, s[24:27], s47 offen lds
    s_mov_b32 m0, 92160
    s_nop 0
    buffer_load_dwordx4 v22, s[24:27], s47 offen lds
    s_mov_b32 m0, 93184
    s_nop 0
    buffer_load_dwordx4 v23, s[24:27], s47 offen lds
    s_mov_b32 m0, 94208
    s_nop 0
    buffer_load_dwordx4 v24, s[24:27], s47 offen lds
    s_mov_b32 m0, 95232
    s_nop 0
    buffer_load_dwordx4 v25, s[24:27], s47 offen lds
    s_mov_b32 m0, 96256
    s_nop 0
    buffer_load_dwordx4 v26, s[24:27], s47 offen lds
    s_mov_b32 m0, 97280
    s_nop 0
    buffer_load_dwordx4 v27, s[24:27], s47 offen lds
    s_waitcnt vmcnt(12)
    s_barrier
    s_mov_b32 s46, 768
    s_mov_b32 s47, 61440
    s_mov_b32 m0, 12288
    s_nop 0
    buffer_load_dwordx4 v16, s[20:23], s46 offen lds
    s_mov_b32 m0, 13312
    s_nop 0
    buffer_load_dwordx4 v17, s[20:23], s46 offen lds
    s_mov_b32 m0, 14336
    s_nop 0
    buffer_load_dwordx4 v18, s[20:23], s46 offen lds
    s_mov_b32 m0, 15360
    s_nop 0
    buffer_load_dwordx4 v19, s[20:23], s46 offen lds
    s_mov_b32 m0, 16384
    s_nop 0
    buffer_load_dwordx4 v20, s[24:27], s47 offen lds
    s_mov_b32 m0, 17408
    s_nop 0
    buffer_load_dwordx4 v21, s[24:27], s47 offen lds
    s_mov_b32 m0, 18432
    s_nop 0
    buffer_load_dwordx4 v22, s[24:27], s47 offen lds
    s_mov_b32 m0, 19456
    s_nop 0
    buffer_load_dwordx4 v23, s[24:27], s47 offen lds
    s_mov_b32 m0, 20480
    s_nop 0
    buffer_load_dwordx4 v24, s[24:27], s47 offen lds
    s_mov_b32 m0, 21504
    s_nop 0
    buffer_load_dwordx4 v25, s[24:27], s47 offen lds
    s_mov_b32 m0, 22528
    s_nop 0
    buffer_load_dwordx4 v26, s[24:27], s47 offen lds
    s_mov_b32 m0, 23552
    s_nop 0
    buffer_load_dwordx4 v27, s[24:27], s47 offen lds
    s_waitcnt vmcnt(12)
    s_barrier
    s_mov_b32 s46, 1024
    s_mov_b32 s47, 81920
    s_mov_b32 m0, 49152
    s_nop 0
    buffer_load_dwordx4 v16, s[20:23], s46 offen lds
    s_mov_b32 m0, 50176
    s_nop 0
    buffer_load_dwordx4 v17, s[20:23], s46 offen lds
    s_mov_b32 m0, 51200
    s_nop 0
    buffer_load_dwordx4 v18, s[20:23], s46 offen lds
    s_mov_b32 m0, 52224
    s_nop 0
    buffer_load_dwordx4 v19, s[20:23], s46 offen lds
    s_mov_b32 m0, 53248
    s_nop 0
    buffer_load_dwordx4 v20, s[24:27], s47 offen lds
    s_mov_b32 m0, 54272
    s_nop 0
    buffer_load_dwordx4 v21, s[24:27], s47 offen lds
    s_mov_b32 m0, 55296
    s_nop 0
    buffer_load_dwordx4 v22, s[24:27], s47 offen lds
    s_mov_b32 m0, 56320
    s_nop 0
    buffer_load_dwordx4 v23, s[24:27], s47 offen lds
    s_mov_b32 m0, 57344
    s_nop 0
    buffer_load_dwordx4 v24, s[24:27], s47 offen lds
    s_mov_b32 m0, 58368
    s_nop 0
    buffer_load_dwordx4 v25, s[24:27], s47 offen lds
    s_mov_b32 m0, 59392
    s_nop 0
    buffer_load_dwordx4 v26, s[24:27], s47 offen lds
    s_mov_b32 m0, 60416
    s_nop 0
    buffer_load_dwordx4 v27, s[24:27], s47 offen lds
    s_waitcnt vmcnt(12)
    s_barrier
    s_waitcnt vmcnt(0)
    s_barrier
    s_waitcnt vmcnt(0)
    s_branch oproj_kernel_end
oproj_kernel_ld2:
    s_lshl_b32 s45, s17, 6
    v_add_u32 v6, 512, v1
    v_lshlrev_b32 v16, 4, v6
    v_add_u32 v6, 576, v1
    v_lshlrev_b32 v17, 4, v6
    v_add_u32 v6, 640, v1
    v_lshlrev_b32 v18, 4, v6
    v_add_u32 v6, 704, v1
    v_lshlrev_b32 v19, 4, v6
    v_add_u32 v6, 768, v1
    v_lshlrev_b32 v20, 4, v6
    v_add_u32 v6, 832, v1
    v_lshlrev_b32 v21, 4, v6
    v_add_u32 v6, 896, v1
    v_lshlrev_b32 v22, 4, v6
    v_add_u32 v6, 960, v1
    v_lshlrev_b32 v23, 4, v6
    v_add_u32 v6, 1024, v1
    v_lshlrev_b32 v24, 4, v6
    v_add_u32 v6, 1088, v1
    v_lshlrev_b32 v25, 4, v6
    v_add_u32 v6, 1152, v1
    v_lshlrev_b32 v26, 4, v6
    v_add_u32 v6, 1216, v1
    v_lshlrev_b32 v27, 4, v6
    s_mov_b32 s46, 0
    s_mov_b32 s47, 0
    s_mov_b32 m0, 24576
    s_nop 0
    buffer_load_dwordx4 v16, s[24:27], s47 offen lds
    s_mov_b32 m0, 25600
    s_nop 0
    buffer_load_dwordx4 v17, s[24:27], s47 offen lds
    s_mov_b32 m0, 26624
    s_nop 0
    buffer_load_dwordx4 v18, s[24:27], s47 offen lds
    s_mov_b32 m0, 27648
    s_nop 0
    buffer_load_dwordx4 v19, s[24:27], s47 offen lds
    s_mov_b32 m0, 28672
    s_nop 0
    buffer_load_dwordx4 v20, s[24:27], s47 offen lds
    s_mov_b32 m0, 29696
    s_nop 0
    buffer_load_dwordx4 v21, s[24:27], s47 offen lds
    s_mov_b32 m0, 30720
    s_nop 0
    buffer_load_dwordx4 v22, s[24:27], s47 offen lds
    s_mov_b32 m0, 31744
    s_nop 0
    buffer_load_dwordx4 v23, s[24:27], s47 offen lds
    s_mov_b32 m0, 32768
    s_nop 0
    buffer_load_dwordx4 v24, s[24:27], s47 offen lds
    s_mov_b32 m0, 33792
    s_nop 0
    buffer_load_dwordx4 v25, s[24:27], s47 offen lds
    s_mov_b32 m0, 34816
    s_nop 0
    buffer_load_dwordx4 v26, s[24:27], s47 offen lds
    s_mov_b32 m0, 35840
    s_nop 0
    buffer_load_dwordx4 v27, s[24:27], s47 offen lds
    s_mov_b32 s46, 256
    s_mov_b32 s47, 20480
    s_mov_b32 m0, 61440
    s_nop 0
    buffer_load_dwordx4 v16, s[24:27], s47 offen lds
    s_mov_b32 m0, 62464
    s_nop 0
    buffer_load_dwordx4 v17, s[24:27], s47 offen lds
    s_mov_b32 m0, 63488
    s_nop 0
    buffer_load_dwordx4 v18, s[24:27], s47 offen lds
    s_mov_b32 m0, 64512
    s_nop 0
    buffer_load_dwordx4 v19, s[24:27], s47 offen lds
    s_mov_b32 m0, 65536
    s_nop 0
    buffer_load_dwordx4 v20, s[24:27], s47 offen lds
    s_mov_b32 m0, 66560
    s_nop 0
    buffer_load_dwordx4 v21, s[24:27], s47 offen lds
    s_mov_b32 m0, 67584
    s_nop 0
    buffer_load_dwordx4 v22, s[24:27], s47 offen lds
    s_mov_b32 m0, 68608
    s_nop 0
    buffer_load_dwordx4 v23, s[24:27], s47 offen lds
    s_mov_b32 m0, 69632
    s_nop 0
    buffer_load_dwordx4 v24, s[24:27], s47 offen lds
    s_mov_b32 m0, 70656
    s_nop 0
    buffer_load_dwordx4 v25, s[24:27], s47 offen lds
    s_mov_b32 m0, 71680
    s_nop 0
    buffer_load_dwordx4 v26, s[24:27], s47 offen lds
    s_mov_b32 m0, 72704
    s_nop 0
    buffer_load_dwordx4 v27, s[24:27], s47 offen lds
    s_waitcnt vmcnt(12)
    s_barrier
    s_mov_b32 s46, 512
    s_mov_b32 s47, 40960
    s_mov_b32 m0, 98304
    s_nop 0
    buffer_load_dwordx4 v16, s[24:27], s47 offen lds
    s_mov_b32 m0, 99328
    s_nop 0
    buffer_load_dwordx4 v17, s[24:27], s47 offen lds
    s_mov_b32 m0, 100352
    s_nop 0
    buffer_load_dwordx4 v18, s[24:27], s47 offen lds
    s_mov_b32 m0, 101376
    s_nop 0
    buffer_load_dwordx4 v19, s[24:27], s47 offen lds
    s_mov_b32 m0, 102400
    s_nop 0
    buffer_load_dwordx4 v20, s[24:27], s47 offen lds
    s_mov_b32 m0, 103424
    s_nop 0
    buffer_load_dwordx4 v21, s[24:27], s47 offen lds
    s_mov_b32 m0, 104448
    s_nop 0
    buffer_load_dwordx4 v22, s[24:27], s47 offen lds
    s_mov_b32 m0, 105472
    s_nop 0
    buffer_load_dwordx4 v23, s[24:27], s47 offen lds
    s_mov_b32 m0, 106496
    s_nop 0
    buffer_load_dwordx4 v24, s[24:27], s47 offen lds
    s_mov_b32 m0, 107520
    s_nop 0
    buffer_load_dwordx4 v25, s[24:27], s47 offen lds
    s_mov_b32 m0, 108544
    s_nop 0
    buffer_load_dwordx4 v26, s[24:27], s47 offen lds
    s_mov_b32 m0, 109568
    s_nop 0
    buffer_load_dwordx4 v27, s[24:27], s47 offen lds
    s_waitcnt vmcnt(12)
    s_barrier
    s_mov_b32 s46, 768
    s_mov_b32 s47, 61440
    s_mov_b32 m0, 24576
    s_nop 0
    buffer_load_dwordx4 v16, s[24:27], s47 offen lds
    s_mov_b32 m0, 25600
    s_nop 0
    buffer_load_dwordx4 v17, s[24:27], s47 offen lds
    s_mov_b32 m0, 26624
    s_nop 0
    buffer_load_dwordx4 v18, s[24:27], s47 offen lds
    s_mov_b32 m0, 27648
    s_nop 0
    buffer_load_dwordx4 v19, s[24:27], s47 offen lds
    s_mov_b32 m0, 28672
    s_nop 0
    buffer_load_dwordx4 v20, s[24:27], s47 offen lds
    s_mov_b32 m0, 29696
    s_nop 0
    buffer_load_dwordx4 v21, s[24:27], s47 offen lds
    s_mov_b32 m0, 30720
    s_nop 0
    buffer_load_dwordx4 v22, s[24:27], s47 offen lds
    s_mov_b32 m0, 31744
    s_nop 0
    buffer_load_dwordx4 v23, s[24:27], s47 offen lds
    s_mov_b32 m0, 32768
    s_nop 0
    buffer_load_dwordx4 v24, s[24:27], s47 offen lds
    s_mov_b32 m0, 33792
    s_nop 0
    buffer_load_dwordx4 v25, s[24:27], s47 offen lds
    s_mov_b32 m0, 34816
    s_nop 0
    buffer_load_dwordx4 v26, s[24:27], s47 offen lds
    s_mov_b32 m0, 35840
    s_nop 0
    buffer_load_dwordx4 v27, s[24:27], s47 offen lds
    s_waitcnt vmcnt(12)
    s_barrier
    s_mov_b32 s46, 1024
    s_mov_b32 s47, 81920
    s_mov_b32 m0, 61440
    s_nop 0
    buffer_load_dwordx4 v16, s[24:27], s47 offen lds
    s_mov_b32 m0, 62464
    s_nop 0
    buffer_load_dwordx4 v17, s[24:27], s47 offen lds
    s_mov_b32 m0, 63488
    s_nop 0
    buffer_load_dwordx4 v18, s[24:27], s47 offen lds
    s_mov_b32 m0, 64512
    s_nop 0
    buffer_load_dwordx4 v19, s[24:27], s47 offen lds
    s_mov_b32 m0, 65536
    s_nop 0
    buffer_load_dwordx4 v20, s[24:27], s47 offen lds
    s_mov_b32 m0, 66560
    s_nop 0
    buffer_load_dwordx4 v21, s[24:27], s47 offen lds
    s_mov_b32 m0, 67584
    s_nop 0
    buffer_load_dwordx4 v22, s[24:27], s47 offen lds
    s_mov_b32 m0, 68608
    s_nop 0
    buffer_load_dwordx4 v23, s[24:27], s47 offen lds
    s_mov_b32 m0, 69632
    s_nop 0
    buffer_load_dwordx4 v24, s[24:27], s47 offen lds
    s_mov_b32 m0, 70656
    s_nop 0
    buffer_load_dwordx4 v25, s[24:27], s47 offen lds
    s_mov_b32 m0, 71680
    s_nop 0
    buffer_load_dwordx4 v26, s[24:27], s47 offen lds
    s_mov_b32 m0, 72704
    s_nop 0
    buffer_load_dwordx4 v27, s[24:27], s47 offen lds
    s_waitcnt vmcnt(12)
    s_barrier
    s_waitcnt vmcnt(0)
    s_barrier
    s_waitcnt vmcnt(0)
oproj_kernel_end:
oproj_kernel_exit:
    s_endpgm
.globl ffn_kernel
.p2align 8
.type ffn_kernel,@function
ffn_kernel:
    s_cmp_ge_u32 s2, 276
    s_cbranch_scc1 ffn_kernel_exit
    s_load_dwordx4 s[8:11], s[0:1], 80
    s_load_dwordx2 s[12:13], s[0:1], 96
    s_waitcnt lgkmcnt(0)
    s_add_u32 s20, s12, 12582912
    s_addc_u32 s21, s13, 0
    s_mov_b32 s22, 2621440
    s_mov_b32 s23, 0x00020000
    s_add_u32 s24, s12, 16777216
    s_addc_u32 s25, s13, 0
    s_mov_b32 s26, 32768
    s_mov_b32 s27, 0x00020000
    s_add_u32 s40, s12, 19922944
    s_addc_u32 s41, s13, 0
    s_mov_b32 s42, 64
    s_mov_b32 s43, 0x00020000
    s_mov_b32 s28, s8
    s_mov_b32 s29, s9
    s_mov_b32 s30, 2621440
    s_mov_b32 s31, 0x00020000
    s_mov_b32 s48, s10
    s_mov_b32 s49, s11
    s_mov_b32 s50, 256
    s_mov_b32 s51, 0x00020000
    s_add_u32 s44, s12, 30408704
    s_addc_u32 s45, s13, 0
    s_mov_b32 s46, 6912
    s_mov_b32 s47, 0x00020000
    v_lshlrev_b32 v1, 4, v0
    v_add_u32 v2, 0, v1
    buffer_load_dwordx3 v[88:90], v2, s[24:27], 0 offen
    v_add_u32 v2, 4096, v1
    buffer_load_dwordx3 v[92:94], v2, s[24:27], 0 offen
    v_add_u32 v2, 8192, v1
    buffer_load_dwordx3 v[96:98], v2, s[24:27], 0 offen
    v_add_u32 v2, 12288, v1
    buffer_load_dwordx3 v[100:102], v2, s[24:27], 0 offen
    v_add_u32 v2, 16384, v1
    buffer_load_dwordx3 v[104:106], v2, s[24:27], 0 offen
    v_add_u32 v2, 20480, v1
    buffer_load_dwordx3 v[108:110], v2, s[24:27], 0 offen
    v_add_u32 v2, 24576, v1
    buffer_load_dwordx3 v[112:114], v2, s[24:27], 0 offen
    v_add_u32 v2, 28672, v1
    buffer_load_dwordx3 v[116:118], v2, s[24:27], 0 offen
    v_mov_b32 v2, 0
    buffer_load_dword v125, v2, s[40:43], 0 offen offset:32
    s_cmp_lt_u32 s2, 108
    s_cbranch_scc1 ffn_kernel_ffa
    s_cmp_lt_u32 s2, 148
    s_cbranch_scc1 ffn_kernel_ffb
    s_sub_u32 s16, s2, 148
    s_add_u32 s17, s16, 4
    s_and_b32 s17, s17, 7
    s_lshl_b32 s17, s17, 4
    s_lshr_b32 s16, s16, 3
    s_add_u32 s16, s16, s17
    s_mul_i32 s17, s16, 20480
    s_lshl_b32 s51, s16, 8
    s_lshl_b32 s16, s16, 4
    v_add_u32 v60, 0, v1
    buffer_load_dwordx4 v[16:19], v60, s[20:23], s17 offen
    v_add_u32 v61, 4096, v1
    buffer_load_dwordx4 v[20:23], v61, s[20:23], s17 offen
    v_add_u32 v62, 8192, v1
    buffer_load_dwordx4 v[24:27], v62, s[20:23], s17 offen
    v_add_u32 v63, 12288, v1
    buffer_load_dwordx4 v[28:31], v63, s[20:23], s17 offen
    v_add_u32 v64, 16384, v1
    buffer_load_dwordx4 v[32:35], v64, s[20:23], s17 offen
    v_add_u32 v66, 0, v0
    v_mul_u32_u24 v66, 3277, v66
    v_lshrrev_b32 v66, 18, v66
    v_lshlrev_b32 v72, 4, v66
    buffer_load_dwordx2 v[40:41], v72, s[24:27], s51 offen
    v_add_u32 v67, 256, v0
    v_mul_u32_u24 v67, 3277, v67
    v_lshrrev_b32 v67, 18, v67
    v_lshlrev_b32 v72, 4, v67
    buffer_load_dwordx2 v[42:43], v72, s[24:27], s51 offen
    v_add_u32 v68, 512, v0
    v_mul_u32_u24 v68, 3277, v68
    v_lshrrev_b32 v68, 18, v68
    v_lshlrev_b32 v72, 4, v68
    buffer_load_dwordx2 v[44:45], v72, s[24:27], s51 offen
    v_add_u32 v69, 768, v0
    v_mul_u32_u24 v69, 3277, v69
    v_lshrrev_b32 v69, 18, v69
    v_lshlrev_b32 v72, 4, v69
    buffer_load_dwordx2 v[46:47], v72, s[24:27], s51 offen
    v_add_u32 v70, 1024, v0
    v_mul_u32_u24 v70, 3277, v70
    v_lshrrev_b32 v70, 18, v70
    v_lshlrev_b32 v72, 4, v70
    buffer_load_dwordx2 v[48:49], v72, s[24:27], s51 offen
    s_waitcnt vmcnt(10)
    v_mov_b32 v7, 0
    v_mul_f32 v8, 0x3acccccd, v88
    v_mul_f32 v9, 0x3acccccd, v89
    v_fma_f32 v9, -v8, v8, v9
    v_max_f32 v9, 0, v9
    v_add_f32 v9, 0x3727c5ac, v9
    v_rsq_f32 v9, v9
    v_fma_f32 v10, -v8, v125, v90
    v_mul_f32 v10, v10, v9
    v_ashrrev_i32 v11, 31, v10
    v_or_b32 v11, 0x80000000, v11
    v_xor_b32 v11, v11, v10
    v_and_b32 v11, 0xfffff800, v11
    v_sub_u32 v12, 2047, v0
    v_or_b32 v11, v11, v12
    v_max_u32 v7, v7, v11
    v_mul_f32 v8, 0x3acccccd, v92
    v_mul_f32 v9, 0x3acccccd, v93
    v_fma_f32 v9, -v8, v8, v9
    v_max_f32 v9, 0, v9
    v_add_f32 v9, 0x3727c5ac, v9
    v_rsq_f32 v9, v9
    v_fma_f32 v10, -v8, v125, v94
    v_mul_f32 v10, v10, v9
    v_ashrrev_i32 v11, 31, v10
    v_or_b32 v11, 0x80000000, v11
    v_xor_b32 v11, v11, v10
    v_and_b32 v11, 0xfffff800, v11
    v_sub_u32 v12, 1791, v0
    v_or_b32 v11, v11, v12
    v_max_u32 v7, v7, v11
    v_mul_f32 v8, 0x3acccccd, v96
    v_mul_f32 v9, 0x3acccccd, v97
    v_fma_f32 v9, -v8, v8, v9
    v_max_f32 v9, 0, v9
    v_add_f32 v9, 0x3727c5ac, v9
    v_rsq_f32 v9, v9
    v_fma_f32 v10, -v8, v125, v98
    v_mul_f32 v10, v10, v9
    v_ashrrev_i32 v11, 31, v10
    v_or_b32 v11, 0x80000000, v11
    v_xor_b32 v11, v11, v10
    v_and_b32 v11, 0xfffff800, v11
    v_sub_u32 v12, 1535, v0
    v_or_b32 v11, v11, v12
    v_max_u32 v7, v7, v11
    v_mul_f32 v8, 0x3acccccd, v100
    v_mul_f32 v9, 0x3acccccd, v101
    v_fma_f32 v9, -v8, v8, v9
    v_max_f32 v9, 0, v9
    v_add_f32 v9, 0x3727c5ac, v9
    v_rsq_f32 v9, v9
    v_fma_f32 v10, -v8, v125, v102
    v_mul_f32 v10, v10, v9
    v_ashrrev_i32 v11, 31, v10
    v_or_b32 v11, 0x80000000, v11
    v_xor_b32 v11, v11, v10
    v_and_b32 v11, 0xfffff800, v11
    v_sub_u32 v12, 1279, v0
    v_or_b32 v11, v11, v12
    v_max_u32 v7, v7, v11
    v_mul_f32 v8, 0x3acccccd, v104
    v_mul_f32 v9, 0x3acccccd, v105
    v_fma_f32 v9, -v8, v8, v9
    v_max_f32 v9, 0, v9
    v_add_f32 v9, 0x3727c5ac, v9
    v_rsq_f32 v9, v9
    v_fma_f32 v10, -v8, v125, v106
    v_mul_f32 v10, v10, v9
    v_ashrrev_i32 v11, 31, v10
    v_or_b32 v11, 0x80000000, v11
    v_xor_b32 v11, v11, v10
    v_and_b32 v11, 0xfffff800, v11
    v_sub_u32 v12, 1023, v0
    v_or_b32 v11, v11, v12
    v_max_u32 v7, v7, v11
    v_mul_f32 v8, 0x3acccccd, v108
    v_mul_f32 v9, 0x3acccccd, v109
    v_fma_f32 v9, -v8, v8, v9
    v_max_f32 v9, 0, v9
    v_add_f32 v9, 0x3727c5ac, v9
    v_rsq_f32 v9, v9
    v_fma_f32 v10, -v8, v125, v110
    v_mul_f32 v10, v10, v9
    v_ashrrev_i32 v11, 31, v10
    v_or_b32 v11, 0x80000000, v11
    v_xor_b32 v11, v11, v10
    v_and_b32 v11, 0xfffff800, v11
    v_sub_u32 v12, 767, v0
    v_or_b32 v11, v11, v12
    v_max_u32 v7, v7, v11
    v_mul_f32 v8, 0x3acccccd, v112
    v_mul_f32 v9, 0x3acccccd, v113
    v_fma_f32 v9, -v8, v8, v9
    v_max_f32 v9, 0, v9
    v_add_f32 v9, 0x3727c5ac, v9
    v_rsq_f32 v9, v9
    v_fma_f32 v10, -v8, v125, v114
    v_mul_f32 v10, v10, v9
    v_ashrrev_i32 v11, 31, v10
    v_or_b32 v11, 0x80000000, v11
    v_xor_b32 v11, v11, v10
    v_and_b32 v11, 0xfffff800, v11
    v_sub_u32 v12, 511, v0
    v_or_b32 v11, v11, v12
    v_max_u32 v7, v7, v11
    v_mul_f32 v8, 0x3acccccd, v116
    v_mul_f32 v9, 0x3acccccd, v117
    v_fma_f32 v9, -v8, v8, v9
    v_max_f32 v9, 0, v9
    v_add_f32 v9, 0x3727c5ac, v9
    v_rsq_f32 v9, v9
    v_fma_f32 v10, -v8, v125, v118
    v_mul_f32 v10, v10, v9
    v_ashrrev_i32 v11, 31, v10
    v_or_b32 v11, 0x80000000, v11
    v_xor_b32 v11, v11, v10
    v_and_b32 v11, 0xfffff800, v11
    v_sub_u32 v12, 255, v0
    v_or_b32 v11, v11, v12
    v_max_u32 v7, v7, v11
    s_nop 1
    v_max_u32_dpp v7, v7, v7 row_ror:8 row_mask:0xf bank_mask:0xf
    s_nop 1
    v_max_u32_dpp v7, v7, v7 row_ror:4 row_mask:0xf bank_mask:0xf
    s_nop 1
    v_max_u32_dpp v7, v7, v7 row_ror:2 row_mask:0xf bank_mask:0xf
    s_nop 1
    v_max_u32_dpp v7, v7, v7 row_ror:1 row_mask:0xf bank_mask:0xf
    v_lshrrev_b32 v8, 4, v0
    v_lshlrev_b32 v8, 2, v8
    ds_write_b32 v8, v7
    s_waitcnt lgkmcnt(0)
    s_barrier
    v_mov_b32 v8, 0
    ds_read_b128 v[8:11], v8
    v_mov_b32 v12, 0
    ds_read_b128 v[12:15], v12 offset:16
    v_mov_b32 v2, 0
    ds_read_b128 v[2:5], v2 offset:32
    v_mov_b32 v120, 0
    ds_read_b128 v[120:123], v120 offset:48
    s_waitcnt lgkmcnt(0)
    v_max3_u32 v7, v8, v9, v10
    v_max3_u32 v7, v11, v12, v7
    v_max3_u32 v7, v13, v14, v7
    v_max3_u32 v7, v15, v2, v7
    v_max3_u32 v7, v3, v4, v7
    v_max3_u32 v7, v5, v120, v7
    v_max3_u32 v7, v121, v122, v7
    v_max_u32 v7, v123, v7
    v_and_b32 v7, 0x7ff, v7
    v_sub_u32 v7, 2047, v7
    s_nop 0
    v_readfirstlane_b32 s18, v7
    s_nop 3
    s_lshl_b32 s19, s18, 4
    s_mul_i32 s53, s18, 1280
    s_sub_u32 s18, s18, s16
    v_mov_b32 v73, 0x40000000
    s_waitcnt vmcnt(0)
    v_mul_f32 v52, 0x3acccccd, v40
    v_mul_f32 v53, 0x3acccccd, v41
    v_fma_f32 v53, -v52, v52, v53
    v_max_f32 v53, 0, v53
    v_add_f32 v53, 0x3727c5ac, v53
    v_rsq_f32 v53, v53
    v_cmp_eq_u32 vcc, s18, v66
    v_mul_f32 v52, v52, v53
    s_nop 0
    v_cndmask_b32 v60, v60, v73, vcc
    v_lshlrev_b32 v54, 16, v16
    v_and_b32 v55, 0xffff0000, v16
    v_fma_f32 v56, v54, v53, -v52
    v_fma_f32 v57, v55, v53, -v52
    v_cvt_pk_bf16_f32 v56, v56, v57
    v_lshlrev_b32 v57, 16, v56
    v_and_b32 v56, 0xffff0000, v56
    v_add_f32 v54, v54, v57
    v_add_f32 v55, v55, v56
    v_cvt_pk_bf16_f32 v16, v54, v55
    v_lshlrev_b32 v54, 16, v17
    v_and_b32 v55, 0xffff0000, v17
    v_fma_f32 v56, v54, v53, -v52
    v_fma_f32 v57, v55, v53, -v52
    v_cvt_pk_bf16_f32 v56, v56, v57
    v_lshlrev_b32 v57, 16, v56
    v_and_b32 v56, 0xffff0000, v56
    v_add_f32 v54, v54, v57
    v_add_f32 v55, v55, v56
    v_cvt_pk_bf16_f32 v17, v54, v55
    v_lshlrev_b32 v54, 16, v18
    v_and_b32 v55, 0xffff0000, v18
    v_fma_f32 v56, v54, v53, -v52
    v_fma_f32 v57, v55, v53, -v52
    v_cvt_pk_bf16_f32 v56, v56, v57
    v_lshlrev_b32 v57, 16, v56
    v_and_b32 v56, 0xffff0000, v56
    v_add_f32 v54, v54, v57
    v_add_f32 v55, v55, v56
    v_cvt_pk_bf16_f32 v18, v54, v55
    v_lshlrev_b32 v54, 16, v19
    v_and_b32 v55, 0xffff0000, v19
    v_fma_f32 v56, v54, v53, -v52
    v_fma_f32 v57, v55, v53, -v52
    v_cvt_pk_bf16_f32 v56, v56, v57
    v_lshlrev_b32 v57, 16, v56
    v_and_b32 v56, 0xffff0000, v56
    v_add_f32 v54, v54, v57
    v_add_f32 v55, v55, v56
    v_cvt_pk_bf16_f32 v19, v54, v55
    buffer_store_dwordx4 v[16:19], v60, s[28:31], s17 offen
    v_mul_f32 v52, 0x3acccccd, v42
    v_mul_f32 v53, 0x3acccccd, v43
    v_fma_f32 v53, -v52, v52, v53
    v_max_f32 v53, 0, v53
    v_add_f32 v53, 0x3727c5ac, v53
    v_rsq_f32 v53, v53
    v_cmp_eq_u32 vcc, s18, v67
    v_mul_f32 v52, v52, v53
    s_nop 0
    v_cndmask_b32 v61, v61, v73, vcc
    v_lshlrev_b32 v54, 16, v20
    v_and_b32 v55, 0xffff0000, v20
    v_fma_f32 v56, v54, v53, -v52
    v_fma_f32 v57, v55, v53, -v52
    v_cvt_pk_bf16_f32 v56, v56, v57
    v_lshlrev_b32 v57, 16, v56
    v_and_b32 v56, 0xffff0000, v56
    v_add_f32 v54, v54, v57
    v_add_f32 v55, v55, v56
    v_cvt_pk_bf16_f32 v20, v54, v55
    v_lshlrev_b32 v54, 16, v21
    v_and_b32 v55, 0xffff0000, v21
    v_fma_f32 v56, v54, v53, -v52
    v_fma_f32 v57, v55, v53, -v52
    v_cvt_pk_bf16_f32 v56, v56, v57
    v_lshlrev_b32 v57, 16, v56
    v_and_b32 v56, 0xffff0000, v56
    v_add_f32 v54, v54, v57
    v_add_f32 v55, v55, v56
    v_cvt_pk_bf16_f32 v21, v54, v55
    v_lshlrev_b32 v54, 16, v22
    v_and_b32 v55, 0xffff0000, v22
    v_fma_f32 v56, v54, v53, -v52
    v_fma_f32 v57, v55, v53, -v52
    v_cvt_pk_bf16_f32 v56, v56, v57
    v_lshlrev_b32 v57, 16, v56
    v_and_b32 v56, 0xffff0000, v56
    v_add_f32 v54, v54, v57
    v_add_f32 v55, v55, v56
    v_cvt_pk_bf16_f32 v22, v54, v55
    v_lshlrev_b32 v54, 16, v23
    v_and_b32 v55, 0xffff0000, v23
    v_fma_f32 v56, v54, v53, -v52
    v_fma_f32 v57, v55, v53, -v52
    v_cvt_pk_bf16_f32 v56, v56, v57
    v_lshlrev_b32 v57, 16, v56
    v_and_b32 v56, 0xffff0000, v56
    v_add_f32 v54, v54, v57
    v_add_f32 v55, v55, v56
    v_cvt_pk_bf16_f32 v23, v54, v55
    buffer_store_dwordx4 v[20:23], v61, s[28:31], s17 offen
    v_mul_f32 v52, 0x3acccccd, v44
    v_mul_f32 v53, 0x3acccccd, v45
    v_fma_f32 v53, -v52, v52, v53
    v_max_f32 v53, 0, v53
    v_add_f32 v53, 0x3727c5ac, v53
    v_rsq_f32 v53, v53
    v_cmp_eq_u32 vcc, s18, v68
    v_mul_f32 v52, v52, v53
    s_nop 0
    v_cndmask_b32 v62, v62, v73, vcc
    v_lshlrev_b32 v54, 16, v24
    v_and_b32 v55, 0xffff0000, v24
    v_fma_f32 v56, v54, v53, -v52
    v_fma_f32 v57, v55, v53, -v52
    v_cvt_pk_bf16_f32 v56, v56, v57
    v_lshlrev_b32 v57, 16, v56
    v_and_b32 v56, 0xffff0000, v56
    v_add_f32 v54, v54, v57
    v_add_f32 v55, v55, v56
    v_cvt_pk_bf16_f32 v24, v54, v55
    v_lshlrev_b32 v54, 16, v25
    v_and_b32 v55, 0xffff0000, v25
    v_fma_f32 v56, v54, v53, -v52
    v_fma_f32 v57, v55, v53, -v52
    v_cvt_pk_bf16_f32 v56, v56, v57
    v_lshlrev_b32 v57, 16, v56
    v_and_b32 v56, 0xffff0000, v56
    v_add_f32 v54, v54, v57
    v_add_f32 v55, v55, v56
    v_cvt_pk_bf16_f32 v25, v54, v55
    v_lshlrev_b32 v54, 16, v26
    v_and_b32 v55, 0xffff0000, v26
    v_fma_f32 v56, v54, v53, -v52
    v_fma_f32 v57, v55, v53, -v52
    v_cvt_pk_bf16_f32 v56, v56, v57
    v_lshlrev_b32 v57, 16, v56
    v_and_b32 v56, 0xffff0000, v56
    v_add_f32 v54, v54, v57
    v_add_f32 v55, v55, v56
    v_cvt_pk_bf16_f32 v26, v54, v55
    v_lshlrev_b32 v54, 16, v27
    v_and_b32 v55, 0xffff0000, v27
    v_fma_f32 v56, v54, v53, -v52
    v_fma_f32 v57, v55, v53, -v52
    v_cvt_pk_bf16_f32 v56, v56, v57
    v_lshlrev_b32 v57, 16, v56
    v_and_b32 v56, 0xffff0000, v56
    v_add_f32 v54, v54, v57
    v_add_f32 v55, v55, v56
    v_cvt_pk_bf16_f32 v27, v54, v55
    buffer_store_dwordx4 v[24:27], v62, s[28:31], s17 offen
    v_mul_f32 v52, 0x3acccccd, v46
    v_mul_f32 v53, 0x3acccccd, v47
    v_fma_f32 v53, -v52, v52, v53
    v_max_f32 v53, 0, v53
    v_add_f32 v53, 0x3727c5ac, v53
    v_rsq_f32 v53, v53
    v_cmp_eq_u32 vcc, s18, v69
    v_mul_f32 v52, v52, v53
    s_nop 0
    v_cndmask_b32 v63, v63, v73, vcc
    v_lshlrev_b32 v54, 16, v28
    v_and_b32 v55, 0xffff0000, v28
    v_fma_f32 v56, v54, v53, -v52
    v_fma_f32 v57, v55, v53, -v52
    v_cvt_pk_bf16_f32 v56, v56, v57
    v_lshlrev_b32 v57, 16, v56
    v_and_b32 v56, 0xffff0000, v56
    v_add_f32 v54, v54, v57
    v_add_f32 v55, v55, v56
    v_cvt_pk_bf16_f32 v28, v54, v55
    v_lshlrev_b32 v54, 16, v29
    v_and_b32 v55, 0xffff0000, v29
    v_fma_f32 v56, v54, v53, -v52
    v_fma_f32 v57, v55, v53, -v52
    v_cvt_pk_bf16_f32 v56, v56, v57
    v_lshlrev_b32 v57, 16, v56
    v_and_b32 v56, 0xffff0000, v56
    v_add_f32 v54, v54, v57
    v_add_f32 v55, v55, v56
    v_cvt_pk_bf16_f32 v29, v54, v55
    v_lshlrev_b32 v54, 16, v30
    v_and_b32 v55, 0xffff0000, v30
    v_fma_f32 v56, v54, v53, -v52
    v_fma_f32 v57, v55, v53, -v52
    v_cvt_pk_bf16_f32 v56, v56, v57
    v_lshlrev_b32 v57, 16, v56
    v_and_b32 v56, 0xffff0000, v56
    v_add_f32 v54, v54, v57
    v_add_f32 v55, v55, v56
    v_cvt_pk_bf16_f32 v30, v54, v55
    v_lshlrev_b32 v54, 16, v31
    v_and_b32 v55, 0xffff0000, v31
    v_fma_f32 v56, v54, v53, -v52
    v_fma_f32 v57, v55, v53, -v52
    v_cvt_pk_bf16_f32 v56, v56, v57
    v_lshlrev_b32 v57, 16, v56
    v_and_b32 v56, 0xffff0000, v56
    v_add_f32 v54, v54, v57
    v_add_f32 v55, v55, v56
    v_cvt_pk_bf16_f32 v31, v54, v55
    buffer_store_dwordx4 v[28:31], v63, s[28:31], s17 offen
    v_mul_f32 v52, 0x3acccccd, v48
    v_mul_f32 v53, 0x3acccccd, v49
    v_fma_f32 v53, -v52, v52, v53
    v_max_f32 v53, 0, v53
    v_add_f32 v53, 0x3727c5ac, v53
    v_rsq_f32 v53, v53
    v_cmp_eq_u32 vcc, s18, v70
    v_mul_f32 v52, v52, v53
    s_nop 0
    v_cndmask_b32 v64, v64, v73, vcc
    v_lshlrev_b32 v54, 16, v32
    v_and_b32 v55, 0xffff0000, v32
    v_fma_f32 v56, v54, v53, -v52
    v_fma_f32 v57, v55, v53, -v52
    v_cvt_pk_bf16_f32 v56, v56, v57
    v_lshlrev_b32 v57, 16, v56
    v_and_b32 v56, 0xffff0000, v56
    v_add_f32 v54, v54, v57
    v_add_f32 v55, v55, v56
    v_cvt_pk_bf16_f32 v32, v54, v55
    v_lshlrev_b32 v54, 16, v33
    v_and_b32 v55, 0xffff0000, v33
    v_fma_f32 v56, v54, v53, -v52
    v_fma_f32 v57, v55, v53, -v52
    v_cvt_pk_bf16_f32 v56, v56, v57
    v_lshlrev_b32 v57, 16, v56
    v_and_b32 v56, 0xffff0000, v56
    v_add_f32 v54, v54, v57
    v_add_f32 v55, v55, v56
    v_cvt_pk_bf16_f32 v33, v54, v55
    v_lshlrev_b32 v54, 16, v34
    v_and_b32 v55, 0xffff0000, v34
    v_fma_f32 v56, v54, v53, -v52
    v_fma_f32 v57, v55, v53, -v52
    v_cvt_pk_bf16_f32 v56, v56, v57
    v_lshlrev_b32 v57, 16, v56
    v_and_b32 v56, 0xffff0000, v56
    v_add_f32 v54, v54, v57
    v_add_f32 v55, v55, v56
    v_cvt_pk_bf16_f32 v34, v54, v55
    v_lshlrev_b32 v54, 16, v35
    v_and_b32 v55, 0xffff0000, v35
    v_fma_f32 v56, v54, v53, -v52
    v_fma_f32 v57, v55, v53, -v52
    v_cvt_pk_bf16_f32 v56, v56, v57
    v_lshlrev_b32 v57, 16, v56
    v_and_b32 v56, 0xffff0000, v56
    v_add_f32 v54, v54, v57
    v_add_f32 v55, v55, v56
    v_cvt_pk_bf16_f32 v35, v54, v55
    buffer_store_dwordx4 v[32:35], v64, s[28:31], s17 offen
    s_branch ffn_kernel_end
ffn_kernel_ffa:
    s_add_u32 s32, s12, 20971520
    s_addc_u32 s33, s13, 0
    s_mov_b32 s34, 4423680
    s_mov_b32 s35, 0x00020000
    s_mul_i32 s16, s2, 40960
    s_add_u32 s17, s16, 0
    buffer_load_dwordx4 v[16:19], v1, s[32:35], s17 offen
    s_add_u32 s17, s16, 20480
    buffer_load_dwordx4 v[36:39], v1, s[32:35], s17 offen
    s_add_u32 s17, s16, 4096
    buffer_load_dwordx4 v[20:23], v1, s[32:35], s17 offen
    s_add_u32 s17, s16, 24576
    buffer_load_dwordx4 v[40:43], v1, s[32:35], s17 offen
    s_add_u32 s17, s16, 8192
    buffer_load_dwordx4 v[24:27], v1, s[32:35], s17 offen
    s_add_u32 s17, s16, 28672
    buffer_load_dwordx4 v[44:47], v1, s[32:35], s17 offen
    s_add_u32 s17, s16, 12288
    buffer_load_dwordx4 v[28:31], v1, s[32:35], s17 offen
    s_add_u32 s17, s16, 32768
    buffer_load_dwordx4 v[48:51], v1, s[32:35], s17 offen
    s_add_u32 s17, s16, 16384
    buffer_load_dwordx4 v[32:35], v1, s[32:35], s17 offen
    s_add_u32 s17, s16, 36864
    buffer_load_dwordx4 v[52:55], v1, s[32:35], s17 offen
    s_waitcnt vmcnt(10)
    v_mov_b32 v7, 0
    v_mul_f32 v8, 0x3acccccd, v88
    v_mul_f32 v9, 0x3acccccd, v89
    v_fma_f32 v9, -v8, v8, v9
    v_max_f32 v9, 0, v9
    v_add_f32 v9, 0x3727c5ac, v9
    v_rsq_f32 v9, v9
    v_fma_f32 v10, -v8, v125, v90
    v_mul_f32 v10, v10, v9
    v_ashrrev_i32 v11, 31, v10
    v_or_b32 v11, 0x80000000, v11
    v_xor_b32 v11, v11, v10
    v_and_b32 v11, 0xfffff800, v11
    v_sub_u32 v12, 2047, v0
    v_or_b32 v11, v11, v12
    v_max_u32 v7, v7, v11
    v_mul_f32 v8, 0x3acccccd, v92
    v_mul_f32 v9, 0x3acccccd, v93
    v_fma_f32 v9, -v8, v8, v9
    v_max_f32 v9, 0, v9
    v_add_f32 v9, 0x3727c5ac, v9
    v_rsq_f32 v9, v9
    v_fma_f32 v10, -v8, v125, v94
    v_mul_f32 v10, v10, v9
    v_ashrrev_i32 v11, 31, v10
    v_or_b32 v11, 0x80000000, v11
    v_xor_b32 v11, v11, v10
    v_and_b32 v11, 0xfffff800, v11
    v_sub_u32 v12, 1791, v0
    v_or_b32 v11, v11, v12
    v_max_u32 v7, v7, v11
    v_mul_f32 v8, 0x3acccccd, v96
    v_mul_f32 v9, 0x3acccccd, v97
    v_fma_f32 v9, -v8, v8, v9
    v_max_f32 v9, 0, v9
    v_add_f32 v9, 0x3727c5ac, v9
    v_rsq_f32 v9, v9
    v_fma_f32 v10, -v8, v125, v98
    v_mul_f32 v10, v10, v9
    v_ashrrev_i32 v11, 31, v10
    v_or_b32 v11, 0x80000000, v11
    v_xor_b32 v11, v11, v10
    v_and_b32 v11, 0xfffff800, v11
    v_sub_u32 v12, 1535, v0
    v_or_b32 v11, v11, v12
    v_max_u32 v7, v7, v11
    v_mul_f32 v8, 0x3acccccd, v100
    v_mul_f32 v9, 0x3acccccd, v101
    v_fma_f32 v9, -v8, v8, v9
    v_max_f32 v9, 0, v9
    v_add_f32 v9, 0x3727c5ac, v9
    v_rsq_f32 v9, v9
    v_fma_f32 v10, -v8, v125, v102
    v_mul_f32 v10, v10, v9
    v_ashrrev_i32 v11, 31, v10
    v_or_b32 v11, 0x80000000, v11
    v_xor_b32 v11, v11, v10
    v_and_b32 v11, 0xfffff800, v11
    v_sub_u32 v12, 1279, v0
    v_or_b32 v11, v11, v12
    v_max_u32 v7, v7, v11
    v_mul_f32 v8, 0x3acccccd, v104
    v_mul_f32 v9, 0x3acccccd, v105
    v_fma_f32 v9, -v8, v8, v9
    v_max_f32 v9, 0, v9
    v_add_f32 v9, 0x3727c5ac, v9
    v_rsq_f32 v9, v9
    v_fma_f32 v10, -v8, v125, v106
    v_mul_f32 v10, v10, v9
    v_ashrrev_i32 v11, 31, v10
    v_or_b32 v11, 0x80000000, v11
    v_xor_b32 v11, v11, v10
    v_and_b32 v11, 0xfffff800, v11
    v_sub_u32 v12, 1023, v0
    v_or_b32 v11, v11, v12
    v_max_u32 v7, v7, v11
    v_mul_f32 v8, 0x3acccccd, v108
    v_mul_f32 v9, 0x3acccccd, v109
    v_fma_f32 v9, -v8, v8, v9
    v_max_f32 v9, 0, v9
    v_add_f32 v9, 0x3727c5ac, v9
    v_rsq_f32 v9, v9
    v_fma_f32 v10, -v8, v125, v110
    v_mul_f32 v10, v10, v9
    v_ashrrev_i32 v11, 31, v10
    v_or_b32 v11, 0x80000000, v11
    v_xor_b32 v11, v11, v10
    v_and_b32 v11, 0xfffff800, v11
    v_sub_u32 v12, 767, v0
    v_or_b32 v11, v11, v12
    v_max_u32 v7, v7, v11
    v_mul_f32 v8, 0x3acccccd, v112
    v_mul_f32 v9, 0x3acccccd, v113
    v_fma_f32 v9, -v8, v8, v9
    v_max_f32 v9, 0, v9
    v_add_f32 v9, 0x3727c5ac, v9
    v_rsq_f32 v9, v9
    v_fma_f32 v10, -v8, v125, v114
    v_mul_f32 v10, v10, v9
    v_ashrrev_i32 v11, 31, v10
    v_or_b32 v11, 0x80000000, v11
    v_xor_b32 v11, v11, v10
    v_and_b32 v11, 0xfffff800, v11
    v_sub_u32 v12, 511, v0
    v_or_b32 v11, v11, v12
    v_max_u32 v7, v7, v11
    v_mul_f32 v8, 0x3acccccd, v116
    v_mul_f32 v9, 0x3acccccd, v117
    v_fma_f32 v9, -v8, v8, v9
    v_max_f32 v9, 0, v9
    v_add_f32 v9, 0x3727c5ac, v9
    v_rsq_f32 v9, v9
    v_fma_f32 v10, -v8, v125, v118
    v_mul_f32 v10, v10, v9
    v_ashrrev_i32 v11, 31, v10
    v_or_b32 v11, 0x80000000, v11
    v_xor_b32 v11, v11, v10
    v_and_b32 v11, 0xfffff800, v11
    v_sub_u32 v12, 255, v0
    v_or_b32 v11, v11, v12
    v_max_u32 v7, v7, v11
    s_nop 1
    v_max_u32_dpp v7, v7, v7 row_ror:8 row_mask:0xf bank_mask:0xf
    s_nop 1
    v_max_u32_dpp v7, v7, v7 row_ror:4 row_mask:0xf bank_mask:0xf
    s_nop 1
    v_max_u32_dpp v7, v7, v7 row_ror:2 row_mask:0xf bank_mask:0xf
    s_nop 1
    v_max_u32_dpp v7, v7, v7 row_ror:1 row_mask:0xf bank_mask:0xf
    v_lshrrev_b32 v8, 4, v0
    v_lshlrev_b32 v8, 2, v8
    ds_write_b32 v8, v7
    s_waitcnt lgkmcnt(0)
    s_barrier
    v_mov_b32 v8, 0
    ds_read_b128 v[8:11], v8
    v_mov_b32 v12, 0
    ds_read_b128 v[12:15], v12 offset:16
    v_mov_b32 v2, 0
    ds_read_b128 v[2:5], v2 offset:32
    v_mov_b32 v120, 0
    ds_read_b128 v[120:123], v120 offset:48
    s_waitcnt lgkmcnt(0)
    v_max3_u32 v7, v8, v9, v10
    v_max3_u32 v7, v11, v12, v7
    v_max3_u32 v7, v13, v14, v7
    v_max3_u32 v7, v15, v2, v7
    v_max3_u32 v7, v3, v4, v7
    v_max3_u32 v7, v5, v120, v7
    v_max3_u32 v7, v121, v122, v7
    v_max_u32 v7, v123, v7
    v_and_b32 v7, 0x7ff, v7
    v_sub_u32 v7, 2047, v7
    s_nop 0
    v_readfirstlane_b32 s18, v7
    s_nop 3
    s_lshl_b32 s19, s18, 4
    s_mul_i32 s53, s18, 1280
    v_mov_b32 v2, 0
    buffer_load_dwordx3 v[88:90], v2, s[24:27], s19 offen
    v_and_b32 v8, 0xfe, v0
    buffer_load_ushort v56, v8, s[20:23], s53 offen offset:0
    buffer_load_ushort v57, v8, s[20:23], s53 offen offset:256
    buffer_load_ushort v58, v8, s[20:23], s53 offen offset:512
    buffer_load_ushort v59, v8, s[20:23], s53 offen offset:768
    buffer_load_ushort v60, v8, s[20:23], s53 offen offset:1024
    s_waitcnt vmcnt(5)
    v_mul_f32 v8, 0x3acccccd, v88
    v_mul_f32 v9, 0x3acccccd, v89
    v_fma_f32 v9, -v8, v8, v9
    v_max_f32 v9, 0, v9
    v_add_f32 v9, 0x3727c5ac, v9
    v_rsq_f32 v9, v9
    s_nop 0
    v_mul_f32 v11, v8, v9
    s_waitcnt vmcnt(0)
    v_lshlrev_b32 v56, 16, v56
    v_fma_f32 v56, v56, v9, -v11
    v_cvt_pk_bf16_f32 v56, v56, v56
    v_lshlrev_b32 v56, 16, v56
    v_lshlrev_b32 v57, 16, v57
    v_fma_f32 v57, v57, v9, -v11
    v_cvt_pk_bf16_f32 v57, v57, v57
    v_lshlrev_b32 v57, 16, v57
    v_lshlrev_b32 v58, 16, v58
    v_fma_f32 v58, v58, v9, -v11
    v_cvt_pk_bf16_f32 v58, v58, v58
    v_lshlrev_b32 v58, 16, v58
    v_lshlrev_b32 v59, 16, v59
    v_fma_f32 v59, v59, v9, -v11
    v_cvt_pk_bf16_f32 v59, v59, v59
    v_lshlrev_b32 v59, 16, v59
    v_lshlrev_b32 v60, 16, v60
    v_fma_f32 v60, v60, v9, -v11
    v_cvt_pk_bf16_f32 v60, v60, v60
    v_lshlrev_b32 v60, 16, v60
    v_mov_b32 v64, 0
    v_mov_b32 v65, 0
    v_mov_b32 v66, 0
    v_mov_b32 v67, 0
    v_mov_b32 v68, 0
    v_mov_b32 v69, 0
    v_mov_b32 v70, 0
    v_mov_b32 v71, 0
    v_mov_b32 v72, 0
    v_mov_b32 v73, 0
    v_mov_b32 v74, 0
    v_mov_b32 v75, 0
    v_mov_b32 v76, 0
    v_mov_b32 v77, 0
    v_mov_b32 v78, 0
    v_mov_b32 v79, 0
    v_lshlrev_b32 v12, 16, v16
    v_and_b32 v13, 0xffff0000, v16
    v_fmac_f32 v64, v12, v56
    v_fmac_f32 v65, v13, v56
    v_lshlrev_b32 v12, 16, v17
    v_and_b32 v13, 0xffff0000, v17
    v_fmac_f32 v66, v12, v56
    v_fmac_f32 v67, v13, v56
    v_lshlrev_b32 v12, 16, v18
    v_and_b32 v13, 0xffff0000, v18
    v_fmac_f32 v68, v12, v56
    v_fmac_f32 v69, v13, v56
    v_lshlrev_b32 v12, 16, v19
    v_and_b32 v13, 0xffff0000, v19
    v_fmac_f32 v70, v12, v56
    v_fmac_f32 v71, v13, v56
    v_lshlrev_b32 v12, 16, v36
    v_and_b32 v13, 0xffff0000, v36
    v_fmac_f32 v72, v12, v56
    v_fmac_f32 v73, v13, v56
    v_lshlrev_b32 v12, 16, v37
    v_and_b32 v13, 0xffff0000, v37
    v_fmac_f32 v74, v12, v56
    v_fmac_f32 v75, v13, v56
    v_lshlrev_b32 v12, 16, v38
    v_and_b32 v13, 0xffff0000, v38
    v_fmac_f32 v76, v12, v56
    v_fmac_f32 v77, v13, v56
    v_lshlrev_b32 v12, 16, v39
    v_and_b32 v13, 0xffff0000, v39
    v_fmac_f32 v78, v12, v56
    v_fmac_f32 v79, v13, v56
    v_lshlrev_b32 v12, 16, v20
    v_and_b32 v13, 0xffff0000, v20
    v_fmac_f32 v64, v12, v57
    v_fmac_f32 v65, v13, v57
    v_lshlrev_b32 v12, 16, v21
    v_and_b32 v13, 0xffff0000, v21
    v_fmac_f32 v66, v12, v57
    v_fmac_f32 v67, v13, v57
    v_lshlrev_b32 v12, 16, v22
    v_and_b32 v13, 0xffff0000, v22
    v_fmac_f32 v68, v12, v57
    v_fmac_f32 v69, v13, v57
    v_lshlrev_b32 v12, 16, v23
    v_and_b32 v13, 0xffff0000, v23
    v_fmac_f32 v70, v12, v57
    v_fmac_f32 v71, v13, v57
    v_lshlrev_b32 v12, 16, v40
    v_and_b32 v13, 0xffff0000, v40
    v_fmac_f32 v72, v12, v57
    v_fmac_f32 v73, v13, v57
    v_lshlrev_b32 v12, 16, v41
    v_and_b32 v13, 0xffff0000, v41
    v_fmac_f32 v74, v12, v57
    v_fmac_f32 v75, v13, v57
    v_lshlrev_b32 v12, 16, v42
    v_and_b32 v13, 0xffff0000, v42
    v_fmac_f32 v76, v12, v57
    v_fmac_f32 v77, v13, v57
    v_lshlrev_b32 v12, 16, v43
    v_and_b32 v13, 0xffff0000, v43
    v_fmac_f32 v78, v12, v57
    v_fmac_f32 v79, v13, v57
    v_lshlrev_b32 v12, 16, v24
    v_and_b32 v13, 0xffff0000, v24
    v_fmac_f32 v64, v12, v58
    v_fmac_f32 v65, v13, v58
    v_lshlrev_b32 v12, 16, v25
    v_and_b32 v13, 0xffff0000, v25
    v_fmac_f32 v66, v12, v58
    v_fmac_f32 v67, v13, v58
    v_lshlrev_b32 v12, 16, v26
    v_and_b32 v13, 0xffff0000, v26
    v_fmac_f32 v68, v12, v58
    v_fmac_f32 v69, v13, v58
    v_lshlrev_b32 v12, 16, v27
    v_and_b32 v13, 0xffff0000, v27
    v_fmac_f32 v70, v12, v58
    v_fmac_f32 v71, v13, v58
    v_lshlrev_b32 v12, 16, v44
    v_and_b32 v13, 0xffff0000, v44
    v_fmac_f32 v72, v12, v58
    v_fmac_f32 v73, v13, v58
    v_lshlrev_b32 v12, 16, v45
    v_and_b32 v13, 0xffff0000, v45
    v_fmac_f32 v74, v12, v58
    v_fmac_f32 v75, v13, v58
    v_lshlrev_b32 v12, 16, v46
    v_and_b32 v13, 0xffff0000, v46
    v_fmac_f32 v76, v12, v58
    v_fmac_f32 v77, v13, v58
    v_lshlrev_b32 v12, 16, v47
    v_and_b32 v13, 0xffff0000, v47
    v_fmac_f32 v78, v12, v58
    v_fmac_f32 v79, v13, v58
    v_lshlrev_b32 v12, 16, v28
    v_and_b32 v13, 0xffff0000, v28
    v_fmac_f32 v64, v12, v59
    v_fmac_f32 v65, v13, v59
    v_lshlrev_b32 v12, 16, v29
    v_and_b32 v13, 0xffff0000, v29
    v_fmac_f32 v66, v12, v59
    v_fmac_f32 v67, v13, v59
    v_lshlrev_b32 v12, 16, v30
    v_and_b32 v13, 0xffff0000, v30
    v_fmac_f32 v68, v12, v59
    v_fmac_f32 v69, v13, v59
    v_lshlrev_b32 v12, 16, v31
    v_and_b32 v13, 0xffff0000, v31
    v_fmac_f32 v70, v12, v59
    v_fmac_f32 v71, v13, v59
    v_lshlrev_b32 v12, 16, v48
    v_and_b32 v13, 0xffff0000, v48
    v_fmac_f32 v72, v12, v59
    v_fmac_f32 v73, v13, v59
    v_lshlrev_b32 v12, 16, v49
    v_and_b32 v13, 0xffff0000, v49
    v_fmac_f32 v74, v12, v59
    v_fmac_f32 v75, v13, v59
    v_lshlrev_b32 v12, 16, v50
    v_and_b32 v13, 0xffff0000, v50
    v_fmac_f32 v76, v12, v59
    v_fmac_f32 v77, v13, v59
    v_lshlrev_b32 v12, 16, v51
    v_and_b32 v13, 0xffff0000, v51
    v_fmac_f32 v78, v12, v59
    v_fmac_f32 v79, v13, v59
    v_lshlrev_b32 v12, 16, v32
    v_and_b32 v13, 0xffff0000, v32
    v_fmac_f32 v64, v12, v60
    v_fmac_f32 v65, v13, v60
    v_lshlrev_b32 v12, 16, v33
    v_and_b32 v13, 0xffff0000, v33
    v_fmac_f32 v66, v12, v60
    v_fmac_f32 v67, v13, v60
    v_lshlrev_b32 v12, 16, v34
    v_and_b32 v13, 0xffff0000, v34
    v_fmac_f32 v68, v12, v60
    v_fmac_f32 v69, v13, v60
    v_lshlrev_b32 v12, 16, v35
    v_and_b32 v13, 0xffff0000, v35
    v_fmac_f32 v70, v12, v60
    v_fmac_f32 v71, v13, v60
    v_lshlrev_b32 v12, 16, v52
    v_and_b32 v13, 0xffff0000, v52
    v_fmac_f32 v72, v12, v60
    v_fmac_f32 v73, v13, v60
    v_lshlrev_b32 v12, 16, v53
    v_and_b32 v13, 0xffff0000, v53
    v_fmac_f32 v74, v12, v60
    v_fmac_f32 v75, v13, v60
    v_lshlrev_b32 v12, 16, v54
    v_and_b32 v13, 0xffff0000, v54
    v_fmac_f32 v76, v12, v60
    v_fmac_f32 v77, v13, v60
    v_lshlrev_b32 v12, 16, v55
    v_and_b32 v13, 0xffff0000, v55
    v_fmac_f32 v78, v12, v60
    v_fmac_f32 v79, v13, v60
    s_nop 1
    v_add_f32_dpp v64, v64, v64 row_ror:8 row_mask:0xf bank_mask:0xf
    v_add_f32_dpp v65, v65, v65 row_ror:8 row_mask:0xf bank_mask:0xf
    v_add_f32_dpp v66, v66, v66 row_ror:8 row_mask:0xf bank_mask:0xf
    v_add_f32_dpp v67, v67, v67 row_ror:8 row_mask:0xf bank_mask:0xf
    v_add_f32_dpp v68, v68, v68 row_ror:8 row_mask:0xf bank_mask:0xf
    v_add_f32_dpp v69, v69, v69 row_ror:8 row_mask:0xf bank_mask:0xf
    v_add_f32_dpp v70, v70, v70 row_ror:8 row_mask:0xf bank_mask:0xf
    v_add_f32_dpp v71, v71, v71 row_ror:8 row_mask:0xf bank_mask:0xf
    v_add_f32_dpp v72, v72, v72 row_ror:8 row_mask:0xf bank_mask:0xf
    v_add_f32_dpp v73, v73, v73 row_ror:8 row_mask:0xf bank_mask:0xf
    v_add_f32_dpp v74, v74, v74 row_ror:8 row_mask:0xf bank_mask:0xf
    v_add_f32_dpp v75, v75, v75 row_ror:8 row_mask:0xf bank_mask:0xf
    v_add_f32_dpp v76, v76, v76 row_ror:8 row_mask:0xf bank_mask:0xf
    v_add_f32_dpp v77, v77, v77 row_ror:8 row_mask:0xf bank_mask:0xf
    v_add_f32_dpp v78, v78, v78 row_ror:8 row_mask:0xf bank_mask:0xf
    v_add_f32_dpp v79, v79, v79 row_ror:8 row_mask:0xf bank_mask:0xf
    s_nop 1
    v_add_f32_dpp v64, v64, v64 row_ror:4 row_mask:0xf bank_mask:0xf
    v_add_f32_dpp v65, v65, v65 row_ror:4 row_mask:0xf bank_mask:0xf
    v_add_f32_dpp v66, v66, v66 row_ror:4 row_mask:0xf bank_mask:0xf
    v_add_f32_dpp v67, v67, v67 row_ror:4 row_mask:0xf bank_mask:0xf
    v_add_f32_dpp v68, v68, v68 row_ror:4 row_mask:0xf bank_mask:0xf
    v_add_f32_dpp v69, v69, v69 row_ror:4 row_mask:0xf bank_mask:0xf
    v_add_f32_dpp v70, v70, v70 row_ror:4 row_mask:0xf bank_mask:0xf
    v_add_f32_dpp v71, v71, v71 row_ror:4 row_mask:0xf bank_mask:0xf
    v_add_f32_dpp v72, v72, v72 row_ror:4 row_mask:0xf bank_mask:0xf
    v_add_f32_dpp v73, v73, v73 row_ror:4 row_mask:0xf bank_mask:0xf
    v_add_f32_dpp v74, v74, v74 row_ror:4 row_mask:0xf bank_mask:0xf
    v_add_f32_dpp v75, v75, v75 row_ror:4 row_mask:0xf bank_mask:0xf
    v_add_f32_dpp v76, v76, v76 row_ror:4 row_mask:0xf bank_mask:0xf
    v_add_f32_dpp v77, v77, v77 row_ror:4 row_mask:0xf bank_mask:0xf
    v_add_f32_dpp v78, v78, v78 row_ror:4 row_mask:0xf bank_mask:0xf
    v_add_f32_dpp v79, v79, v79 row_ror:4 row_mask:0xf bank_mask:0xf
    s_nop 1
    v_add_f32_dpp v64, v64, v64 row_ror:2 row_mask:0xf bank_mask:0xf
    v_add_f32_dpp v65, v65, v65 row_ror:2 row_mask:0xf bank_mask:0xf
    v_add_f32_dpp v66, v66, v66 row_ror:2 row_mask:0xf bank_mask:0xf
    v_add_f32_dpp v67, v67, v67 row_ror:2 row_mask:0xf bank_mask:0xf
    v_add_f32_dpp v68, v68, v68 row_ror:2 row_mask:0xf bank_mask:0xf
    v_add_f32_dpp v69, v69, v69 row_ror:2 row_mask:0xf bank_mask:0xf
    v_add_f32_dpp v70, v70, v70 row_ror:2 row_mask:0xf bank_mask:0xf
    v_add_f32_dpp v71, v71, v71 row_ror:2 row_mask:0xf bank_mask:0xf
    v_add_f32_dpp v72, v72, v72 row_ror:2 row_mask:0xf bank_mask:0xf
    v_add_f32_dpp v73, v73, v73 row_ror:2 row_mask:0xf bank_mask:0xf
    v_add_f32_dpp v74, v74, v74 row_ror:2 row_mask:0xf bank_mask:0xf
    v_add_f32_dpp v75, v75, v75 row_ror:2 row_mask:0xf bank_mask:0xf
    v_add_f32_dpp v76, v76, v76 row_ror:2 row_mask:0xf bank_mask:0xf
    v_add_f32_dpp v77, v77, v77 row_ror:2 row_mask:0xf bank_mask:0xf
    v_add_f32_dpp v78, v78, v78 row_ror:2 row_mask:0xf bank_mask:0xf
    v_add_f32_dpp v79, v79, v79 row_ror:2 row_mask:0xf bank_mask:0xf
    v_lshrrev_b32 v12, 4, v0
    v_lshlrev_b32 v12, 7, v12
    v_and_b32 v13, 1, v0
    v_lshl_add_u32 v12, v13, 6, v12
    s_mov_b32 s52, 0x00030003
    s_mov_b32 exec_lo, s52
    s_mov_b32 exec_hi, s52
    ds_write_b128 v12, v[64:67] offset:64
    ds_write_b128 v12, v[68:71] offset:80
    ds_write_b128 v12, v[72:75] offset:96
    ds_write_b128 v12, v[76:79] offset:112
    s_mov_b64 exec, -1
    s_waitcnt lgkmcnt(0)
    s_barrier
    v_and_b32 v13, 7, v0
    v_bfe_u32 v12, v0, 3, 1
    v_lshlrev_b32 v12, 6, v12
    v_lshl_add_u32 v12, v13, 2, v12
    s_cmp_lt_u32 s2, 0x7fffffff
    v_cmp_gt_u32 vcc, 64, v0
    s_cbranch_vccz ffn_kernel_end
    ds_read_b32 v16, v12 offset:64
    ds_read_b32 v32, v12 offset:96
    ds_read_b32 v17, v12 offset:192
    ds_read_b32 v33, v12 offset:224
    ds_read_b32 v18, v12 offset:320
    ds_read_b32 v34, v12 offset:352
    ds_read_b32 v19, v12 offset:448
    ds_read_b32 v35, v12 offset:480
    ds_read_b32 v20, v12 offset:576
    ds_read_b32 v36, v12 offset:608
    ds_read_b32 v21, v12 offset:704
    ds_read_b32 v37, v12 offset:736
    ds_read_b32 v22, v12 offset:832
    ds_read_b32 v38, v12 offset:864
    ds_read_b32 v23, v12 offset:960
    ds_read_b32 v39, v12 offset:992
    ds_read_b32 v24, v12 offset:1088
    ds_read_b32 v40, v12 offset:1120
    ds_read_b32 v25, v12 offset:1216
    ds_read_b32 v41, v12 offset:1248
    ds_read_b32 v26, v12 offset:1344
    ds_read_b32 v42, v12 offset:1376
    ds_read_b32 v27, v12 offset:1472
    ds_read_b32 v43, v12 offset:1504
    ds_read_b32 v28, v12 offset:1600
    ds_read_b32 v44, v12 offset:1632
    ds_read_b32 v29, v12 offset:1728
    ds_read_b32 v45, v12 offset:1760
    ds_read_b32 v30, v12 offset:1856
    ds_read_b32 v46, v12 offset:1888
    ds_read_b32 v31, v12 offset:1984
    ds_read_b32 v47, v12 offset:2016
    s_waitcnt lgkmcnt(0)
    v_add_f32 v16, v16, v24
    v_add_f32 v32, v32, v40
    v_add_f32 v17, v17, v25
    v_add_f32 v33, v33, v41
    v_add_f32 v18, v18, v26
    v_add_f32 v34, v34, v42
    v_add_f32 v19, v19, v27
    v_add_f32 v35, v35, v43
    v_add_f32 v20, v20, v28
    v_add_f32 v36, v36, v44
    v_add_f32 v21, v21, v29
    v_add_f32 v37, v37, v45
    v_add_f32 v22, v22, v30
    v_add_f32 v38, v38, v46
    v_add_f32 v23, v23, v31
    v_add_f32 v39, v39, v47
    v_add_f32 v16, v16, v20
    v_add_f32 v32, v32, v36
    v_add_f32 v17, v17, v21
    v_add_f32 v33, v33, v37
    v_add_f32 v18, v18, v22
    v_add_f32 v34, v34, v38
    v_add_f32 v19, v19, v23
    v_add_f32 v35, v35, v39
    v_add_f32 v16, v16, v18
    v_add_f32 v32, v32, v34
    v_add_f32 v17, v17, v19
    v_add_f32 v33, v33, v35
    v_add_f32 v16, v16, v17
    v_add_f32 v32, v32, v33
    v_cvt_pk_bf16_f32 v16, v16, v32
    v_and_b32 v20, 0xffff0000, v16
    v_lshlrev_b32 v16, 16, v16
    v_mul_f32 v17, 0xbfb8aa3b, v16
    v_exp_f32 v17, v17
    s_nop 0
    v_add_f32 v17, 1.0, v17
    v_rcp_f32 v17, v17
    s_nop 0
    v_mul_f32 v16, v16, v17
    v_cvt_pk_bf16_f32 v16, v16, v16
    v_lshlrev_b32 v16, 16, v16
    v_mul_f32 v16, v16, v20
    v_cvt_pk_bf16_f32 v16, v16, v16
    v_lshlrev_b32 v16, 16, v16
    v_lshlrev_b32 v12, 2, v0
    s_lshl_b32 s16, s2, 6
    s_mov_b64 exec, 0xffff
    buffer_store_dword v16, v12, s[44:47], s16 offen sc1
    s_mov_b64 exec, -1
    s_branch ffn_kernel_end
ffn_kernel_ffb:
    s_add_u32 s32, s12, 27262976
    s_addc_u32 s33, s13, 0
    s_mov_b32 s34, 2211840
    s_mov_b32 s35, 0x00020000
    s_sub_u32 s16, s2, 108
    s_mul_i32 s17, s16, 55296
    v_cmp_gt_u32 vcc, 128, v0
    v_mov_b32 v2, 0x40000000
    s_nop 1
    v_cndmask_b32 v6, v2, v1, vcc
    buffer_load_dwordx4 v[16:19], v1, s[32:35], s17 offen
    s_add_u32 s17, s17, 4096
    buffer_load_dwordx4 v[20:23], v1, s[32:35], s17 offen
    s_add_u32 s17, s17, 4096
    buffer_load_dwordx4 v[24:27], v1, s[32:35], s17 offen
    s_add_u32 s17, s17, 4096
    buffer_load_dwordx4 v[28:31], v1, s[32:35], s17 offen
    s_add_u32 s17, s17, 4096
    buffer_load_dwordx4 v[32:35], v1, s[32:35], s17 offen
    s_add_u32 s17, s17, 4096
    buffer_load_dwordx4 v[36:39], v1, s[32:35], s17 offen
    s_add_u32 s17, s17, 4096
    buffer_load_dwordx4 v[40:43], v1, s[32:35], s17 offen
    s_add_u32 s17, s17, 4096
    buffer_load_dwordx4 v[44:47], v1, s[32:35], s17 offen
    s_add_u32 s17, s17, 4096
    buffer_load_dwordx4 v[48:51], v1, s[32:35], s17 offen
    s_add_u32 s17, s17, 4096
    buffer_load_dwordx4 v[52:55], v1, s[32:35], s17 offen
    s_add_u32 s17, s17, 4096
    buffer_load_dwordx4 v[56:59], v1, s[32:35], s17 offen
    s_add_u32 s17, s17, 4096
    buffer_load_dwordx4 v[60:63], v1, s[32:35], s17 offen
    s_add_u32 s17, s17, 4096
    buffer_load_dwordx4 v[64:67], v1, s[32:35], s17 offen
    s_add_u32 s17, s17, 4096
    buffer_load_dwordx4 v[68:71], v6, s[32:35], s17 offen
    s_add_u32 s17, s17, 4096
    s_waitcnt vmcnt(14)
    v_mov_b32 v7, 0
    v_mul_f32 v8, 0x3acccccd, v88
    v_mul_f32 v9, 0x3acccccd, v89
    v_fma_f32 v9, -v8, v8, v9
    v_max_f32 v9, 0, v9
    v_add_f32 v9, 0x3727c5ac, v9
    v_rsq_f32 v9, v9
    v_fma_f32 v10, -v8, v125, v90
    v_mul_f32 v10, v10, v9
    v_ashrrev_i32 v11, 31, v10
    v_or_b32 v11, 0x80000000, v11
    v_xor_b32 v11, v11, v10
    v_and_b32 v11, 0xfffff800, v11
    v_sub_u32 v12, 2047, v0
    v_or_b32 v11, v11, v12
    v_max_u32 v7, v7, v11
    v_mul_f32 v8, 0x3acccccd, v92
    v_mul_f32 v9, 0x3acccccd, v93
    v_fma_f32 v9, -v8, v8, v9
    v_max_f32 v9, 0, v9
    v_add_f32 v9, 0x3727c5ac, v9
    v_rsq_f32 v9, v9
    v_fma_f32 v10, -v8, v125, v94
    v_mul_f32 v10, v10, v9
    v_ashrrev_i32 v11, 31, v10
    v_or_b32 v11, 0x80000000, v11
    v_xor_b32 v11, v11, v10
    v_and_b32 v11, 0xfffff800, v11
    v_sub_u32 v12, 1791, v0
    v_or_b32 v11, v11, v12
    v_max_u32 v7, v7, v11
    v_mul_f32 v8, 0x3acccccd, v96
    v_mul_f32 v9, 0x3acccccd, v97
    v_fma_f32 v9, -v8, v8, v9
    v_max_f32 v9, 0, v9
    v_add_f32 v9, 0x3727c5ac, v9
    v_rsq_f32 v9, v9
    v_fma_f32 v10, -v8, v125, v98
    v_mul_f32 v10, v10, v9
    v_ashrrev_i32 v11, 31, v10
    v_or_b32 v11, 0x80000000, v11
    v_xor_b32 v11, v11, v10
    v_and_b32 v11, 0xfffff800, v11
    v_sub_u32 v12, 1535, v0
    v_or_b32 v11, v11, v12
    v_max_u32 v7, v7, v11
    v_mul_f32 v8, 0x3acccccd, v100
    v_mul_f32 v9, 0x3acccccd, v101
    v_fma_f32 v9, -v8, v8, v9
    v_max_f32 v9, 0, v9
    v_add_f32 v9, 0x3727c5ac, v9
    v_rsq_f32 v9, v9
    v_fma_f32 v10, -v8, v125, v102
    v_mul_f32 v10, v10, v9
    v_ashrrev_i32 v11, 31, v10
    v_or_b32 v11, 0x80000000, v11
    v_xor_b32 v11, v11, v10
    v_and_b32 v11, 0xfffff800, v11
    v_sub_u32 v12, 1279, v0
    v_or_b32 v11, v11, v12
    v_max_u32 v7, v7, v11
    v_mul_f32 v8, 0x3acccccd, v104
    v_mul_f32 v9, 0x3acccccd, v105
    v_fma_f32 v9, -v8, v8, v9
    v_max_f32 v9, 0, v9
    v_add_f32 v9, 0x3727c5ac, v9
    v_rsq_f32 v9, v9
    v_fma_f32 v10, -v8, v125, v106
    v_mul_f32 v10, v10, v9
    v_ashrrev_i32 v11, 31, v10
    v_or_b32 v11, 0x80000000, v11
    v_xor_b32 v11, v11, v10
    v_and_b32 v11, 0xfffff800, v11
    v_sub_u32 v12, 1023, v0
    v_or_b32 v11, v11, v12
    v_max_u32 v7, v7, v11
    v_mul_f32 v8, 0x3acccccd, v108
    v_mul_f32 v9, 0x3acccccd, v109
    v_fma_f32 v9, -v8, v8, v9
    v_max_f32 v9, 0, v9
    v_add_f32 v9, 0x3727c5ac, v9
    v_rsq_f32 v9, v9
    v_fma_f32 v10, -v8, v125, v110
    v_mul_f32 v10, v10, v9
    v_ashrrev_i32 v11, 31, v10
    v_or_b32 v11, 0x80000000, v11
    v_xor_b32 v11, v11, v10
    v_and_b32 v11, 0xfffff800, v11
    v_sub_u32 v12, 767, v0
    v_or_b32 v11, v11, v12
    v_max_u32 v7, v7, v11
    v_mul_f32 v8, 0x3acccccd, v112
    v_mul_f32 v9, 0x3acccccd, v113
    v_fma_f32 v9, -v8, v8, v9
    v_max_f32 v9, 0, v9
    v_add_f32 v9, 0x3727c5ac, v9
    v_rsq_f32 v9, v9
    v_fma_f32 v10, -v8, v125, v114
    v_mul_f32 v10, v10, v9
    v_ashrrev_i32 v11, 31, v10
    v_or_b32 v11, 0x80000000, v11
    v_xor_b32 v11, v11, v10
    v_and_b32 v11, 0xfffff800, v11
    v_sub_u32 v12, 511, v0
    v_or_b32 v11, v11, v12
    v_max_u32 v7, v7, v11
    v_mul_f32 v8, 0x3acccccd, v116
    v_mul_f32 v9, 0x3acccccd, v117
    v_fma_f32 v9, -v8, v8, v9
    v_max_f32 v9, 0, v9
    v_add_f32 v9, 0x3727c5ac, v9
    v_rsq_f32 v9, v9
    v_fma_f32 v10, -v8, v125, v118
    v_mul_f32 v10, v10, v9
    v_ashrrev_i32 v11, 31, v10
    v_or_b32 v11, 0x80000000, v11
    v_xor_b32 v11, v11, v10
    v_and_b32 v11, 0xfffff800, v11
    v_sub_u32 v12, 255, v0
    v_or_b32 v11, v11, v12
    v_max_u32 v7, v7, v11
    s_nop 1
    v_max_u32_dpp v7, v7, v7 row_ror:8 row_mask:0xf bank_mask:0xf
    s_nop 1
    v_max_u32_dpp v7, v7, v7 row_ror:4 row_mask:0xf bank_mask:0xf
    s_nop 1
    v_max_u32_dpp v7, v7, v7 row_ror:2 row_mask:0xf bank_mask:0xf
    s_nop 1
    v_max_u32_dpp v7, v7, v7 row_ror:1 row_mask:0xf bank_mask:0xf
    v_lshrrev_b32 v8, 4, v0
    v_lshlrev_b32 v8, 2, v8
    ds_write_b32 v8, v7
    s_waitcnt lgkmcnt(0)
    s_barrier
    v_mov_b32 v8, 0
    ds_read_b128 v[8:11], v8
    v_mov_b32 v12, 0
    ds_read_b128 v[12:15], v12 offset:16
    v_mov_b32 v2, 0
    ds_read_b128 v[2:5], v2 offset:32
    v_mov_b32 v120, 0
    ds_read_b128 v[120:123], v120 offset:48
    s_waitcnt lgkmcnt(0)
    v_max3_u32 v7, v8, v9, v10
    v_max3_u32 v7, v11, v12, v7
    v_max3_u32 v7, v13, v14, v7
    v_max3_u32 v7, v15, v2, v7
    v_max3_u32 v7, v3, v4, v7
    v_max3_u32 v7, v5, v120, v7
    v_max3_u32 v7, v121, v122, v7
    v_max_u32 v7, v123, v7
    v_and_b32 v7, 0x7ff, v7
    v_sub_u32 v7, 2047, v7
    s_nop 0
    v_readfirstlane_b32 s18, v7
    s_nop 3
    s_lshl_b32 s19, s18, 4
    s_mul_i32 s53, s18, 1280
    v_mov_b32 v2, 0
    buffer_load_dwordx3 v[88:90], v2, s[24:27], s19 offen
    v_and_b32 v3, 15, v0
    v_lshlrev_b32 v3, 1, v3
    s_lshl_b32 s17, s16, 5
    s_add_u32 s53, s53, s17
    buffer_load_ushort v124, v3, s[20:23], s53 offen
    s_waitcnt vmcnt(1)
    v_mul_f32 v8, 0x3acccccd, v88
    v_mul_f32 v9, 0x3acccccd, v89
    v_fma_f32 v9, -v8, v8, v9
    v_max_f32 v9, 0, v9
    v_add_f32 v9, 0x3727c5ac, v9
    v_rsq_f32 v9, v9
    v_fma_f32 v10, -v8, v125, v90
    v_mul_f32 v10, v10, v9
    s_nop 0
    v_cvt_pk_bf16_f32 v10, v10, v10
    v_lshlrev_b32 v10, 16, v10
    v_mul_f32 v11, 0xbfb8aa3b, v10
    v_exp_f32 v11, v11
    s_nop 0
    v_add_f32 v11, 1.0, v11
    v_rcp_f32 v11, v11
    s_nop 0
    v_cvt_pk_bf16_f32 v11, v11, v11
    v_lshlrev_b32 v11, 16, v11
    s_mov_b32 s17, 0
    v_lshrrev_b32 v4, 1, v0
    v_lshlrev_b32 v4, 2, v4
ffn_kernel_poll:
    s_mov_b32 s16, 0
    buffer_load_dword v72, v4, s[44:47], s16 offen sc1
    s_mov_b32 s16, 512
    buffer_load_dword v73, v4, s[44:47], s16 offen sc1
    s_mov_b32 s16, 1024
    buffer_load_dword v74, v4, s[44:47], s16 offen sc1
    s_mov_b32 s16, 1536
    buffer_load_dword v75, v4, s[44:47], s16 offen sc1
    s_mov_b32 s16, 2048
    buffer_load_dword v76, v4, s[44:47], s16 offen sc1
    s_mov_b32 s16, 2560
    buffer_load_dword v77, v4, s[44:47], s16 offen sc1
    s_mov_b32 s16, 3072
    buffer_load_dword v78, v4, s[44:47], s16 offen sc1
    s_mov_b32 s16, 3584
    buffer_load_dword v79, v4, s[44:47], s16 offen sc1
    s_mov_b32 s16, 4096
    buffer_load_dword v80, v4, s[44:47], s16 offen sc1
    s_mov_b32 s16, 4608
    buffer_load_dword v81, v4, s[44:47], s16 offen sc1
    s_mov_b32 s16, 5120
    buffer_load_dword v82, v4, s[44:47], s16 offen sc1
    s_mov_b32 s16, 5632
    buffer_load_dword v83, v4, s[44:47], s16 offen sc1
    s_mov_b32 s16, 6144
    buffer_load_dword v84, v4, s[44:47], s16 offen sc1
    s_mov_b32 s16, 6656
    buffer_load_dword v85, v4, s[44:47], s16 offen sc1
    s_waitcnt vmcnt(0)
    v_and_b32 v5, v72, v73
    v_max_u32 v5, v72, v73
    v_max3_u32 v5, v74, v75, v5
    v_max3_u32 v5, v76, v77, v5
    v_max3_u32 v5, v78, v79, v5
    v_max3_u32 v5, v80, v81, v5
    v_max3_u32 v5, v82, v83, v5
    v_max3_u32 v5, v84, v85, v5
    v_cmp_eq_u32 vcc, -1, v5
    s_add_u32 s17, s17, 1
    s_cbranch_vccz ffn_kernel_go
    s_cmp_lt_u32 s17, 0x100000
    s_cbranch_scc0 ffn_kernel_go
    s_sleep 2
    s_branch ffn_kernel_poll
ffn_kernel_go:
    v_mov_b32 v104, 0
    v_mov_b32 v105, 0
    v_mov_b32 v106, 0
    v_mov_b32 v107, 0
    v_mov_b32 v108, 0
    v_mov_b32 v109, 0
    v_mov_b32 v110, 0
    v_mov_b32 v111, 0
    v_lshlrev_b32 v12, 16, v16
    v_and_b32 v13, 0xffff0000, v16
    v_fmac_f32 v104, v12, v72
    v_fmac_f32 v105, v13, v72
    v_lshlrev_b32 v12, 16, v17
    v_and_b32 v13, 0xffff0000, v17
    v_fmac_f32 v106, v12, v72
    v_fmac_f32 v107, v13, v72
    v_lshlrev_b32 v12, 16, v18
    v_and_b32 v13, 0xffff0000, v18
    v_fmac_f32 v108, v12, v72
    v_fmac_f32 v109, v13, v72
    v_lshlrev_b32 v12, 16, v19
    v_and_b32 v13, 0xffff0000, v19
    v_fmac_f32 v110, v12, v72
    v_fmac_f32 v111, v13, v72
    v_lshlrev_b32 v12, 16, v20
    v_and_b32 v13, 0xffff0000, v20
    v_fmac_f32 v104, v12, v73
    v_fmac_f32 v105, v13, v73
    v_lshlrev_b32 v12, 16, v21
    v_and_b32 v13, 0xffff0000, v21
    v_fmac_f32 v106, v12, v73
    v_fmac_f32 v107, v13, v73
    v_lshlrev_b32 v12, 16, v22
    v_and_b32 v13, 0xffff0000, v22
    v_fmac_f32 v108, v12, v73
    v_fmac_f32 v109, v13, v73
    v_lshlrev_b32 v12, 16, v23
    v_and_b32 v13, 0xffff0000, v23
    v_fmac_f32 v110, v12, v73
    v_fmac_f32 v111, v13, v73
    v_lshlrev_b32 v12, 16, v24
    v_and_b32 v13, 0xffff0000, v24
    v_fmac_f32 v104, v12, v74
    v_fmac_f32 v105, v13, v74
    v_lshlrev_b32 v12, 16, v25
    v_and_b32 v13, 0xffff0000, v25
    v_fmac_f32 v106, v12, v74
    v_fmac_f32 v107, v13, v74
    v_lshlrev_b32 v12, 16, v26
    v_and_b32 v13, 0xffff0000, v26
    v_fmac_f32 v108, v12, v74
    v_fmac_f32 v109, v13, v74
    v_lshlrev_b32 v12, 16, v27
    v_and_b32 v13, 0xffff0000, v27
    v_fmac_f32 v110, v12, v74
    v_fmac_f32 v111, v13, v74
    v_lshlrev_b32 v12, 16, v28
    v_and_b32 v13, 0xffff0000, v28
    v_fmac_f32 v104, v12, v75
    v_fmac_f32 v105, v13, v75
    v_lshlrev_b32 v12, 16, v29
    v_and_b32 v13, 0xffff0000, v29
    v_fmac_f32 v106, v12, v75
    v_fmac_f32 v107, v13, v75
    v_lshlrev_b32 v12, 16, v30
    v_and_b32 v13, 0xffff0000, v30
    v_fmac_f32 v108, v12, v75
    v_fmac_f32 v109, v13, v75
    v_lshlrev_b32 v12, 16, v31
    v_and_b32 v13, 0xffff0000, v31
    v_fmac_f32 v110, v12, v75
    v_fmac_f32 v111, v13, v75
    v_lshlrev_b32 v12, 16, v32
    v_and_b32 v13, 0xffff0000, v32
    v_fmac_f32 v104, v12, v76
    v_fmac_f32 v105, v13, v76
    v_lshlrev_b32 v12, 16, v33
    v_and_b32 v13, 0xffff0000, v33
    v_fmac_f32 v106, v12, v76
    v_fmac_f32 v107, v13, v76
    v_lshlrev_b32 v12, 16, v34
    v_and_b32 v13, 0xffff0000, v34
    v_fmac_f32 v108, v12, v76
    v_fmac_f32 v109, v13, v76
    v_lshlrev_b32 v12, 16, v35
    v_and_b32 v13, 0xffff0000, v35
    v_fmac_f32 v110, v12, v76
    v_fmac_f32 v111, v13, v76
    v_lshlrev_b32 v12, 16, v36
    v_and_b32 v13, 0xffff0000, v36
    v_fmac_f32 v104, v12, v77
    v_fmac_f32 v105, v13, v77
    v_lshlrev_b32 v12, 16, v37
    v_and_b32 v13, 0xffff0000, v37
    v_fmac_f32 v106, v12, v77
    v_fmac_f32 v107, v13, v77
    v_lshlrev_b32 v12, 16, v38
    v_and_b32 v13, 0xffff0000, v38
    v_fmac_f32 v108, v12, v77
    v_fmac_f32 v109, v13, v77
    v_lshlrev_b32 v12, 16, v39
    v_and_b32 v13, 0xffff0000, v39
    v_fmac_f32 v110, v12, v77
    v_fmac_f32 v111, v13, v77
    v_lshlrev_b32 v12, 16, v40
    v_and_b32 v13, 0xffff0000, v40
    v_fmac_f32 v104, v12, v78
    v_fmac_f32 v105, v13, v78
    v_lshlrev_b32 v12, 16, v41
    v_and_b32 v13, 0xffff0000, v41
    v_fmac_f32 v106, v12, v78
    v_fmac_f32 v107, v13, v78
    v_lshlrev_b32 v12, 16, v42
    v_and_b32 v13, 0xffff0000, v42
    v_fmac_f32 v108, v12, v78
    v_fmac_f32 v109, v13, v78
    v_lshlrev_b32 v12, 16, v43
    v_and_b32 v13, 0xffff0000, v43
    v_fmac_f32 v110, v12, v78
    v_fmac_f32 v111, v13, v78
    v_lshlrev_b32 v12, 16, v44
    v_and_b32 v13, 0xffff0000, v44
    v_fmac_f32 v104, v12, v79
    v_fmac_f32 v105, v13, v79
    v_lshlrev_b32 v12, 16, v45
    v_and_b32 v13, 0xffff0000, v45
    v_fmac_f32 v106, v12, v79
    v_fmac_f32 v107, v13, v79
    v_lshlrev_b32 v12, 16, v46
    v_and_b32 v13, 0xffff0000, v46
    v_fmac_f32 v108, v12, v79
    v_fmac_f32 v109, v13, v79
    v_lshlrev_b32 v12, 16, v47
    v_and_b32 v13, 0xffff0000, v47
    v_fmac_f32 v110, v12, v79
    v_fmac_f32 v111, v13, v79
    v_lshlrev_b32 v12, 16, v48
    v_and_b32 v13, 0xffff0000, v48
    v_fmac_f32 v104, v12, v80
    v_fmac_f32 v105, v13, v80
    v_lshlrev_b32 v12, 16, v49
    v_and_b32 v13, 0xffff0000, v49
    v_fmac_f32 v106, v12, v80
    v_fmac_f32 v107, v13, v80
    v_lshlrev_b32 v12, 16, v50
    v_and_b32 v13, 0xffff0000, v50
    v_fmac_f32 v108, v12, v80
    v_fmac_f32 v109, v13, v80
    v_lshlrev_b32 v12, 16, v51
    v_and_b32 v13, 0xffff0000, v51
    v_fmac_f32 v110, v12, v80
    v_fmac_f32 v111, v13, v80
    v_lshlrev_b32 v12, 16, v52
    v_and_b32 v13, 0xffff0000, v52
    v_fmac_f32 v104, v12, v81
    v_fmac_f32 v105, v13, v81
    v_lshlrev_b32 v12, 16, v53
    v_and_b32 v13, 0xffff0000, v53
    v_fmac_f32 v106, v12, v81
    v_fmac_f32 v107, v13, v81
    v_lshlrev_b32 v12, 16, v54
    v_and_b32 v13, 0xffff0000, v54
    v_fmac_f32 v108, v12, v81
    v_fmac_f32 v109, v13, v81
    v_lshlrev_b32 v12, 16, v55
    v_and_b32 v13, 0xffff0000, v55
    v_fmac_f32 v110, v12, v81
    v_fmac_f32 v111, v13, v81
    v_lshlrev_b32 v12, 16, v56
    v_and_b32 v13, 0xffff0000, v56
    v_fmac_f32 v104, v12, v82
    v_fmac_f32 v105, v13, v82
    v_lshlrev_b32 v12, 16, v57
    v_and_b32 v13, 0xffff0000, v57
    v_fmac_f32 v106, v12, v82
    v_fmac_f32 v107, v13, v82
    v_lshlrev_b32 v12, 16, v58
    v_and_b32 v13, 0xffff0000, v58
    v_fmac_f32 v108, v12, v82
    v_fmac_f32 v109, v13, v82
    v_lshlrev_b32 v12, 16, v59
    v_and_b32 v13, 0xffff0000, v59
    v_fmac_f32 v110, v12, v82
    v_fmac_f32 v111, v13, v82
    v_lshlrev_b32 v12, 16, v60
    v_and_b32 v13, 0xffff0000, v60
    v_fmac_f32 v104, v12, v83
    v_fmac_f32 v105, v13, v83
    v_lshlrev_b32 v12, 16, v61
    v_and_b32 v13, 0xffff0000, v61
    v_fmac_f32 v106, v12, v83
    v_fmac_f32 v107, v13, v83
    v_lshlrev_b32 v12, 16, v62
    v_and_b32 v13, 0xffff0000, v62
    v_fmac_f32 v108, v12, v83
    v_fmac_f32 v109, v13, v83
    v_lshlrev_b32 v12, 16, v63
    v_and_b32 v13, 0xffff0000, v63
    v_fmac_f32 v110, v12, v83
    v_fmac_f32 v111, v13, v83
    v_lshlrev_b32 v12, 16, v64
    v_and_b32 v13, 0xffff0000, v64
    v_fmac_f32 v104, v12, v84
    v_fmac_f32 v105, v13, v84
    v_lshlrev_b32 v12, 16, v65
    v_and_b32 v13, 0xffff0000, v65
    v_fmac_f32 v106, v12, v84
    v_fmac_f32 v107, v13, v84
    v_lshlrev_b32 v12, 16, v66
    v_and_b32 v13, 0xffff0000, v66
    v_fmac_f32 v108, v12, v84
    v_fmac_f32 v109, v13, v84
    v_lshlrev_b32 v12, 16, v67
    v_and_b32 v13, 0xffff0000, v67
    v_fmac_f32 v110, v12, v84
    v_fmac_f32 v111, v13, v84
    v_lshlrev_b32 v12, 16, v68
    v_and_b32 v13, 0xffff0000, v68
    v_fmac_f32 v104, v12, v85
    v_fmac_f32 v105, v13, v85
    v_lshlrev_b32 v12, 16, v69
    v_and_b32 v13, 0xffff0000, v69
    v_fmac_f32 v106, v12, v85
    v_fmac_f32 v107, v13, v85
    v_lshlrev_b32 v12, 16, v70
    v_and_b32 v13, 0xffff0000, v70
    v_fmac_f32 v108, v12, v85
    v_fmac_f32 v109, v13, v85
    v_lshlrev_b32 v12, 16, v71
    v_and_b32 v13, 0xffff0000, v71
    v_fmac_f32 v110, v12, v85
    v_fmac_f32 v111, v13, v85
    s_nop 1
    v_add_f32_dpp v104, v104, v104 row_ror:8 row_mask:0xf bank_mask:0xf
    v_add_f32_dpp v105, v105, v105 row_ror:8 row_mask:0xf bank_mask:0xf
    v_add_f32_dpp v106, v106, v106 row_ror:8 row_mask:0xf bank_mask:0xf
    v_add_f32_dpp v107, v107, v107 row_ror:8 row_mask:0xf bank_mask:0xf
    v_add_f32_dpp v108, v108, v108 row_ror:8 row_mask:0xf bank_mask:0xf
    v_add_f32_dpp v109, v109, v109 row_ror:8 row_mask:0xf bank_mask:0xf
    v_add_f32_dpp v110, v110, v110 row_ror:8 row_mask:0xf bank_mask:0xf
    v_add_f32_dpp v111, v111, v111 row_ror:8 row_mask:0xf bank_mask:0xf
    s_nop 1
    v_add_f32_dpp v104, v104, v104 row_ror:4 row_mask:0xf bank_mask:0xf
    v_add_f32_dpp v105, v105, v105 row_ror:4 row_mask:0xf bank_mask:0xf
    v_add_f32_dpp v106, v106, v106 row_ror:4 row_mask:0xf bank_mask:0xf
    v_add_f32_dpp v107, v107, v107 row_ror:4 row_mask:0xf bank_mask:0xf
    v_add_f32_dpp v108, v108, v108 row_ror:4 row_mask:0xf bank_mask:0xf
    v_add_f32_dpp v109, v109, v109 row_ror:4 row_mask:0xf bank_mask:0xf
    v_add_f32_dpp v110, v110, v110 row_ror:4 row_mask:0xf bank_mask:0xf
    v_add_f32_dpp v111, v111, v111 row_ror:4 row_mask:0xf bank_mask:0xf
    s_nop 1
    v_add_f32_dpp v104, v104, v104 row_ror:2 row_mask:0xf bank_mask:0xf
    v_add_f32_dpp v105, v105, v105 row_ror:2 row_mask:0xf bank_mask:0xf
    v_add_f32_dpp v106, v106, v106 row_ror:2 row_mask:0xf bank_mask:0xf
    v_add_f32_dpp v107, v107, v107 row_ror:2 row_mask:0xf bank_mask:0xf
    v_add_f32_dpp v108, v108, v108 row_ror:2 row_mask:0xf bank_mask:0xf
    v_add_f32_dpp v109, v109, v109 row_ror:2 row_mask:0xf bank_mask:0xf
    v_add_f32_dpp v110, v110, v110 row_ror:2 row_mask:0xf bank_mask:0xf
    v_add_f32_dpp v111, v111, v111 row_ror:2 row_mask:0xf bank_mask:0xf
    v_lshrrev_b32 v12, 4, v0
    v_lshlrev_b32 v12, 7, v12
    v_and_b32 v13, 1, v0
    v_lshl_add_u32 v12, v13, 6, v12
    s_mov_b32 s52, 0x00030003
    s_mov_b32 exec_lo, s52
    s_mov_b32 exec_hi, s52
    ds_write_b128 v12, v[104:107] offset:64
    ds_write_b128 v12, v[108:111] offset:80
    s_mov_b64 exec, -1
    s_waitcnt lgkmcnt(0)
    s_barrier
    v_and_b32 v13, 7, v0
    v_bfe_u32 v12, v0, 3, 1
    v_lshlrev_b32 v12, 6, v12
    v_lshl_add_u32 v12, v13, 2, v12
    v_cmp_gt_u32 vcc, 64, v0
    s_cbranch_vccz ffn_kernel_end
    ds_read_b32 v16, v12 offset:64
    ds_read_b32 v17, v12 offset:192
    ds_read_b32 v18, v12 offset:320
    ds_read_b32 v19, v12 offset:448
    ds_read_b32 v20, v12 offset:576
    ds_read_b32 v21, v12 offset:704
    ds_read_b32 v22, v12 offset:832
    ds_read_b32 v23, v12 offset:960
    ds_read_b32 v24, v12 offset:1088
    ds_read_b32 v25, v12 offset:1216
    ds_read_b32 v26, v12 offset:1344
    ds_read_b32 v27, v12 offset:1472
    ds_read_b32 v28, v12 offset:1600
    ds_read_b32 v29, v12 offset:1728
    ds_read_b32 v30, v12 offset:1856
    ds_read_b32 v31, v12 offset:1984
    s_waitcnt lgkmcnt(0)
    v_add_f32 v16, v16, v24
    v_add_f32 v17, v17, v25
    v_add_f32 v18, v18, v26
    v_add_f32 v19, v19, v27
    v_add_f32 v20, v20, v28
    v_add_f32 v21, v21, v29
    v_add_f32 v22, v22, v30
    v_add_f32 v23, v23, v31
    v_add_f32 v16, v16, v20
    v_add_f32 v17, v17, v21
    v_add_f32 v18, v18, v22
    v_add_f32 v19, v19, v23
    v_add_f32 v16, v16, v18
    v_add_f32 v17, v17, v19
    v_add_f32 v16, v16, v17
    v_cvt_pk_bf16_f32 v16, v16, v16
    v_lshlrev_b32 v16, 16, v16
    v_mul_f32 v16, v16, v11
    v_cvt_pk_bf16_f32 v16, v16, v16
    v_lshlrev_b32 v16, 16, v16
    v_lshlrev_b32 v124, 16, v124
    v_sub_f32 v10, v124, v8
    v_mul_f32 v10, v10, v9
    v_cvt_pk_bf16_f32 v10, v10, v10
    v_lshlrev_b32 v10, 16, v10
    v_add_f32 v10, v10, v16
    v_cvt_pk_bf16_f32 v10, v10, v10
    v_lshlrev_b32 v10, 16, v10
    v_add_f32 v10, v10, v124
    v_cvt_pk_bf16_f32 v10, v10, v10
    s_mov_b64 exec, 0xffff
    buffer_store_short v10, v3, s[28:31], s53 offen
    s_mov_b64 exec, -1
ffn_kernel_end:
ffn_kernel_exit:
    s_endpgm
.section .rodata,"a"
.p2align 6
.amdhsa_kernel kv_kernel
  .amdhsa_next_free_vgpr 96
  .amdhsa_next_free_sgpr 96
  .amdhsa_accum_offset 96
  .amdhsa_group_segment_fixed_size 0
  .amdhsa_kernarg_size 104
  .amdhsa_user_sgpr_count 2
  .amdhsa_user_sgpr_kernarg_segment_ptr 1
  .amdhsa_system_sgpr_workgroup_id_x 1
.end_amdhsa_kernel
.p2align 6
.amdhsa_kernel attn_kernel
  .amdhsa_next_free_vgpr 144
  .amdhsa_next_free_sgpr 96
  .amdhsa_accum_offset 144
  .amdhsa_group_segment_fixed_size 0
  .amdhsa_kernarg_size 104
  .amdhsa_user_sgpr_count 2
  .amdhsa_user_sgpr_kernarg_segment_ptr 1
  .amdhsa_system_sgpr_workgroup_id_x 1
.end_amdhsa_kernel
.p2align 6
.amdhsa_kernel oproj_kernel
  .amdhsa_next_free_vgpr 128
  .amdhsa_next_free_sgpr 96
  .amdhsa_accum_offset 128
  .amdhsa_group_segment_fixed_size 0
  .amdhsa_kernarg_size 104
  .amdhsa_user_sgpr_count 2
  .amdhsa_user_sgpr_kernarg_segment_ptr 1
  .amdhsa_system_sgpr_workgroup_id_x 1
.end_amdhsa_kernel
.p2align 6
.amdhsa_kernel ffn_kernel
  .amdhsa_next_free_vgpr 128
  .amdhsa_next_free_sgpr 96
  .amdhsa_accum_offset 128
  .amdhsa_group_segment_fixed_size 0
  .amdhsa_kernarg_size 104
  .amdhsa_user_sgpr_count 2
  .amdhsa_user_sgpr_kernarg_segment_ptr 1
  .amdhsa_system_sgpr_workgroup_id_x 1
.end_amdhsa_kernel
```
